```python
import torch

def _softmax(x, axis=-1):
    return torch.softmax(x, dim=axis)
def _gelu(x):
    return torch.nn.functional.gelu(x, approximate="tanh")
def _silu(x):
    return torch.nn.functional.silu(x)
def _sigmoid(x):
    return torch.sigmoid(x)
def _layernorm(x, axis=-1, eps=1e-5):
    m = x.mean(dim=axis, keepdim=True)
    v = x.var(dim=axis, keepdim=True, unbiased=False)
    return (x - m) / torch.sqrt(v + eps)
def _scatter_add(tgt, idx, src, axis=0):
    return tgt.clone().index_add_(axis, idx, src)
def _segment_sum(src, seg, n):
    out = torch.zeros((n,) + src.shape[1:], dtype=src.dtype)
    return out.index_add_(0, seg, src)
def _pad(x, pw):
    flat = tuple(v for pair in reversed(pw) for v in pair)
    return torch.nn.functional.pad(x, flat)

kernel_name = 'concat_heads__gqa_block_cached__mha_block_cached__near_ridge'

def setup_inputs():

    _w = (lambda a: (lambda t: t.to(torch.bfloat16) if t.is_floating_point() else t)(torch.as_tensor(a)))
    def _A_setup():
        B, Sq, D = 16, 48, 512
        Hq, Hkv, Sk, Dh = 32, 8, 512, 128
        assert Hq % Hkv == 0, (Hq, Hkv)
        return {
            "x": _w((lambda *s: torch.randn(*s, dtype=torch.bfloat16) * 0.8)(B, Sq, D)),
            "k_cache": _w((lambda *s: torch.randn(*s, dtype=torch.bfloat16) * 0.8)(B, Hkv, Sk, Dh)),
            "v_cache": _w((lambda *s: torch.randn(*s, dtype=torch.bfloat16) * 0.05)(B, Hkv, Sk, Dh)),
            "wq": _w((lambda *s: torch.randn(*s, dtype=torch.bfloat16) * 0.8)(D, Hq * Dh) * (D ** -0.5)),
            "wo": _w((lambda *s: torch.randn(*s, dtype=torch.bfloat16) * 0.05)(Hq * Dh, D) * ((Hq * Dh) ** -0.5)),
        }
    _A_in = _A_setup()

    def _B_setup():
        B, Sq, D = 16, 48, 512
        H, Sk, Dh = 32, 512, 128
        return {
            "x": _w((lambda *s: torch.randn(*s, dtype=torch.bfloat16) * 0.8)(B, Sq, D)),
            "k_cache": _w((lambda *s: torch.randn(*s, dtype=torch.bfloat16) * 0.8)(B, H, Sk, Dh)),
            "v_cache": _w((lambda *s: torch.randn(*s, dtype=torch.bfloat16) * 0.05)(B, H, Sk, Dh)),
            "wq": _w((lambda *s: torch.randn(*s, dtype=torch.bfloat16) * 0.8)(D, H * Dh) * (D ** -0.5)),
            "wo": _w((lambda *s: torch.randn(*s, dtype=torch.bfloat16) * 0.05)(H * Dh, D) * ((H * Dh) ** -0.5)),
        }
    _B_in = _B_setup()

    return {
        "A_x": _A_in["x"],
        "A_k_cache": _A_in["k_cache"],
        "A_v_cache": _A_in["v_cache"],
        "A_wq": _A_in["wq"],
        "A_wo": _A_in["wo"],
        "B_x": _B_in["x"],
        "B_k_cache": _B_in["k_cache"],
        "B_v_cache": _B_in["v_cache"],
        "B_wq": _B_in["wq"],
        "B_wo": _B_in["wo"],
    }

def reference(A_x, A_k_cache, A_v_cache, A_wq, A_wo, B_x, B_k_cache, B_v_cache, B_wq, B_wo):
    def _A_ref(x, k_cache, v_cache, wq, wo):
        B, Sq, D = x.shape
        Hq, Dh = 32, 128
        Hkv = k_cache.shape[1]
        rep = Hq // Hkv
        q = (lambda x, *d: x.permute(*d))((x @ wq).reshape(B, Sq, Hq, Dh), 0, 2, 1, 3)
        k = (lambda x, n, axis: torch.repeat_interleave(x, n, dim=axis))(k_cache, rep, axis=1)
        v = (lambda x, n, axis: torch.repeat_interleave(x, n, dim=axis))(v_cache, rep, axis=1)
        scores = torch.einsum("bhqd,bhkd->bhqk", q, k) * (Dh ** -0.5)
        p = _softmax(scores, axis=-1)
        o = torch.einsum("bhqk,bhkd->bhqd", p, v)
        return (lambda x, *d: x.permute(*d))(o, 0, 2, 1, 3).reshape(B, Sq, Hq * Dh) @ wo

    def _B_ref(x, k_cache, v_cache, wq, wo):
        B, Sq, D = x.shape
        H, Dh = 32, 128
        q = (lambda x, *d: x.permute(*d))((x @ wq).reshape(B, Sq, H, Dh), 0, 2, 1, 3)
        scores = torch.einsum("bhqd,bhkd->bhqk", q, k_cache) * (Dh ** -0.5)
        p = _softmax(scores, axis=-1)
        o = torch.einsum("bhqk,bhkd->bhqd", p, v_cache)
        return (lambda x, *d: x.permute(*d))(o, 0, 2, 1, 3).reshape(B, Sq, H * Dh) @ wo

    a = _A_ref(A_x, A_k_cache, A_v_cache, A_wq, A_wo)
    b = _B_ref(B_x, B_k_cache, B_v_cache, B_wq, B_wo)
    return torch.concatenate([a, b], axis=-1)
```

```asm
; @launch grid=(256,1,1) block=(512,1,1) lds=163840
.amdgcn_target "amdgcn-amd-amdhsa--gfx950"
.text
.globl concat_heads__gqa_block_cached__mha_block_cached__near_ridge_kernel
.p2align 8
.type concat_heads__gqa_block_cached__mha_block_cached__near_ridge_kernel,@function
concat_heads__gqa_block_cached__mha_block_cached__near_ridge_kernel:
  s_cmp_ge_u32 s2, 256
  s_cbranch_scc1 L_end
  s_load_dwordx8 s[44:51], s[0:1], 40
  s_load_dwordx2 s[52:53], s[0:1], 72
  s_load_dwordx8 s[32:39], s[0:1], 0
  s_load_dwordx2 s[40:41], s[0:1], 32
  s_load_dwordx2 s[54:55], s[0:1], 96
  v_lshrrev_b32 v16, 6, v0
  v_and_b32 v22, 63, v0
  v_readfirstlane_b32 s3, v16
  s_and_b32 s57, s2, 7
  s_lshr_b32 s66, s2, 3
  s_and_b32 s56, s66, 15
  s_lshr_b32 s58, s66, 4
  s_bitcmp1_b32 0xaaaa, s56
  s_cselect_b32 s60, 2, 1
  s_mul_i32 s60, s60, s58
  s_and_b32 s67, s3, 3
  s_lshl_b32 s62, s67, 10
  v_lshrrev_b32 v16, 4, v22
  s_lshl_b32 s66, s3, 1
  s_and_b32 s66, s66, 4
  v_or_b32 v17, s66, v16
  v_bfe_u32 v18, v22, 1, 3
  v_xor_b32 v17, v17, v18
  v_lshlrev_b32 v17, 5, v17
  v_and_b32 v18, 1, v22
  v_lshl_or_b32 v3, v18, 4, v17
  s_lshl_b32 s66, s67, 2
  v_add_u32 v2, s66, v16
  v_lshl_add_u32 v4, v2, 13, v3
  s_lshl_b32 s70, s57, 2
  s_add_u32 s70, s70, 1
  s_sub_u32 s70, s70, s58
  s_lshl_b32 s7, s70, 8
  s_getpc_b64 s[68:69]
L_pc0:
  s_lshl_b32 s66, s60, 8
  s_add_u32 s66, s66, L_table-L_pc0
  v_lshl_add_u32 v1, v22, 2, s66
  global_load_dword v1, v1, s[68:69]
  s_bitcmp1_b32 s3, 2
  s_cbranch_scc1 L_nocp
  s_lshr_b32 s66, s2, 3
  s_lshl_b32 s66, s66, 2
  s_add_u32 s66, s66, s3
  s_lshl_b32 s66, s66, 9
  v_lshl_add_u32 v16, v22, 3, s66
  v_min_u32 v16, L_table-L_pc0, v16
  global_load_dwordx2 v[156:157], v16, s[68:69]
L_nocp:
  v_mbcnt_lo_u32_b32 v162, -1, 0
  v_mbcnt_hi_u32_b32 v162, -1, v162
  v_lshrrev_b32 v161, 4, v162
  v_and_b32 v162, 15, v162
  v_xor_b32 v162, v162, v161
  v_lshlrev_b32 v162, 4, v162
  v_lshl_or_b32 v162, v161, 10, v162
  s_mul_i32 s66, s62, 3
  s_add_u32 s89, s66, 98304
  s_mul_i32 s88, s56, 49152
  s_lshl_b32 s69, s66, 2
  s_add_u32 s88, s88, s69
  s_lshr_b32 s66, s66, 4
  s_add_u32 s69, s66, 0
  s_and_b32 s69, s69, 0xc0
  v_xor_b32 v160, s69, v162
  s_add_u32 s69, s66, 64
  s_and_b32 s69, s69, 0xc0
  v_xor_b32 v161, s69, v162
  s_add_u32 s69, s66, 128
  s_and_b32 s69, s69, 0xc0
  v_xor_b32 v162, s69, v162
  s_bitcmp1_b32 s3, 2
  s_waitcnt lgkmcnt(0)
  s_mov_b32 s28, s44
  s_mov_b32 s29, s45
  s_mov_b32 s30, 786432
  s_mov_b32 s31, 0x20000
  s_mov_b32 s24, s38
  s_mov_b32 s25, s39
  s_mov_b32 s26, 4194304
  s_mov_b32 s27, 0x20000
  s_mov_b32 s8, s50
  s_mov_b32 s9, s51
  s_mov_b32 s10, 4194304
  s_mov_b32 s11, 0x20000
  s_mov_b32 s80, s50
  s_mov_b32 s81, s51
  s_mov_b32 s82, 4194304
  s_mov_b32 s83, 0x20000
  s_mov_b32 s84, s50
  s_mov_b32 s85, s51
  s_mov_b32 s86, 4194304
  s_mov_b32 s87, 0x20000
  s_cbranch_scc1 L_pro_ld
  s_branch L_pro_done
L_pro_ld:
  s_cmp_eq_u32 s60, 1
  s_cselect_b64 s[28:29], s[32:33], s[44:45]
  s_cselect_b64 s[80:81], s[38:39], s[50:51]
  s_mov_b32 s96, 262144
  s_cselect_b32 s74, 256, s96
  s_cselect_b32 s96, s96, 1048576
  s_cselect_b32 s5, 15, 3
  s_cselect_b32 s90, 2, 0
  s_lshr_b32 s90, s56, s90
  s_mov_b32 s73, s7
  s_add_u32 s42, s90, 0
  s_and_b32 s42, s42, 3
  s_cmp_eq_u32 s60, 1
  s_cselect_b32 s43, s42, 0
  s_mul_i32 s43, s43, 12288
  s_add_u32 s43, s43, s89
  s_lshl_b32 s42, s42, 8
  s_add_u32 s42, s42, s88
  s_add_u32 m0, s43, 0
  s_nop 0
  buffer_load_dwordx4 v160, s[28:31], s42 offen lds
  s_add_u32 m0, s43, 1024
  s_add_u32 s42, s42, 4096
  buffer_load_dwordx4 v161, s[28:31], s42 offen lds
  s_add_u32 m0, s43, 2048
  s_add_u32 s42, s42, 4096
  buffer_load_dwordx4 v162, s[28:31], s42 offen lds
  s_add_u32 s42, s56, 0
  s_and_b32 s42, s42, s5
  s_mul_i32 s42, s42, s96
  s_add_u32 s42, s42, s73
  s_add_u32 m0, s62, 0
  s_nop 0
  buffer_load_dwordx4 v4, s[80:83], s42 offen lds
  s_add_u32 m0, s62, 4096
  s_add_u32 s43, s42, 131072
  buffer_load_dwordx4 v4, s[80:83], s43 offen lds
  s_add_u32 m0, s62, 8192
  s_add_u32 s42, s42, s74
  buffer_load_dwordx4 v4, s[80:83], s42 offen lds
  s_add_u32 m0, s62, 12288
  s_add_u32 s43, s42, 131072
  buffer_load_dwordx4 v4, s[80:83], s43 offen lds
  s_add_u32 m0, s62, 16384
  s_add_u32 s42, s42, s74
  buffer_load_dwordx4 v4, s[80:83], s42 offen lds
  s_add_u32 m0, s62, 20480
  s_add_u32 s43, s42, 131072
  buffer_load_dwordx4 v4, s[80:83], s43 offen lds
  s_add_u32 m0, s62, 24576
  s_add_u32 s42, s42, s74
  buffer_load_dwordx4 v4, s[80:83], s42 offen lds
  s_add_u32 m0, s62, 28672
  s_add_u32 s43, s42, 131072
  buffer_load_dwordx4 v4, s[80:83], s43 offen lds
  s_add_u32 s42, s90, 1
  s_and_b32 s42, s42, 3
  s_cmp_eq_u32 s60, 1
  s_cselect_b32 s43, s42, 1
  s_mul_i32 s43, s43, 12288
  s_add_u32 s43, s43, s89
  s_lshl_b32 s42, s42, 8
  s_add_u32 s42, s42, s88
  s_add_u32 m0, s43, 0
  s_nop 0
  buffer_load_dwordx4 v160, s[28:31], s42 offen lds
  s_add_u32 m0, s43, 1024
  s_add_u32 s42, s42, 4096
  buffer_load_dwordx4 v161, s[28:31], s42 offen lds
  s_add_u32 m0, s43, 2048
  s_add_u32 s42, s42, 4096
  buffer_load_dwordx4 v162, s[28:31], s42 offen lds
L_pro_done:
  v_mbcnt_lo_u32_b32 v22, -1, 0
  v_mbcnt_hi_u32_b32 v22, -1, v22
  v_lshrrev_b32 v16, 4, v22
  v_and_b32 v17, 15, v22
  v_bfe_u32 v18, v22, 2, 2
  v_and_b32 v19, 3, v22
  v_lshl_add_u32 v20, v16, 3, v18
  v_lshlrev_b32 v20, 8, v20
  v_and_b32 v21, 1, v16
  v_lshl_or_b32 v21, v21, 2, v18
  v_lshl_or_b32 v20, v21, 5, v20
  v_lshl_or_b32 v6, v19, 3, v20
  s_lshr_b32 s66, s62, 4
  v_xor_b32 v5, s66, v6
  s_lshr_b32 s67, s3, 1
  s_lshl_b32 s67, s67, 13
  v_lshrrev_b32 v20, 2, v17
  v_lshl_or_b32 v20, v20, 3, v19
  v_lshlrev_b32 v20, 8, v20
  v_lshrrev_b32 v21, 1, v16
  v_and_b32 v7, 7, v17
  v_xor_b32 v21, v21, v7
  v_lshl_or_b32 v20, v21, 5, v20
  v_and_b32 v21, 1, v16
  v_lshl_or_b32 v20, v21, 4, v20
  s_and_b32 s66, s3, 1
  s_lshl_b32 s66, s66, 10
  s_add_u32 s66, s66, s67
  v_add_u32 v7, s66, v20
  v_mul_u32_u24 v20, 256, v17
  v_add_u32 v20, 98304, v20
  v_xor_b32 v21, v16, v17
  v_lshlrev_b32 v21, 4, v21
  v_xor_b32 v8, 0, v21
  v_add_u32 v8, v8, v20
  v_xor_b32 v9, 64, v21
  v_add_u32 v9, v9, v20
  v_xor_b32 v10, 128, v21
  v_add_u32 v10, v10, v20
  v_xor_b32 v11, 192, v21
  v_add_u32 v11, v11, v20
  v_lshrrev_b32 v21, 1, v16
  s_lshr_b32 s66, s62, 8
  v_add_u32 v21, s66, v21
  v_xor_b32 v21, v21, v17
  v_lshl_add_u32 v12, v21, 4, v20
  v_and_b32 v21, 1, v16
  v_lshl_add_u32 v12, v21, 3, v12
  s_lshr_b32 s66, s3, 1
  s_lshl_b32 s66, s66, 2
  v_add_u32 v21, s66, v16
  v_xor_b32 v21, v21, v17
  v_lshl_add_u32 v13, v21, 4, v20
  s_and_b32 s66, s3, 1
  s_lshl_b32 s66, s66, 3
  v_add_u32 v13, s66, v13
  v_lshlrev_b32 v15, 5, v17
  v_add_u32 v15, 159744, v15
  v_lshlrev_b32 v21, 1, v16
  v_mov_b32 v20, 0x98
  v_lshrrev_b32 v21, v21, v20
  v_and_b32 v21, 3, v21
  v_lshl_add_u32 v14, v21, 9, v15
  s_lshl_b32 s66, s3, 2
  v_add_u32 v14, s66, v14
  s_cmp_eq_u32 s60, 1
  s_cselect_b64 s[12:13], s[34:35], s[46:47]
  s_mov_b32 s14, 67108864
  s_cselect_b32 s14, 16777216, s14
  s_mov_b32 s15, 0x20000
  s_cselect_b64 s[16:17], s[36:37], s[48:49]
  s_mov_b32 s18, 67108864
  s_cselect_b32 s18, 16777216, s18
  s_mov_b32 s19, 0x20000
  s_cselect_b64 s[20:21], s[40:41], s[52:53]
  s_mov_b32 s22, 4194304
  s_mov_b32 s23, 0x20000
  s_lshl_b32 s66, s70, 8
  s_lshl_b32 s67, s56, 5
  s_add_u32 s67, s67, s70
  s_lshl_b32 s67, s67, 17
  s_lshl_b32 s68, s70, 17
  s_lshl_b32 s69, s56, 3
  s_add_u32 s69, s69, s57
  s_lshl_b32 s69, s69, 17
  s_cmp_eq_u32 s58, 1
  s_cselect_b32 s59, 1, 3
  v_mov_b32 v17, s66
  s_bitcmp1_b32 s3, 2
  s_cbranch_scc1 L_tabw
  s_mov_b32 s84, s54
  s_mov_b32 s85, s55
  s_mov_b32 s86, 268435456
  s_mov_b32 s87, 0x20000
  v_mbcnt_lo_u32_b32 v19, -1, 0
  v_mbcnt_hi_u32_b32 v19, -1, v19
  v_lshlrev_b32 v19, 2, v19
  s_lshl_b32 s71, s56, 8
  s_add_u32 s71, s71, 33554432
  s_mov_b32 m0, 163072
  s_cmp_eq_u32 s3, 3
  s_cbranch_scc0 L_tabw0
  buffer_load_dword v19, s[84:87], s71 offen sc1 lds
L_tabw0:
  s_waitcnt vmcnt(0)
L_tabw:
  s_waitcnt vmcnt(14)
  v_bfe_u32 v16, v1, 3, 2
  v_cmp_eq_u32 vcc, 1, v16
  v_mov_b32 v18, s67
  s_nop 0
  v_cndmask_b32 v17, v17, v18, vcc
  v_cmp_eq_u32 vcc, 2, v16
  v_mov_b32 v18, s68
  s_nop 0
  v_cndmask_b32 v17, v17, v18, vcc
  v_cmp_eq_u32 vcc, 3, v16
  v_mov_b32 v18, s69
  s_nop 0
  v_cndmask_b32 v17, v17, v18, vcc
  s_lshl_b32 s71, s56, 20
  s_cmp_eq_u32 s60, 1
  s_cselect_b32 s71, 0, s71
  v_and_b32 v16, 31, v1
  v_cmp_eq_u32 vcc, 0, v16
  v_add_u32 v18, s71, v1
  s_mov_b32 s71, 0x300000
  v_bfi_b32 v18, s71, v18, v1
  v_cndmask_b32 v1, v1, v18, vcc
  s_lshl_b32 s71, s56, 18
  v_and_b32 v16, 7, v1
  v_cmp_eq_u32 vcc, 4, v16
  v_add_u32 v18, s71, v1
  v_and_b32 v18, 0x3fffff, v18
  v_cndmask_b32 v1, v1, v18, vcc
  v_add_u32 v1, v1, v17
  s_mov_b32 s6, 3
  s_mov_b32 s4, 0
  v_readlane_b32 s7, v1, 3
  s_mov_b32 s61, 0x3e0293ee
  s_mov_b32 s64, 0x41000000
  s_or_b32 s91, s58, 1
  s_and_b32 s75, s58, 2
  s_and_b32 s79, s58, 2
  v_mov_b32 v16, 162824
  v_mov_b64 v[18:19], 0
  ds_write_b64 v16, v[18:19]
  s_mov_b32 s101, 0
  s_cmp_eq_u32 s60, 1
  s_cbranch_scc1 L_apath
L_q0:
  s_mov_b32 s65, 2
  s_call_b64 s[92:93], L_qproj
  s_bitcmp1_b32 s3, 2
  s_cbranch_scc1 L_q0ld
  v_xor_b32 v22, 32, v12
  ds_write_b64 v12, v[24:25] offset:49152
  ds_write_b64 v12, v[26:27] offset:53248
  ds_write_b64 v12, v[28:29] offset:57344
  ds_write_b64 v22, v[30:31] offset:49152
  ds_write_b64 v22, v[32:33] offset:53248
  ds_write_b64 v22, v[34:35] offset:57344
  s_cmp_eq_u32 s60, 1
  s_cbranch_scc1 L_q0done
  s_cmp_eq_u32 s60, 2
  s_cbranch_scc1 L_pfc
  v_mbcnt_lo_u32_b32 v17, -1, 0
  v_mbcnt_hi_u32_b32 v17, -1, v17
  v_lshrrev_b32 v16, 4, v17
  v_lshlrev_b32 v17, 4, v17
  v_and_b32 v18, 0xf0, v17
  v_lshl_or_b32 v16, v16, 13, v18
  s_lshl_b32 s66, s57, 2
  s_lshr_b32 s68, s56, 0
  s_lshl_b32 s68, s68, 2
  s_add_u32 s68, s68, s3
  s_mov_b32 s86, 4194304
  s_add_u32 s69, s66, 2
  s_lshl_b32 s69, s69, 8
  s_lshl_b32 s67, s68, 16
  s_add_u32 s67, s67, s69
  s_mov_b64 s[84:85], s[50:51]
  buffer_load_dwordx4 v[156:159], v16, s[84:87], s67 offen
  s_add_u32 s67, s67, 32768
  buffer_load_dwordx4 v[156:159], v16, s[84:87], s67 offen
  s_add_u32 s69, s66, 3
  s_lshl_b32 s69, s69, 8
  s_lshl_b32 s67, s68, 16
  s_add_u32 s67, s67, s69
  s_mov_b64 s[84:85], s[50:51]
  buffer_load_dwordx4 v[156:159], v16, s[84:87], s67 offen
  s_add_u32 s67, s67, 32768
  buffer_load_dwordx4 v[156:159], v16, s[84:87], s67 offen
  s_add_u32 s69, s66, 0
  s_lshl_b32 s69, s69, 17
  s_lshl_b32 s67, s68, 11
  s_add_u32 s67, s67, s69
  s_mov_b64 s[84:85], s[52:53]
  buffer_load_dwordx4 v[156:159], v17, s[84:87], s67 offen
  s_add_u32 s67, s67, 1024
  buffer_load_dwordx4 v[156:159], v17, s[84:87], s67 offen
  s_add_u32 s69, s66, 1
  s_lshl_b32 s69, s69, 17
  s_lshl_b32 s67, s68, 11
  s_add_u32 s67, s67, s69
  s_mov_b64 s[84:85], s[52:53]
  buffer_load_dwordx4 v[156:159], v17, s[84:87], s67 offen
  s_add_u32 s67, s67, 1024
  buffer_load_dwordx4 v[156:159], v17, s[84:87], s67 offen
  s_branch L_q0done
L_pfc:
  s_branch L_q0done
L_q0ld:
  v_mbcnt_lo_u32_b32 v22, -1, 0
  v_mbcnt_hi_u32_b32 v22, -1, v22
  v_lshrrev_b32 v16, 4, v22
  v_and_b32 v17, 15, v22
  v_bfe_u32 v18, v22, 2, 2
  v_and_b32 v19, 3, v22
  v_lshl_add_u32 v20, v16, 3, v18
  v_lshlrev_b32 v20, 8, v20
  v_and_b32 v21, 1, v16
  v_lshl_or_b32 v21, v21, 2, v18
  v_lshl_or_b32 v20, v21, 5, v20
  v_lshl_or_b32 v6, v19, 3, v20
  s_lshr_b32 s66, s62, 4
  v_xor_b32 v5, s66, v6
  s_lshr_b32 s67, s3, 1
  s_lshl_b32 s67, s67, 13
  v_lshrrev_b32 v20, 2, v17
  v_lshl_or_b32 v20, v20, 3, v19
  v_lshlrev_b32 v20, 8, v20
  v_lshrrev_b32 v21, 1, v16
  v_and_b32 v7, 7, v17
  v_xor_b32 v21, v21, v7
  v_lshl_or_b32 v20, v21, 5, v20
  v_and_b32 v21, 1, v16
  v_lshl_or_b32 v20, v21, 4, v20
  s_and_b32 s66, s3, 1
  s_lshl_b32 s66, s66, 10
  s_add_u32 s66, s66, s67
  v_add_u32 v7, s66, v20
  v_mul_u32_u24 v20, 256, v17
  v_add_u32 v20, 98304, v20
  v_xor_b32 v21, v16, v17
  v_lshlrev_b32 v21, 4, v21
  v_xor_b32 v8, 0, v21
  v_add_u32 v8, v8, v20
  v_xor_b32 v9, 64, v21
  v_add_u32 v9, v9, v20
  v_xor_b32 v10, 128, v21
  v_add_u32 v10, v10, v20
  v_xor_b32 v11, 192, v21
  v_add_u32 v11, v11, v20
  v_lshrrev_b32 v21, 1, v16
  s_lshr_b32 s66, s62, 8
  v_add_u32 v21, s66, v21
  v_xor_b32 v21, v21, v17
  v_lshl_add_u32 v12, v21, 4, v20
  v_and_b32 v21, 1, v16
  v_lshl_add_u32 v12, v21, 3, v12
  s_lshr_b32 s66, s3, 1
  s_lshl_b32 s66, s66, 2
  v_add_u32 v21, s66, v16
  v_xor_b32 v21, v21, v17
  v_lshl_add_u32 v13, v21, 4, v20
  s_and_b32 s66, s3, 1
  s_lshl_b32 s66, s66, 3
  v_add_u32 v13, s66, v13
  v_lshlrev_b32 v15, 5, v17
  v_add_u32 v15, 159744, v15
  v_lshlrev_b32 v21, 1, v16
  v_mov_b32 v20, 0x98
  v_lshrrev_b32 v21, v21, v20
  v_and_b32 v21, 3, v21
  v_lshl_add_u32 v14, v21, 9, v15
  s_lshl_b32 s66, s3, 2
  v_add_u32 v14, s66, v14
L_q0done:
  s_branch L_bpath
L_apath:
  s_bitcmp1_b32 s3, 2
  s_cbranch_scc1 L_ct1
L_ct1:
  s_mov_b32 s101, 0
  s_mov_b32 s63, s56
  s_mov_b32 s75, 36864
  s_mov_b32 s65, 3
  s_call_b64 s[92:93], L_wide
  s_bitcmp1_b32 s3, 2
  s_cbranch_scc1 L_qa_ld
  s_barrier
  s_waitcnt vmcnt(0)
  s_getpc_b64 s[68:69]
L_pc1:
  s_sub_u32 s68, s68, L_pc1-L_pc0
  s_subb_u32 s69, s69, 0
  s_lshr_b32 s66, s2, 3
  s_lshl_b32 s66, s66, 2
  s_add_u32 s66, s66, s3
  s_lshl_b32 s66, s66, 9
  v_mbcnt_lo_u32_b32 v16, -1, 0
  v_mbcnt_hi_u32_b32 v16, -1, v16
  v_lshl_add_u32 v16, v16, 3, s66
  v_min_u32 v16, L_table-L_pc0, v16
  global_load_dwordx2 v[50:51], v16, s[68:69]
  s_mul_i32 s66, s3, 12288
  v_mbcnt_lo_u32_b32 v17, -1, 0
  v_mbcnt_hi_u32_b32 v17, -1, v17
  v_lshrrev_b32 v16, 4, v17
  v_and_b32 v17, 15, v17
  v_lshrrev_b32 v18, 1, v16
  v_xor_b32 v18, v18, v17
  v_lshlrev_b32 v18, 4, v18
  v_and_b32 v16, 1, v16
  v_lshl_or_b32 v18, v16, 3, v18
  v_mul_u32_u24 v17, 256, v17
  s_add_u32 s71, s66, 98304
  v_add3_u32 v17, v17, s71, v18
  v_mov_b32 v20, s61
  v_mfma_f32_16x16x32_bf16 v[160:163], v[72:75], v[36:39], v[160:163]
  v_mfma_f32_16x16x32_bf16 v[164:167], v[72:75], v[40:43], v[164:167]
  v_mfma_f32_16x16x32_bf16 v[168:171], v[72:75], v[44:47], v[168:171]
  v_mfma_f32_16x16x32_bf16 v[172:175], v[76:79], v[36:39], v[172:175]
  v_mfma_f32_16x16x32_bf16 v[176:179], v[76:79], v[40:43], v[176:179]
  v_mfma_f32_16x16x32_bf16 v[180:183], v[76:79], v[44:47], v[180:183]
  v_mfma_f32_16x16x32_bf16 v[184:187], v[80:83], v[36:39], v[184:187]
  v_mfma_f32_16x16x32_bf16 v[188:191], v[80:83], v[40:43], v[188:191]
  v_mfma_f32_16x16x32_bf16 v[192:195], v[80:83], v[44:47], v[192:195]
  v_mfma_f32_16x16x32_bf16 v[196:199], v[84:87], v[36:39], v[196:199]
  v_mfma_f32_16x16x32_bf16 v[200:203], v[84:87], v[40:43], v[200:203]
  v_mfma_f32_16x16x32_bf16 v[204:207], v[84:87], v[44:47], v[204:207]
  v_mfma_f32_16x16x32_bf16 v[208:211], v[88:91], v[36:39], v[208:211]
  v_mfma_f32_16x16x32_bf16 v[212:215], v[88:91], v[40:43], v[212:215]
  v_xor_b32 v18, 0, v17
  v_pk_mul_f32 v[160:161], v[160:161], v[20:21] op_sel_hi:[1,0]
  v_pk_mul_f32 v[162:163], v[162:163], v[20:21] op_sel_hi:[1,0]
  v_cvt_pk_bf16_f32 v160, v160, v161
  v_mfma_f32_16x16x32_bf16 v[216:219], v[88:91], v[44:47], v[216:219]
  v_cvt_pk_bf16_f32 v161, v162, v163
  ds_write_b64 v18, v[160:161] offset:0
  v_pk_mul_f32 v[164:165], v[164:165], v[20:21] op_sel_hi:[1,0]
  v_pk_mul_f32 v[166:167], v[166:167], v[20:21] op_sel_hi:[1,0]
  v_mfma_f32_16x16x32_bf16 v[220:223], v[92:95], v[36:39], v[220:223]
  v_cvt_pk_bf16_f32 v164, v164, v165
  v_cvt_pk_bf16_f32 v165, v166, v167
  ds_write_b64 v18, v[164:165] offset:4096
  v_pk_mul_f32 v[168:169], v[168:169], v[20:21] op_sel_hi:[1,0]
  v_mfma_f32_16x16x32_bf16 v[224:227], v[92:95], v[40:43], v[224:227]
  v_pk_mul_f32 v[170:171], v[170:171], v[20:21] op_sel_hi:[1,0]
  v_cvt_pk_bf16_f32 v168, v168, v169
  v_cvt_pk_bf16_f32 v169, v170, v171
  ds_write_b64 v18, v[168:169] offset:8192
  v_mfma_f32_16x16x32_bf16 v[228:231], v[92:95], v[44:47], v[228:231]
  v_xor_b32 v19, 32, v17
  v_pk_mul_f32 v[172:173], v[172:173], v[20:21] op_sel_hi:[1,0]
  v_pk_mul_f32 v[174:175], v[174:175], v[20:21] op_sel_hi:[1,0]
  v_cvt_pk_bf16_f32 v172, v172, v173
  v_mfma_f32_16x16x32_bf16 v[232:235], v[104:107], v[36:39], v[232:235]
  v_cvt_pk_bf16_f32 v173, v174, v175
  ds_write_b64 v19, v[172:173] offset:0
  v_pk_mul_f32 v[176:177], v[176:177], v[20:21] op_sel_hi:[1,0]
  v_pk_mul_f32 v[178:179], v[178:179], v[20:21] op_sel_hi:[1,0]
  v_mfma_f32_16x16x32_bf16 v[236:239], v[104:107], v[40:43], v[236:239]
  v_cvt_pk_bf16_f32 v176, v176, v177
  v_cvt_pk_bf16_f32 v177, v178, v179
  ds_write_b64 v19, v[176:177] offset:4096
  v_pk_mul_f32 v[180:181], v[180:181], v[20:21] op_sel_hi:[1,0]
  v_mfma_f32_16x16x32_bf16 v[240:243], v[104:107], v[44:47], v[240:243]
  v_pk_mul_f32 v[182:183], v[182:183], v[20:21] op_sel_hi:[1,0]
  v_cvt_pk_bf16_f32 v180, v180, v181
  v_cvt_pk_bf16_f32 v181, v182, v183
  ds_write_b64 v19, v[180:181] offset:8192
  v_mfma_f32_16x16x32_bf16 v[244:247], v[108:111], v[36:39], v[244:247]
  v_xor_b32 v18, 64, v17
  v_pk_mul_f32 v[184:185], v[184:185], v[20:21] op_sel_hi:[1,0]
  v_pk_mul_f32 v[186:187], v[186:187], v[20:21] op_sel_hi:[1,0]
  v_cvt_pk_bf16_f32 v184, v184, v185
  v_mfma_f32_16x16x32_bf16 v[248:251], v[108:111], v[40:43], v[248:251]
  v_cvt_pk_bf16_f32 v185, v186, v187
  ds_write_b64 v18, v[184:185] offset:0
  v_pk_mul_f32 v[188:189], v[188:189], v[20:21] op_sel_hi:[1,0]
  v_pk_mul_f32 v[190:191], v[190:191], v[20:21] op_sel_hi:[1,0]
  v_mfma_f32_16x16x32_bf16 v[252:255], v[108:111], v[44:47], v[252:255]
  v_cvt_pk_bf16_f32 v188, v188, v189
  v_cvt_pk_bf16_f32 v189, v190, v191
  ds_write_b64 v18, v[188:189] offset:4096
  v_pk_mul_f32 v[192:193], v[192:193], v[20:21] op_sel_hi:[1,0]
  v_pk_mul_f32 v[194:195], v[194:195], v[20:21] op_sel_hi:[1,0]
  v_cvt_pk_bf16_f32 v192, v192, v193
  v_cvt_pk_bf16_f32 v193, v194, v195
  ds_write_b64 v18, v[192:193] offset:8192
  v_xor_b32 v19, 96, v17
  v_pk_mul_f32 v[196:197], v[196:197], v[20:21] op_sel_hi:[1,0]
  v_pk_mul_f32 v[198:199], v[198:199], v[20:21] op_sel_hi:[1,0]
  v_cvt_pk_bf16_f32 v196, v196, v197
  v_cvt_pk_bf16_f32 v197, v198, v199
  ds_write_b64 v19, v[196:197] offset:0
  v_pk_mul_f32 v[200:201], v[200:201], v[20:21] op_sel_hi:[1,0]
  v_pk_mul_f32 v[202:203], v[202:203], v[20:21] op_sel_hi:[1,0]
  v_cvt_pk_bf16_f32 v200, v200, v201
  v_cvt_pk_bf16_f32 v201, v202, v203
  ds_write_b64 v19, v[200:201] offset:4096
  v_pk_mul_f32 v[204:205], v[204:205], v[20:21] op_sel_hi:[1,0]
  v_pk_mul_f32 v[206:207], v[206:207], v[20:21] op_sel_hi:[1,0]
  v_cvt_pk_bf16_f32 v204, v204, v205
  v_cvt_pk_bf16_f32 v205, v206, v207
  ds_write_b64 v19, v[204:205] offset:8192
  v_xor_b32 v18, 128, v17
  v_pk_mul_f32 v[208:209], v[208:209], v[20:21] op_sel_hi:[1,0]
  v_pk_mul_f32 v[210:211], v[210:211], v[20:21] op_sel_hi:[1,0]
  v_cvt_pk_bf16_f32 v208, v208, v209
  v_cvt_pk_bf16_f32 v209, v210, v211
  ds_write_b64 v18, v[208:209] offset:0
  v_pk_mul_f32 v[212:213], v[212:213], v[20:21] op_sel_hi:[1,0]
  v_pk_mul_f32 v[214:215], v[214:215], v[20:21] op_sel_hi:[1,0]
  v_cvt_pk_bf16_f32 v212, v212, v213
  v_cvt_pk_bf16_f32 v213, v214, v215
  ds_write_b64 v18, v[212:213] offset:4096
  v_pk_mul_f32 v[216:217], v[216:217], v[20:21] op_sel_hi:[1,0]
  v_pk_mul_f32 v[218:219], v[218:219], v[20:21] op_sel_hi:[1,0]
  v_cvt_pk_bf16_f32 v216, v216, v217
  v_cvt_pk_bf16_f32 v217, v218, v219
  ds_write_b64 v18, v[216:217] offset:8192
  v_xor_b32 v19, 160, v17
  v_pk_mul_f32 v[220:221], v[220:221], v[20:21] op_sel_hi:[1,0]
  v_pk_mul_f32 v[222:223], v[222:223], v[20:21] op_sel_hi:[1,0]
  v_cvt_pk_bf16_f32 v220, v220, v221
  v_cvt_pk_bf16_f32 v221, v222, v223
  ds_write_b64 v19, v[220:221] offset:0
  v_pk_mul_f32 v[224:225], v[224:225], v[20:21] op_sel_hi:[1,0]
  v_pk_mul_f32 v[226:227], v[226:227], v[20:21] op_sel_hi:[1,0]
  v_cvt_pk_bf16_f32 v224, v224, v225
  v_cvt_pk_bf16_f32 v225, v226, v227
  ds_write_b64 v19, v[224:225] offset:4096
  v_pk_mul_f32 v[228:229], v[228:229], v[20:21] op_sel_hi:[1,0]
  v_pk_mul_f32 v[230:231], v[230:231], v[20:21] op_sel_hi:[1,0]
  v_cvt_pk_bf16_f32 v228, v228, v229
  v_cvt_pk_bf16_f32 v229, v230, v231
  ds_write_b64 v19, v[228:229] offset:8192
  v_xor_b32 v18, 192, v17
  v_pk_mul_f32 v[232:233], v[232:233], v[20:21] op_sel_hi:[1,0]
  v_pk_mul_f32 v[234:235], v[234:235], v[20:21] op_sel_hi:[1,0]
  v_cvt_pk_bf16_f32 v232, v232, v233
  v_cvt_pk_bf16_f32 v233, v234, v235
  ds_write_b64 v18, v[232:233] offset:0
  v_pk_mul_f32 v[236:237], v[236:237], v[20:21] op_sel_hi:[1,0]
  v_pk_mul_f32 v[238:239], v[238:239], v[20:21] op_sel_hi:[1,0]
  v_cvt_pk_bf16_f32 v236, v236, v237
  v_cvt_pk_bf16_f32 v237, v238, v239
  ds_write_b64 v18, v[236:237] offset:4096
  v_pk_mul_f32 v[240:241], v[240:241], v[20:21] op_sel_hi:[1,0]
  v_pk_mul_f32 v[242:243], v[242:243], v[20:21] op_sel_hi:[1,0]
  v_cvt_pk_bf16_f32 v240, v240, v241
  v_cvt_pk_bf16_f32 v241, v242, v243
  ds_write_b64 v18, v[240:241] offset:8192
  v_xor_b32 v19, 224, v17
  v_pk_mul_f32 v[244:245], v[244:245], v[20:21] op_sel_hi:[1,0]
  v_pk_mul_f32 v[246:247], v[246:247], v[20:21] op_sel_hi:[1,0]
  v_cvt_pk_bf16_f32 v244, v244, v245
  v_cvt_pk_bf16_f32 v245, v246, v247
  ds_write_b64 v19, v[244:245] offset:0
  v_pk_mul_f32 v[248:249], v[248:249], v[20:21] op_sel_hi:[1,0]
  v_pk_mul_f32 v[250:251], v[250:251], v[20:21] op_sel_hi:[1,0]
  v_cvt_pk_bf16_f32 v248, v248, v249
  v_cvt_pk_bf16_f32 v249, v250, v251
  ds_write_b64 v19, v[248:249] offset:4096
  v_pk_mul_f32 v[252:253], v[252:253], v[20:21] op_sel_hi:[1,0]
  v_pk_mul_f32 v[254:255], v[254:255], v[20:21] op_sel_hi:[1,0]
  v_cvt_pk_bf16_f32 v252, v252, v253
  v_cvt_pk_bf16_f32 v253, v254, v255
  ds_write_b64 v19, v[252:253] offset:8192
  s_branch L_qa_done
L_qa_ld:
  s_waitcnt vmcnt(8) lgkmcnt(0)
  s_barrier
  s_add_u32 m0, s5, 0
  s_add_u32 s90, s72, s88
  buffer_load_dwordx4 v4, s[80:83], s72 offen nt lds
  s_add_u32 m0, m0, 4096
  s_nop 0
  buffer_load_dwordx4 v4, s[80:83], s90 offen nt lds
L_sk2:
  s_add_u32 s72, s72, s74
  s_add_u32 m0, s5, 8192
  s_add_u32 s90, s72, s88
  buffer_load_dwordx4 v4, s[80:83], s72 offen nt lds
  s_add_u32 m0, m0, 4096
  s_nop 0
  buffer_load_dwordx4 v4, s[80:83], s90 offen nt lds
L_sk3:
  s_add_u32 s72, s72, s74
  s_add_u32 m0, s5, 16384
  s_add_u32 s90, s72, s88
  buffer_load_dwordx4 v4, s[80:83], s72 offen nt lds
  s_add_u32 m0, m0, 4096
  s_nop 0
  buffer_load_dwordx4 v4, s[80:83], s90 offen nt lds
L_sk4:
  s_add_u32 s72, s72, s74
  s_add_u32 m0, s5, 24576
  s_add_u32 s90, s72, s88
  buffer_load_dwordx4 v4, s[80:83], s72 offen nt lds
  s_add_u32 m0, m0, 4096
  s_nop 0
  buffer_load_dwordx4 v4, s[80:83], s90 offen nt lds
L_sk5:
L_qa_done:
  s_and_b32 s66, s3, 1
  s_lshl_b32 s68, s66, 14
  s_lshl_b32 s69, s66, 7
  s_lshl_b32 s66, s66, 10
  s_lshr_b32 s67, s3, 1
  s_mul_i32 s63, s67, 12288
  s_lshl_b32 s67, s67, 13
  s_add_u32 s66, s66, s67
  s_sub_u32 s66, s68, s66
  v_add_u32 v5, s66, v7
  v_xor_b32 v7, s69, v6
  v_add_u32 v7, s68, v7
  s_mov_b32 s98, s4
  s_add_u32 s4, s4, 32768
  s_cmp_eq_u32 s4, 98304
  s_cselect_b32 s4, 0, s4
  s_mov_b32 s99, s4
  s_add_u32 s4, s4, 32768
  s_cmp_eq_u32 s4, 98304
  s_cselect_b32 s4, 0, s4
  s_xor_b32 s100, s98, s4
  s_xor_b32 s101, s99, 98304
  v_add_u32 v16, s98, v5
  v_xor_b32 v17, 64, v16
  v_xor_b32 v18, 128, v16
  v_xor_b32 v19, 192, v16
  s_lshl_b32 s69, s56, 3
  s_add_u32 s69, s69, s57
  s_lshl_b32 s69, s69, 17
  s_lshl_b32 s70, s3, 10
  s_and_b32 s71, s70, 4096
  s_add_u32 s69, s69, s71
  s_add_u32 s71, s99, s70
  s_add_u32 s70, s4, s70
  s_add_u32 s4, s4, 32768
  s_cmp_eq_u32 s4, 98304
  s_cselect_b32 s4, 0, s4
  s_add_u32 s42, s69, 24576
  s_add_u32 s43, s69, 57344
  s_bitcmp1_b32 s3, 2
  s_cselect_b64 s[80:81], s[12:13], s[16:17]
  s_mov_b32 s82, 16777216
  s_cselect_b32 s72, s43, s42
  s_cselect_b32 s5, s70, s71
  s_cselect_b32 s67, s100, s101
  s_mov_b32 s74, 8192
  s_mov_b32 s73, 1
  v_lshl_add_u32 v4, v2, 8, v3
  s_cselect_b64 s[84:85], s[16:17], s[12:13]
  s_mov_b32 s86, 16777216
  s_cselect_b32 s94, s42, s43
  s_cselect_b32 s97, s71, s70
  s_cselect_b32 s68, s101, s100
  s_mov_b32 s96, 8192
  s_mov_b32 s95, 1
  v_lshl_add_u32 v0, v2, 8, v3
  s_mov_b32 s66, 0
  s_mov_b32 s28, s48
  s_mov_b32 s29, s49
  s_mov_b32 s30, 0
  s_mov_b32 s31, 0x20000
  s_and_b32 s69, s56, 14
  s_lshl_b32 s69, s69, 3
  s_add_u32 s69, s69, s57
  s_lshl_b32 s69, s69, 19
  s_add_u32 s70, s69, 131072
  s_cmp_eq_u32 s60, 2
  s_cselect_b32 s30, s70, 0
  s_and_b32 s70, s3, 4
  s_lshl_b32 s70, s70, 10
  s_add_u32 s69, s69, s70
  s_add_u32 s69, s69, 57344
  v_mov_b64 v[12:13], 0
  v_mov_b64 v[14:15], 0
  v_mov_b64 v[56:57], 0
  v_mov_b64 v[58:59], 0
  v_mov_b64 v[60:61], 0
  v_mov_b64 v[62:63], 0
  s_mov_b32 s79, 0
  s_mov_b32 s65, 4
  s_bitcmp1_b32 s3, 2
  s_cbranch_scc0 L_att0
  s_xor_b32 s97, s97, s68
  s_add_u32 s66, s66, 1
  s_cmp_ge_u32 s66, 6
  s_cbranch_scc1 L_wo6
L_wb7:
  v_add_u32 v44, s63, v8
  v_add_u32 v45, s63, v9
  v_add_u32 v46, s63, v10
  v_add_u32 v47, s63, v11
  ds_read_b128 v[64:67], v44 offset:0
  ds_read_b128 v[80:83], v44 offset:4096
  ds_read_b128 v[96:99], v44 offset:8192
  ds_read_b128 v[68:71], v45 offset:0
  ds_read_b128 v[84:87], v45 offset:4096
  ds_read_b128 v[100:103], v45 offset:8192
  ds_read_b128 v[72:75], v46 offset:0
  ds_read_b128 v[88:91], v46 offset:4096
  ds_read_b128 v[104:107], v46 offset:8192
  ds_read_b128 v[76:79], v47 offset:0
  ds_read_b128 v[92:95], v47 offset:4096
  ds_read_b128 v[108:111], v47 offset:8192
L_att0:
  s_bitcmp1_b32 s3, 2
  s_cbranch_scc1 L_ey8
  s_waitcnt vmcnt(8) lgkmcnt(0)
  s_barrier
  v_add_u32 v44, s63, v8
  v_add_u32 v45, s63, v9
  v_add_u32 v46, s63, v10
  v_add_u32 v47, s63, v11
  ds_read_b128 v[64:67], v44 offset:0
  ds_read_b128 v[80:83], v44 offset:4096
  ds_read_b128 v[96:99], v44 offset:8192
  ds_read_b128 v[68:71], v45 offset:0
  ds_read_b128 v[84:87], v45 offset:4096
  ds_read_b128 v[100:103], v45 offset:8192
  ds_read_b128 v[72:75], v46 offset:0
  ds_read_b128 v[88:91], v46 offset:4096
  ds_read_b128 v[104:107], v46 offset:8192
  ds_read_b128 v[76:79], v47 offset:0
  ds_read_b128 v[92:95], v47 offset:4096
  ds_read_b128 v[108:111], v47 offset:8192
  ds_read_b128 v[24:27], v16 offset:0
  ds_read_b128 v[28:31], v17 offset:0
  ds_read_b128 v[32:35], v18 offset:0
  ds_read_b128 v[36:39], v19 offset:0
  ds_read_b128 v[40:43], v16 offset:1024
  s_branch L_ed9
L_ey8:
  s_waitcnt lgkmcnt(0)
  ds_read_b128 v[24:27], v16 offset:0
  ds_read_b128 v[28:31], v17 offset:0
  ds_read_b128 v[32:35], v18 offset:0
  ds_read_b128 v[36:39], v19 offset:0
  ds_read_b128 v[40:43], v16 offset:1024
  s_waitcnt vmcnt(8)
  s_barrier
L_ed9:
  s_bitcmp1_b32 s3, 2
  s_cbranch_scc0 L_d11
  s_cmp_lt_u32 s69, s30
  s_cbranch_scc1 L_cp12
L_cq13:
  s_add_u32 m0, s97, 0
  s_bitcmp1_b32 6, s95
  s_cbranch_scc0 L_w10
  s_add_u32 s94, s94, s96
  buffer_load_dwordx4 v0, s[84:87], s94 offen nt lds
L_d11:
  s_waitcnt lgkmcnt(3)
  v_mfma_f32_16x16x32_bf16 v[112:115], v[24:27], v[64:67], v[12:15]
  s_xor_b32 s5, s5, s67
  v_mfma_f32_16x16x32_bf16 v[120:123], v[24:27], v[80:83], v[56:59]
  s_add_u32 s66, s66, 1
  s_cmp_ge_u32 s66, 6
  s_cbranch_scc1 L_wo20
L_wb21:
  v_mfma_f32_16x16x32_bf16 v[128:131], v[24:27], v[96:99], v[60:63]
  s_xor_b32 s98, s98, s100
  ds_read_b128 v[24:27], v17 offset:1024
  v_mfma_f32_16x16x32_bf16 v[112:115], v[28:31], v[68:71], v[112:115]
  v_mov_b32 v8, 0x3f803f80
  v_mfma_f32_16x16x32_bf16 v[120:123], v[28:31], v[84:87], v[120:123]
  v_mov_b32 v9, 0x3f803f80
  v_mfma_f32_16x16x32_bf16 v[128:131], v[28:31], v[100:103], v[128:131]
  v_mov_b32 v10, 0x3f803f80
  ds_read_b128 v[28:31], v18 offset:1024
  s_waitcnt lgkmcnt(3)
  v_mfma_f32_16x16x32_bf16 v[112:115], v[32:35], v[72:75], v[112:115]
  v_mov_b32 v11, 0x3f803f80
  v_mfma_f32_16x16x32_bf16 v[120:123], v[32:35], v[88:91], v[120:123]
  v_mfma_f32_16x16x32_bf16 v[128:131], v[32:35], v[104:107], v[128:131]
  ds_read_b128 v[32:35], v19 offset:1024
  v_mfma_f32_16x16x32_bf16 v[112:115], v[36:39], v[76:79], v[112:115]
  v_mfma_f32_16x16x32_bf16 v[120:123], v[36:39], v[92:95], v[120:123]
  v_mfma_f32_16x16x32_bf16 v[128:131], v[36:39], v[108:111], v[128:131]
  ds_read_b128 v[36:39], v16 offset:8192
  s_bitcmp1_b32 s3, 2
  s_cbranch_scc0 L_d15
  s_add_u32 m0, s97, 8192
  s_bitcmp1_b32 6, s95
  s_cbranch_scc0 L_w14
  s_add_u32 s94, s94, s96
  buffer_load_dwordx4 v0, s[84:87], s94 offen nt lds
L_d15:
  s_waitcnt lgkmcnt(3)
  v_mfma_f32_16x16x32_bf16 v[116:119], v[40:43], v[64:67], v[12:15]
  v_mfma_f32_16x16x32_bf16 v[124:127], v[40:43], v[80:83], v[56:59]
  v_mfma_f32_16x16x32_bf16 v[132:135], v[40:43], v[96:99], v[60:63]
  ds_read_b128 v[40:43], v17 offset:8192
  v_mfma_f32_16x16x32_bf16 v[116:119], v[24:27], v[68:71], v[116:119]
  v_mfma_f32_16x16x32_bf16 v[124:127], v[24:27], v[84:87], v[124:127]
  v_mfma_f32_16x16x32_bf16 v[132:135], v[24:27], v[100:103], v[132:135]
  ds_read_b128 v[24:27], v18 offset:8192
  s_waitcnt lgkmcnt(3)
  v_mfma_f32_16x16x32_bf16 v[116:119], v[28:31], v[72:75], v[116:119]
  v_mfma_f32_16x16x32_bf16 v[124:127], v[28:31], v[88:91], v[124:127]
  v_mfma_f32_16x16x32_bf16 v[132:135], v[28:31], v[104:107], v[132:135]
  ds_read_b128 v[28:31], v19 offset:8192
  v_mfma_f32_16x16x32_bf16 v[116:119], v[32:35], v[76:79], v[116:119]
  v_mfma_f32_16x16x32_bf16 v[124:127], v[32:35], v[92:95], v[124:127]
  v_mfma_f32_16x16x32_bf16 v[132:135], v[32:35], v[108:111], v[132:135]
  ds_read_b128 v[32:35], v16 offset:9216
  s_setprio 1
  s_bitcmp1_b32 s3, 2
  s_cbranch_scc0 L_d17
  s_add_u32 m0, s97, 16384
  s_bitcmp1_b32 6, s95
  s_cbranch_scc0 L_w16
  s_add_u32 s94, s94, s96
  buffer_load_dwordx4 v0, s[84:87], s94 offen nt lds
L_d17:
  s_waitcnt lgkmcnt(3)
  v_mfma_f32_16x16x32_bf16 v[136:139], v[36:39], v[64:67], v[12:15]
  v_mfma_f32_16x16x32_bf16 v[144:147], v[36:39], v[80:83], v[56:59]
  v_mfma_f32_16x16x32_bf16 v[152:155], v[36:39], v[96:99], v[60:63]
  ds_read_b128 v[36:39], v17 offset:9216
  v_mfma_f32_16x16x32_bf16 v[136:139], v[40:43], v[68:71], v[136:139]
  v_mfma_f32_16x16x32_bf16 v[144:147], v[40:43], v[84:87], v[144:147]
  v_mfma_f32_16x16x32_bf16 v[152:155], v[40:43], v[100:103], v[152:155]
  ds_read_b128 v[40:43], v18 offset:9216
  s_waitcnt lgkmcnt(3)
  v_mfma_f32_16x16x32_bf16 v[136:139], v[24:27], v[72:75], v[136:139]
  s_branch L_r0first
L_n0f:
  v_exp_f32 v112, v112
  v_exp_f32 v113, v113
  v_mfma_f32_16x16x32_bf16 v[144:147], v[24:27], v[88:91], v[144:147]
  v_exp_f32 v114, v114
  v_exp_f32 v115, v115
  v_cvt_pk_bf16_f32 v112, v112, v113
  v_mfma_f32_16x16x32_bf16 v[152:155], v[24:27], v[104:107], v[152:155]
  v_exp_f32 v116, v116
  v_exp_f32 v117, v117
  v_cvt_pk_bf16_f32 v113, v114, v115
  ds_read_b128 v[24:27], v19 offset:9216
  v_mfma_f32_16x16x32_bf16 v[136:139], v[28:31], v[76:79], v[136:139]
  v_exp_f32 v118, v118
  v_exp_f32 v119, v119
  v_cvt_pk_bf16_f32 v114, v116, v117
  v_mfma_f32_16x16x32_bf16 v[144:147], v[28:31], v[92:95], v[144:147]
  v_exp_f32 v120, v120
  v_cvt_pk_bf16_f32 v115, v118, v119
  v_exp_f32 v121, v121
  v_exp_f32 v122, v122
  v_mfma_f32_16x16x32_bf16 v[152:155], v[28:31], v[108:111], v[152:155]
  v_exp_f32 v123, v123
  v_cvt_pk_bf16_f32 v120, v120, v121
  v_exp_f32 v124, v124
  s_bitcmp1_b32 s3, 2
  s_cbranch_scc0 L_d19
  s_add_u32 m0, s97, 24576
  s_bitcmp1_b32 6, s95
  s_cbranch_scc0 L_w18
  s_add_u32 s94, s94, s96
  buffer_load_dwordx4 v0, s[84:87], s94 offen nt lds
L_d19:
  s_waitcnt lgkmcnt(2)
  v_mfma_f32_16x16x32_bf16 v[140:143], v[32:35], v[64:67], v[12:15]
  v_exp_f32 v125, v125
  v_cvt_pk_bf16_f32 v121, v122, v123
  v_exp_f32 v126, v126
  v_mfma_f32_16x16x32_bf16 v[148:151], v[32:35], v[80:83], v[56:59]
  v_exp_f32 v127, v127
  v_cvt_pk_bf16_f32 v122, v124, v125
  v_exp_f32 v128, v128
  v_cvt_pk_bf16_f32 v123, v126, v127
  v_mfma_f32_16x16x32_bf16 v[156:159], v[32:35], v[96:99], v[60:63]
  v_exp_f32 v129, v129
  v_exp_f32 v130, v130
  v_exp_f32 v131, v131
  v_mfma_f32_16x16x32_bf16 v[140:143], v[36:39], v[68:71], v[140:143]
  v_cvt_pk_bf16_f32 v128, v128, v129
  v_exp_f32 v132, v132
  v_exp_f32 v133, v133
  v_mfma_f32_16x16x32_bf16 v[148:151], v[36:39], v[84:87], v[148:151]
  v_cvt_pk_bf16_f32 v129, v130, v131
  v_exp_f32 v134, v134
  v_exp_f32 v135, v135
  v_mfma_f32_16x16x32_bf16 v[156:159], v[36:39], v[100:103], v[156:159]
  v_cvt_pk_bf16_f32 v130, v132, v133
  s_nop 0
  v_cvt_pk_bf16_f32 v131, v134, v135
  s_waitcnt lgkmcnt(0)
  v_mfma_f32_16x16x32_bf16 v[140:143], v[40:43], v[72:75], v[140:143]
  v_mfma_f32_16x16x32_bf16 v[148:151], v[40:43], v[88:91], v[148:151]
  v_mfma_f32_16x16x32_bf16 v[156:159], v[40:43], v[104:107], v[156:159]
  v_mfma_f32_16x16x32_bf16 v[140:143], v[24:27], v[76:79], v[140:143]
  v_mfma_f32_16x16x32_bf16 v[148:151], v[24:27], v[92:95], v[148:151]
  v_mfma_f32_16x16x32_bf16 v[156:159], v[24:27], v[108:111], v[156:159]
  s_cmp_eq_u32 s79, 0
  v_add_u32 v16, s99, v7
  s_nop 5
  s_cbranch_scc0 L_r0bf
L_n0bf:
  v_max3_f32 v20, v136, v137, v138
  v_max3_f32 v20, v20, v139, v140
  v_max3_f32 v20, v20, v141, v142
  v_max3_f32 v20, v20, v143, v144
  v_max3_f32 v20, v20, v145, v146
  v_max3_f32 v20, v20, v147, v148
  v_max3_f32 v20, v20, v149, v150
  v_max3_f32 v20, v20, v151, v152
  v_max3_f32 v20, v20, v153, v154
  v_max3_f32 v20, v20, v155, v156
  v_max3_f32 v20, v20, v157, v158
  v_max_f32 v20, v20, v159
  v_cmp_lt_f32 vcc, s64, v20
  s_cbranch_vccnz L_r1f
L_n1f:
  s_bitcmp1_b32 s3, 2
  s_cbranch_scc1 L_ey22
  s_waitcnt vmcnt(4) lgkmcnt(0)
  s_barrier
  ds_read_b64_tr_b16 v[24:25], v16 offset:0
  ds_read_b64_tr_b16 v[26:27], v16 offset:1024
  v_xor_b32 v116, 32, v16
  ds_read_b64_tr_b16 v[28:29], v116 offset:0
  ds_read_b64_tr_b16 v[30:31], v116 offset:1024
  v_xor_b32 v117, 64, v16
  ds_read_b64_tr_b16 v[32:33], v117 offset:0
  ds_read_b64_tr_b16 v[34:35], v117 offset:1024
  v_xor_b32 v118, 96, v16
  ds_read_b64_tr_b16 v[36:37], v118 offset:0
  ds_read_b64_tr_b16 v[38:39], v118 offset:1024
  v_xor_b32 v119, 128, v16
  ds_read_b64_tr_b16 v[40:41], v119 offset:0
  ds_read_b64_tr_b16 v[42:43], v119 offset:1024
  s_branch L_ed23
L_ey22:
  s_waitcnt lgkmcnt(0)
  ds_read_b64_tr_b16 v[24:25], v16 offset:0
  ds_read_b64_tr_b16 v[26:27], v16 offset:1024
  v_xor_b32 v116, 32, v16
  ds_read_b64_tr_b16 v[28:29], v116 offset:0
  ds_read_b64_tr_b16 v[30:31], v116 offset:1024
  v_xor_b32 v117, 64, v16
  ds_read_b64_tr_b16 v[32:33], v117 offset:0
  ds_read_b64_tr_b16 v[34:35], v117 offset:1024
  v_xor_b32 v118, 96, v16
  ds_read_b64_tr_b16 v[36:37], v118 offset:0
  ds_read_b64_tr_b16 v[38:39], v118 offset:1024
  v_xor_b32 v119, 128, v16
  ds_read_b64_tr_b16 v[40:41], v119 offset:0
  ds_read_b64_tr_b16 v[42:43], v119 offset:1024
  s_waitcnt vmcnt(4)
  s_barrier
L_ed23:
  s_cmp_lt_u32 s69, s30
  s_cbranch_scc1 L_cp26
L_cq27:
  s_add_u32 m0, s5, 0
  s_bitcmp1_b32 6, s73
  s_cbranch_scc0 L_w24
  s_add_u32 s72, s72, s74
  buffer_load_dwordx4 v4, s[80:83], s72 offen nt lds
L_d25:
  v_mfma_f32_16x16x32_bf16 v[44:47], v[8:11], v[112:115], 0
  v_exp_f32 v136, v136
  v_exp_f32 v137, v137
  v_mfma_f32_16x16x32_bf16 v[48:51], v[8:11], v[120:123], 0
  v_exp_f32 v138, v138
  v_exp_f32 v139, v139
  v_mfma_f32_16x16x32_bf16 v[52:55], v[8:11], v[128:131], 0
  v_cvt_pk_bf16_f32 v136, v136, v137
  v_exp_f32 v140, v140
  s_waitcnt lgkmcnt(6)
  v_mfma_f32_16x16x32_bf16 v[160:163], v[24:27], v[112:115], 0
  v_exp_f32 v141, v141
  v_cvt_pk_bf16_f32 v137, v138, v139
  v_mfma_f32_16x16x32_bf16 v[164:167], v[24:27], v[120:123], 0
  v_exp_f32 v142, v142
  v_exp_f32 v143, v143
  v_mfma_f32_16x16x32_bf16 v[168:171], v[24:27], v[128:131], 0
  v_cvt_pk_bf16_f32 v138, v140, v141
  v_exp_f32 v144, v144
  v_cvt_pk_bf16_f32 v139, v142, v143
  v_xor_b32 v124, 160, v16
  ds_read_b64_tr_b16 v[24:25], v124 offset:0
  ds_read_b64_tr_b16 v[26:27], v124 offset:1024
  v_mfma_f32_16x16x32_bf16 v[172:175], v[28:31], v[112:115], 0
  v_exp_f32 v145, v145
  v_exp_f32 v146, v146
  v_mfma_f32_16x16x32_bf16 v[176:179], v[28:31], v[120:123], 0
  v_exp_f32 v147, v147
  v_cvt_pk_bf16_f32 v144, v144, v145
  v_mfma_f32_16x16x32_bf16 v[180:183], v[28:31], v[128:131], 0
  v_exp_f32 v148, v148
  v_exp_f32 v149, v149
  v_xor_b32 v125, 192, v16
  ds_read_b64_tr_b16 v[28:29], v125 offset:0
  ds_read_b64_tr_b16 v[30:31], v125 offset:1024
  s_add_u32 m0, s5, 8192
  s_bitcmp1_b32 6, s73
  s_cbranch_scc0 L_w28
  s_add_u32 s72, s72, s74
  buffer_load_dwordx4 v4, s[80:83], s72 offen nt lds
L_d29:
  s_waitcnt lgkmcnt(6)
  v_mfma_f32_16x16x32_bf16 v[184:187], v[32:35], v[112:115], 0
  v_cvt_pk_bf16_f32 v145, v146, v147
  v_exp_f32 v150, v150
  v_mfma_f32_16x16x32_bf16 v[188:191], v[32:35], v[120:123], 0
  v_exp_f32 v151, v151
  v_cvt_pk_bf16_f32 v146, v148, v149
  v_mfma_f32_16x16x32_bf16 v[192:195], v[32:35], v[128:131], 0
  v_exp_f32 v152, v152
  v_cvt_pk_bf16_f32 v147, v150, v151
  v_exp_f32 v153, v153
  v_xor_b32 v126, 224, v16
  ds_read_b64_tr_b16 v[32:33], v126 offset:0
  ds_read_b64_tr_b16 v[34:35], v126 offset:1024
  v_mfma_f32_16x16x32_bf16 v[196:199], v[36:39], v[112:115], 0
  v_exp_f32 v154, v154
  v_exp_f32 v155, v155
  v_mfma_f32_16x16x32_bf16 v[200:203], v[36:39], v[120:123], 0
  v_cvt_pk_bf16_f32 v152, v152, v153
  v_exp_f32 v156, v156
  v_mfma_f32_16x16x32_bf16 v[204:207], v[36:39], v[128:131], 0
  v_exp_f32 v157, v157
  v_cvt_pk_bf16_f32 v153, v154, v155
  ds_read_b64_tr_b16 v[36:37], v16 offset:8192
  ds_read_b64_tr_b16 v[38:39], v16 offset:9216
  s_add_u32 m0, s5, 16384
  s_bitcmp1_b32 6, s73
  s_cbranch_scc0 L_w30
  s_add_u32 s72, s72, s74
  buffer_load_dwordx4 v4, s[80:83], s72 offen nt lds
L_d31:
  s_waitcnt lgkmcnt(6)
  v_mfma_f32_16x16x32_bf16 v[208:211], v[40:43], v[112:115], 0
  v_exp_f32 v158, v158
  v_exp_f32 v159, v159
  v_mfma_f32_16x16x32_bf16 v[212:215], v[40:43], v[120:123], 0
  v_cvt_pk_bf16_f32 v154, v156, v157
  s_nop 0
  v_cvt_pk_bf16_f32 v155, v158, v159
  v_mfma_f32_16x16x32_bf16 v[216:219], v[40:43], v[128:131], 0
  ds_read_b64_tr_b16 v[40:41], v116 offset:8192
  ds_read_b64_tr_b16 v[42:43], v116 offset:9216
  v_mfma_f32_16x16x32_bf16 v[220:223], v[24:27], v[112:115], 0
  v_mfma_f32_16x16x32_bf16 v[224:227], v[24:27], v[120:123], 0
  v_mfma_f32_16x16x32_bf16 v[228:231], v[24:27], v[128:131], 0
  ds_read_b64_tr_b16 v[24:25], v117 offset:8192
  ds_read_b64_tr_b16 v[26:27], v117 offset:9216
  s_add_u32 m0, s5, 24576
  s_bitcmp1_b32 6, s73
  s_cbranch_scc0 L_w32
  s_add_u32 s72, s72, s74
  buffer_load_dwordx4 v4, s[80:83], s72 offen nt lds
L_d33:
  s_waitcnt lgkmcnt(6)
  v_mfma_f32_16x16x32_bf16 v[232:235], v[28:31], v[112:115], 0
  v_mfma_f32_16x16x32_bf16 v[236:239], v[28:31], v[120:123], 0
  v_mfma_f32_16x16x32_bf16 v[240:243], v[28:31], v[128:131], 0
  ds_read_b64_tr_b16 v[28:29], v118 offset:8192
  ds_read_b64_tr_b16 v[30:31], v118 offset:9216
  v_mfma_f32_16x16x32_bf16 v[244:247], v[32:35], v[112:115], 0
  v_mfma_f32_16x16x32_bf16 v[248:251], v[32:35], v[120:123], 0
  v_mfma_f32_16x16x32_bf16 v[252:255], v[32:35], v[128:131], 0
  ds_read_b64_tr_b16 v[32:33], v119 offset:8192
  ds_read_b64_tr_b16 v[34:35], v119 offset:9216
  s_setprio 0
  s_nop 1
  v_mfma_f32_16x16x32_bf16 v[44:47], v[8:11], v[136:139], v[44:47]
  s_xor_b32 s97, s97, s68
  v_mfma_f32_16x16x32_bf16 v[48:51], v[8:11], v[144:147], v[48:51]
  s_add_u32 s66, s66, 1
  s_cmp_ge_u32 s66, 6
  s_cbranch_scc1 L_wo34
L_wb35:
  v_mfma_f32_16x16x32_bf16 v[52:55], v[8:11], v[152:155], v[52:55]
  s_xor_b32 s99, s99, s101
  s_waitcnt lgkmcnt(6)
  v_mfma_f32_16x16x32_bf16 v[160:163], v[36:39], v[136:139], v[160:163]
  v_mfma_f32_16x16x32_bf16 v[164:167], v[36:39], v[144:147], v[164:167]
  v_mfma_f32_16x16x32_bf16 v[168:171], v[36:39], v[152:155], v[168:171]
  ds_read_b64_tr_b16 v[36:37], v124 offset:8192
  ds_read_b64_tr_b16 v[38:39], v124 offset:9216
  v_mfma_f32_16x16x32_bf16 v[172:175], v[40:43], v[136:139], v[172:175]
  v_mfma_f32_16x16x32_bf16 v[176:179], v[40:43], v[144:147], v[176:179]
  v_mfma_f32_16x16x32_bf16 v[180:183], v[40:43], v[152:155], v[180:183]
  ds_read_b64_tr_b16 v[40:41], v125 offset:8192
  ds_read_b64_tr_b16 v[42:43], v125 offset:9216
  s_waitcnt lgkmcnt(6)
  v_mfma_f32_16x16x32_bf16 v[184:187], v[24:27], v[136:139], v[184:187]
  v_mfma_f32_16x16x32_bf16 v[188:191], v[24:27], v[144:147], v[188:191]
  v_mfma_f32_16x16x32_bf16 v[192:195], v[24:27], v[152:155], v[192:195]
  ds_read_b64_tr_b16 v[24:25], v126 offset:8192
  ds_read_b64_tr_b16 v[26:27], v126 offset:9216
  v_mfma_f32_16x16x32_bf16 v[196:199], v[28:31], v[136:139], v[196:199]
  v_add_u32 v16, s98, v5
  v_mfma_f32_16x16x32_bf16 v[200:203], v[28:31], v[144:147], v[200:203]
  v_xor_b32 v17, 64, v16
  v_mfma_f32_16x16x32_bf16 v[204:207], v[28:31], v[152:155], v[204:207]
  v_xor_b32 v18, 128, v16
  s_waitcnt lgkmcnt(4)
  v_mfma_f32_16x16x32_bf16 v[208:211], v[32:35], v[136:139], v[208:211]
  v_xor_b32 v19, 192, v16
  v_mfma_f32_16x16x32_bf16 v[212:215], v[32:35], v[144:147], v[212:215]
  v_mfma_f32_16x16x32_bf16 v[216:219], v[32:35], v[152:155], v[216:219]
  v_mfma_f32_16x16x32_bf16 v[220:223], v[36:39], v[136:139], v[220:223]
  v_mfma_f32_16x16x32_bf16 v[224:227], v[36:39], v[144:147], v[224:227]
  v_mfma_f32_16x16x32_bf16 v[228:231], v[36:39], v[152:155], v[228:231]
  s_waitcnt lgkmcnt(0)
  v_mfma_f32_16x16x32_bf16 v[232:235], v[40:43], v[136:139], v[232:235]
  v_mfma_f32_16x16x32_bf16 v[236:239], v[40:43], v[144:147], v[236:239]
  v_mfma_f32_16x16x32_bf16 v[240:243], v[40:43], v[152:155], v[240:243]
  v_mfma_f32_16x16x32_bf16 v[244:247], v[24:27], v[136:139], v[244:247]
  v_mfma_f32_16x16x32_bf16 v[248:251], v[24:27], v[144:147], v[248:251]
  v_mfma_f32_16x16x32_bf16 v[252:255], v[24:27], v[152:155], v[252:255]
L_attA:
  s_sub_u32 s65, s65, 1
  s_bitcmp1_b32 s3, 2
  s_cbranch_scc1 L_ey36
  s_waitcnt vmcnt(4) lgkmcnt(0)
  s_barrier
  ds_read_b128 v[24:27], v16 offset:0
  ds_read_b128 v[28:31], v17 offset:0
  ds_read_b128 v[32:35], v18 offset:0
  ds_read_b128 v[36:39], v19 offset:0
  ds_read_b128 v[40:43], v16 offset:1024
  s_branch L_ed37
L_ey36:
  s_waitcnt lgkmcnt(0)
  ds_read_b128 v[24:27], v16 offset:0
  ds_read_b128 v[28:31], v17 offset:0
  ds_read_b128 v[32:35], v18 offset:0
  ds_read_b128 v[36:39], v19 offset:0
  ds_read_b128 v[40:43], v16 offset:1024
  s_waitcnt vmcnt(4)
  s_barrier
L_ed37:
  s_cmp_lt_u32 s69, s30
  s_cbranch_scc1 L_cp40
L_cq41:
  s_add_u32 m0, s97, 0
  s_bitcmp1_b32 6, s95
  s_cbranch_scc0 L_w38
  s_add_u32 s94, s94, s96
  buffer_load_dwordx4 v0, s[84:87], s94 offen nt lds
L_d39:
  s_waitcnt lgkmcnt(3)
  v_mfma_f32_16x16x32_bf16 v[112:115], v[24:27], v[64:67], v[12:15]
  s_xor_b32 s5, s5, s67
  v_mfma_f32_16x16x32_bf16 v[120:123], v[24:27], v[80:83], v[56:59]
  s_add_u32 s66, s66, 1
  s_cmp_ge_u32 s66, 6
  s_cbranch_scc1 L_wo48
L_wb49:
  v_mfma_f32_16x16x32_bf16 v[128:131], v[24:27], v[96:99], v[60:63]
  s_xor_b32 s98, s98, s100
  ds_read_b128 v[24:27], v17 offset:1024
  v_mfma_f32_16x16x32_bf16 v[112:115], v[28:31], v[68:71], v[112:115]
  v_mfma_f32_16x16x32_bf16 v[120:123], v[28:31], v[84:87], v[120:123]
  v_mfma_f32_16x16x32_bf16 v[128:131], v[28:31], v[100:103], v[128:131]
  ds_read_b128 v[28:31], v18 offset:1024
  s_waitcnt lgkmcnt(3)
  v_mfma_f32_16x16x32_bf16 v[112:115], v[32:35], v[72:75], v[112:115]
  v_mfma_f32_16x16x32_bf16 v[120:123], v[32:35], v[88:91], v[120:123]
  v_mfma_f32_16x16x32_bf16 v[128:131], v[32:35], v[104:107], v[128:131]
  ds_read_b128 v[32:35], v19 offset:1024
  v_mfma_f32_16x16x32_bf16 v[112:115], v[36:39], v[76:79], v[112:115]
  v_mfma_f32_16x16x32_bf16 v[120:123], v[36:39], v[92:95], v[120:123]
  v_mfma_f32_16x16x32_bf16 v[128:131], v[36:39], v[108:111], v[128:131]
  ds_read_b128 v[36:39], v16 offset:8192
  s_add_u32 m0, s97, 8192
  s_bitcmp1_b32 6, s95
  s_cbranch_scc0 L_w42
  s_add_u32 s94, s94, s96
  buffer_load_dwordx4 v0, s[84:87], s94 offen nt lds
L_d43:
  s_waitcnt lgkmcnt(3)
  v_mfma_f32_16x16x32_bf16 v[116:119], v[40:43], v[64:67], v[12:15]
  v_mfma_f32_16x16x32_bf16 v[124:127], v[40:43], v[80:83], v[56:59]
  v_mfma_f32_16x16x32_bf16 v[132:135], v[40:43], v[96:99], v[60:63]
  ds_read_b128 v[40:43], v17 offset:8192
  v_mfma_f32_16x16x32_bf16 v[116:119], v[24:27], v[68:71], v[116:119]
  v_mfma_f32_16x16x32_bf16 v[124:127], v[24:27], v[84:87], v[124:127]
  v_mfma_f32_16x16x32_bf16 v[132:135], v[24:27], v[100:103], v[132:135]
  ds_read_b128 v[24:27], v18 offset:8192
  s_waitcnt lgkmcnt(3)
  v_mfma_f32_16x16x32_bf16 v[116:119], v[28:31], v[72:75], v[116:119]
  v_mfma_f32_16x16x32_bf16 v[124:127], v[28:31], v[88:91], v[124:127]
  v_mfma_f32_16x16x32_bf16 v[132:135], v[28:31], v[104:107], v[132:135]
  ds_read_b128 v[28:31], v19 offset:8192
  v_mfma_f32_16x16x32_bf16 v[116:119], v[32:35], v[76:79], v[116:119]
  v_mfma_f32_16x16x32_bf16 v[124:127], v[32:35], v[92:95], v[124:127]
  v_mfma_f32_16x16x32_bf16 v[132:135], v[32:35], v[108:111], v[132:135]
  ds_read_b128 v[32:35], v16 offset:9216
  s_setprio 1
  s_add_u32 m0, s97, 16384
  s_bitcmp1_b32 6, s95
  s_cbranch_scc0 L_w44
  s_add_u32 s94, s94, s96
  buffer_load_dwordx4 v0, s[84:87], s94 offen nt lds
L_d45:
  s_waitcnt lgkmcnt(3)
  v_mfma_f32_16x16x32_bf16 v[136:139], v[36:39], v[64:67], v[12:15]
  v_mfma_f32_16x16x32_bf16 v[144:147], v[36:39], v[80:83], v[56:59]
  v_mfma_f32_16x16x32_bf16 v[152:155], v[36:39], v[96:99], v[60:63]
  ds_read_b128 v[36:39], v17 offset:9216
  v_mfma_f32_16x16x32_bf16 v[136:139], v[40:43], v[68:71], v[136:139]
  v_mfma_f32_16x16x32_bf16 v[144:147], v[40:43], v[84:87], v[144:147]
  v_mfma_f32_16x16x32_bf16 v[152:155], v[40:43], v[100:103], v[152:155]
  ds_read_b128 v[40:43], v18 offset:9216
  s_waitcnt lgkmcnt(3)
  v_mfma_f32_16x16x32_bf16 v[136:139], v[24:27], v[72:75], v[136:139]
  v_max3_f32 v20, v112, v113, v114
  v_max3_f32 v20, v20, v115, v116
  v_max3_f32 v20, v20, v117, v118
  v_mfma_f32_16x16x32_bf16 v[144:147], v[24:27], v[88:91], v[144:147]
  v_max3_f32 v20, v20, v119, v120
  v_max3_f32 v20, v20, v121, v122
  v_max3_f32 v20, v20, v123, v124
  v_mfma_f32_16x16x32_bf16 v[152:155], v[24:27], v[104:107], v[152:155]
  v_max3_f32 v20, v20, v125, v126
  v_max3_f32 v20, v20, v127, v128
  v_max3_f32 v20, v20, v129, v130
  ds_read_b128 v[24:27], v19 offset:9216
  v_mfma_f32_16x16x32_bf16 v[136:139], v[28:31], v[76:79], v[136:139]
  v_max3_f32 v20, v20, v131, v132
  v_max3_f32 v20, v20, v133, v134
  v_max_f32 v20, v20, v135
  v_mfma_f32_16x16x32_bf16 v[144:147], v[28:31], v[92:95], v[144:147]
  v_cmp_lt_f32 vcc, s64, v20
  s_cbranch_vccnz L_r0
L_n0l:
  v_exp_f32 v112, v112
  v_exp_f32 v113, v113
  v_mfma_f32_16x16x32_bf16 v[152:155], v[28:31], v[108:111], v[152:155]
  v_exp_f32 v114, v114
  v_exp_f32 v115, v115
  v_cvt_pk_bf16_f32 v112, v112, v113
  s_add_u32 m0, s97, 24576
  s_bitcmp1_b32 6, s95
  s_cbranch_scc0 L_w46
  s_add_u32 s94, s94, s96
  buffer_load_dwordx4 v0, s[84:87], s94 offen nt lds
L_d47:
  s_waitcnt lgkmcnt(2)
  v_mfma_f32_16x16x32_bf16 v[140:143], v[32:35], v[64:67], v[12:15]
  v_exp_f32 v116, v116
  v_exp_f32 v117, v117
  v_cvt_pk_bf16_f32 v113, v114, v115
  v_mfma_f32_16x16x32_bf16 v[148:151], v[32:35], v[80:83], v[56:59]
  v_exp_f32 v118, v118
  v_exp_f32 v119, v119
  v_cvt_pk_bf16_f32 v114, v116, v117
  v_mfma_f32_16x16x32_bf16 v[156:159], v[32:35], v[96:99], v[60:63]
  v_exp_f32 v120, v120
  v_cvt_pk_bf16_f32 v115, v118, v119
  v_exp_f32 v121, v121
  v_exp_f32 v122, v122
  v_mfma_f32_16x16x32_bf16 v[140:143], v[36:39], v[68:71], v[140:143]
  v_exp_f32 v123, v123
  v_cvt_pk_bf16_f32 v120, v120, v121
  v_exp_f32 v124, v124
  v_mfma_f32_16x16x32_bf16 v[148:151], v[36:39], v[84:87], v[148:151]
  v_exp_f32 v125, v125
  v_cvt_pk_bf16_f32 v121, v122, v123
  v_exp_f32 v126, v126
  v_mfma_f32_16x16x32_bf16 v[156:159], v[36:39], v[100:103], v[156:159]
  v_exp_f32 v127, v127
  v_cvt_pk_bf16_f32 v122, v124, v125
  v_exp_f32 v128, v128
  v_cvt_pk_bf16_f32 v123, v126, v127
  s_waitcnt lgkmcnt(0)
  v_mfma_f32_16x16x32_bf16 v[140:143], v[40:43], v[72:75], v[140:143]
  v_exp_f32 v129, v129
  v_exp_f32 v130, v130
  v_exp_f32 v131, v131
  v_mfma_f32_16x16x32_bf16 v[148:151], v[40:43], v[88:91], v[148:151]
  v_cvt_pk_bf16_f32 v128, v128, v129
  v_exp_f32 v132, v132
  v_exp_f32 v133, v133
  v_mfma_f32_16x16x32_bf16 v[156:159], v[40:43], v[104:107], v[156:159]
  v_cvt_pk_bf16_f32 v129, v130, v131
  v_exp_f32 v134, v134
  v_exp_f32 v135, v135
  v_mfma_f32_16x16x32_bf16 v[140:143], v[24:27], v[76:79], v[140:143]
  v_cvt_pk_bf16_f32 v130, v132, v133
  s_nop 0
  v_cvt_pk_bf16_f32 v131, v134, v135
  v_mfma_f32_16x16x32_bf16 v[148:151], v[24:27], v[92:95], v[148:151]
  v_mfma_f32_16x16x32_bf16 v[156:159], v[24:27], v[108:111], v[156:159]
  s_cmp_eq_u32 s79, 0
  v_add_u32 v16, s99, v7
  s_nop 5
  s_cbranch_scc0 L_r0bl
L_n0bl:
  v_max3_f32 v20, v136, v137, v138
  v_max3_f32 v20, v20, v139, v140
  v_max3_f32 v20, v20, v141, v142
  v_max3_f32 v20, v20, v143, v144
  v_max3_f32 v20, v20, v145, v146
  v_max3_f32 v20, v20, v147, v148
  v_max3_f32 v20, v20, v149, v150
  v_max3_f32 v20, v20, v151, v152
  v_max3_f32 v20, v20, v153, v154
  v_max3_f32 v20, v20, v155, v156
  v_max3_f32 v20, v20, v157, v158
  v_max_f32 v20, v20, v159
  v_cmp_lt_f32 vcc, s64, v20
  s_cbranch_vccnz L_r1l
L_n1l:
  s_bitcmp1_b32 s3, 2
  s_cbranch_scc1 L_ey50
  s_waitcnt vmcnt(4) lgkmcnt(0)
  s_barrier
  ds_read_b64_tr_b16 v[24:25], v16 offset:0
  ds_read_b64_tr_b16 v[26:27], v16 offset:1024
  v_xor_b32 v116, 32, v16
  ds_read_b64_tr_b16 v[28:29], v116 offset:0
  ds_read_b64_tr_b16 v[30:31], v116 offset:1024
  v_xor_b32 v117, 64, v16
  ds_read_b64_tr_b16 v[32:33], v117 offset:0
  ds_read_b64_tr_b16 v[34:35], v117 offset:1024
  v_xor_b32 v118, 96, v16
  ds_read_b64_tr_b16 v[36:37], v118 offset:0
  ds_read_b64_tr_b16 v[38:39], v118 offset:1024
  v_xor_b32 v119, 128, v16
  ds_read_b64_tr_b16 v[40:41], v119 offset:0
  ds_read_b64_tr_b16 v[42:43], v119 offset:1024
  s_branch L_ed51
L_ey50:
  s_waitcnt lgkmcnt(0)
  ds_read_b64_tr_b16 v[24:25], v16 offset:0
  ds_read_b64_tr_b16 v[26:27], v16 offset:1024
  v_xor_b32 v116, 32, v16
  ds_read_b64_tr_b16 v[28:29], v116 offset:0
  ds_read_b64_tr_b16 v[30:31], v116 offset:1024
  v_xor_b32 v117, 64, v16
  ds_read_b64_tr_b16 v[32:33], v117 offset:0
  ds_read_b64_tr_b16 v[34:35], v117 offset:1024
  v_xor_b32 v118, 96, v16
  ds_read_b64_tr_b16 v[36:37], v118 offset:0
  ds_read_b64_tr_b16 v[38:39], v118 offset:1024
  v_xor_b32 v119, 128, v16
  ds_read_b64_tr_b16 v[40:41], v119 offset:0
  ds_read_b64_tr_b16 v[42:43], v119 offset:1024
  s_waitcnt vmcnt(4)
  s_barrier
L_ed51:
  s_cmp_lt_u32 s69, s30
  s_cbranch_scc1 L_cp54
L_cq55:
  s_add_u32 m0, s5, 0
  s_bitcmp1_b32 6, s73
  s_cbranch_scc0 L_w52
  s_add_u32 s72, s72, s74
  buffer_load_dwordx4 v4, s[80:83], s72 offen nt lds
L_d53:
  v_mfma_f32_16x16x32_bf16 v[44:47], v[8:11], v[112:115], v[44:47]
  v_exp_f32 v136, v136
  v_exp_f32 v137, v137
  v_mfma_f32_16x16x32_bf16 v[48:51], v[8:11], v[120:123], v[48:51]
  v_exp_f32 v138, v138
  v_exp_f32 v139, v139
  v_mfma_f32_16x16x32_bf16 v[52:55], v[8:11], v[128:131], v[52:55]
  v_cvt_pk_bf16_f32 v136, v136, v137
  v_exp_f32 v140, v140
  s_waitcnt lgkmcnt(6)
  v_mfma_f32_16x16x32_bf16 v[160:163], v[24:27], v[112:115], v[160:163]
  v_exp_f32 v141, v141
  v_cvt_pk_bf16_f32 v137, v138, v139
  v_mfma_f32_16x16x32_bf16 v[164:167], v[24:27], v[120:123], v[164:167]
  v_exp_f32 v142, v142
  v_exp_f32 v143, v143
  v_mfma_f32_16x16x32_bf16 v[168:171], v[24:27], v[128:131], v[168:171]
  v_cvt_pk_bf16_f32 v138, v140, v141
  v_exp_f32 v144, v144
  v_cvt_pk_bf16_f32 v139, v142, v143
  v_xor_b32 v124, 160, v16
  ds_read_b64_tr_b16 v[24:25], v124 offset:0
  ds_read_b64_tr_b16 v[26:27], v124 offset:1024
  v_mfma_f32_16x16x32_bf16 v[172:175], v[28:31], v[112:115], v[172:175]
  v_exp_f32 v145, v145
  v_exp_f32 v146, v146
  v_mfma_f32_16x16x32_bf16 v[176:179], v[28:31], v[120:123], v[176:179]
  v_exp_f32 v147, v147
  v_cvt_pk_bf16_f32 v144, v144, v145
  v_mfma_f32_16x16x32_bf16 v[180:183], v[28:31], v[128:131], v[180:183]
  v_exp_f32 v148, v148
  v_exp_f32 v149, v149
  v_xor_b32 v125, 192, v16
  ds_read_b64_tr_b16 v[28:29], v125 offset:0
  ds_read_b64_tr_b16 v[30:31], v125 offset:1024
  s_add_u32 m0, s5, 8192
  s_bitcmp1_b32 6, s73
  s_cbranch_scc0 L_w56
  s_add_u32 s72, s72, s74
  buffer_load_dwordx4 v4, s[80:83], s72 offen nt lds
L_d57:
  s_waitcnt lgkmcnt(6)
  v_mfma_f32_16x16x32_bf16 v[184:187], v[32:35], v[112:115], v[184:187]
  v_cvt_pk_bf16_f32 v145, v146, v147
  v_exp_f32 v150, v150
  v_mfma_f32_16x16x32_bf16 v[188:191], v[32:35], v[120:123], v[188:191]
  v_exp_f32 v151, v151
  v_cvt_pk_bf16_f32 v146, v148, v149
  v_mfma_f32_16x16x32_bf16 v[192:195], v[32:35], v[128:131], v[192:195]
  v_exp_f32 v152, v152
  v_cvt_pk_bf16_f32 v147, v150, v151
  v_exp_f32 v153, v153
  v_xor_b32 v126, 224, v16
  ds_read_b64_tr_b16 v[32:33], v126 offset:0
  ds_read_b64_tr_b16 v[34:35], v126 offset:1024
  v_mfma_f32_16x16x32_bf16 v[196:199], v[36:39], v[112:115], v[196:199]
  v_exp_f32 v154, v154
  v_exp_f32 v155, v155
  v_mfma_f32_16x16x32_bf16 v[200:203], v[36:39], v[120:123], v[200:203]
  v_cvt_pk_bf16_f32 v152, v152, v153
  v_exp_f32 v156, v156
  v_mfma_f32_16x16x32_bf16 v[204:207], v[36:39], v[128:131], v[204:207]
  v_exp_f32 v157, v157
  v_cvt_pk_bf16_f32 v153, v154, v155
  ds_read_b64_tr_b16 v[36:37], v16 offset:8192
  ds_read_b64_tr_b16 v[38:39], v16 offset:9216
  s_add_u32 m0, s5, 16384
  s_bitcmp1_b32 6, s73
  s_cbranch_scc0 L_w58
  s_add_u32 s72, s72, s74
  buffer_load_dwordx4 v4, s[80:83], s72 offen nt lds
L_d59:
  s_waitcnt lgkmcnt(6)
  v_mfma_f32_16x16x32_bf16 v[208:211], v[40:43], v[112:115], v[208:211]
  v_exp_f32 v158, v158
  v_exp_f32 v159, v159
  v_mfma_f32_16x16x32_bf16 v[212:215], v[40:43], v[120:123], v[212:215]
  v_cvt_pk_bf16_f32 v154, v156, v157
  s_nop 0
  v_cvt_pk_bf16_f32 v155, v158, v159
  v_mfma_f32_16x16x32_bf16 v[216:219], v[40:43], v[128:131], v[216:219]
  ds_read_b64_tr_b16 v[40:41], v116 offset:8192
  ds_read_b64_tr_b16 v[42:43], v116 offset:9216
  v_mfma_f32_16x16x32_bf16 v[220:223], v[24:27], v[112:115], v[220:223]
  v_mfma_f32_16x16x32_bf16 v[224:227], v[24:27], v[120:123], v[224:227]
  v_mfma_f32_16x16x32_bf16 v[228:231], v[24:27], v[128:131], v[228:231]
  ds_read_b64_tr_b16 v[24:25], v117 offset:8192
  ds_read_b64_tr_b16 v[26:27], v117 offset:9216
  s_add_u32 m0, s5, 24576
  s_bitcmp1_b32 6, s73
  s_cbranch_scc0 L_w60
  s_add_u32 s72, s72, s74
  buffer_load_dwordx4 v4, s[80:83], s72 offen nt lds
L_d61:
  s_waitcnt lgkmcnt(6)
  v_mfma_f32_16x16x32_bf16 v[232:235], v[28:31], v[112:115], v[232:235]
  v_mfma_f32_16x16x32_bf16 v[236:239], v[28:31], v[120:123], v[236:239]
  v_mfma_f32_16x16x32_bf16 v[240:243], v[28:31], v[128:131], v[240:243]
  ds_read_b64_tr_b16 v[28:29], v118 offset:8192
  ds_read_b64_tr_b16 v[30:31], v118 offset:9216
  v_mfma_f32_16x16x32_bf16 v[244:247], v[32:35], v[112:115], v[244:247]
  v_mfma_f32_16x16x32_bf16 v[248:251], v[32:35], v[120:123], v[248:251]
  v_mfma_f32_16x16x32_bf16 v[252:255], v[32:35], v[128:131], v[252:255]
  ds_read_b64_tr_b16 v[32:33], v119 offset:8192
  ds_read_b64_tr_b16 v[34:35], v119 offset:9216
  s_setprio 0
  s_cmp_eq_u32 s65, 1
  s_cbranch_scc1 L_attlast
  v_mfma_f32_16x16x32_bf16 v[44:47], v[8:11], v[136:139], v[44:47]
  s_xor_b32 s97, s97, s68
  v_mfma_f32_16x16x32_bf16 v[48:51], v[8:11], v[144:147], v[48:51]
  s_add_u32 s66, s66, 1
  s_cmp_ge_u32 s66, 6
  s_cbranch_scc1 L_wo62
L_wb63:
  v_mfma_f32_16x16x32_bf16 v[52:55], v[8:11], v[152:155], v[52:55]
  s_xor_b32 s99, s99, s101
  s_waitcnt lgkmcnt(6)
  v_mfma_f32_16x16x32_bf16 v[160:163], v[36:39], v[136:139], v[160:163]
  v_mfma_f32_16x16x32_bf16 v[164:167], v[36:39], v[144:147], v[164:167]
  v_mfma_f32_16x16x32_bf16 v[168:171], v[36:39], v[152:155], v[168:171]
  ds_read_b64_tr_b16 v[36:37], v124 offset:8192
  ds_read_b64_tr_b16 v[38:39], v124 offset:9216
  v_mfma_f32_16x16x32_bf16 v[172:175], v[40:43], v[136:139], v[172:175]
  v_mfma_f32_16x16x32_bf16 v[176:179], v[40:43], v[144:147], v[176:179]
  v_mfma_f32_16x16x32_bf16 v[180:183], v[40:43], v[152:155], v[180:183]
  ds_read_b64_tr_b16 v[40:41], v125 offset:8192
  ds_read_b64_tr_b16 v[42:43], v125 offset:9216
  s_waitcnt lgkmcnt(6)
  v_mfma_f32_16x16x32_bf16 v[184:187], v[24:27], v[136:139], v[184:187]
  v_mfma_f32_16x16x32_bf16 v[188:191], v[24:27], v[144:147], v[188:191]
  v_mfma_f32_16x16x32_bf16 v[192:195], v[24:27], v[152:155], v[192:195]
  ds_read_b64_tr_b16 v[24:25], v126 offset:8192
  ds_read_b64_tr_b16 v[26:27], v126 offset:9216
  v_mfma_f32_16x16x32_bf16 v[196:199], v[28:31], v[136:139], v[196:199]
  v_add_u32 v16, s98, v5
  v_mfma_f32_16x16x32_bf16 v[200:203], v[28:31], v[144:147], v[200:203]
  v_xor_b32 v17, 64, v16
  v_mfma_f32_16x16x32_bf16 v[204:207], v[28:31], v[152:155], v[204:207]
  v_xor_b32 v18, 128, v16
  s_waitcnt lgkmcnt(4)
  v_mfma_f32_16x16x32_bf16 v[208:211], v[32:35], v[136:139], v[208:211]
  v_xor_b32 v19, 192, v16
  v_mfma_f32_16x16x32_bf16 v[212:215], v[32:35], v[144:147], v[212:215]
  v_mfma_f32_16x16x32_bf16 v[216:219], v[32:35], v[152:155], v[216:219]
  v_mfma_f32_16x16x32_bf16 v[220:223], v[36:39], v[136:139], v[220:223]
  v_mfma_f32_16x16x32_bf16 v[224:227], v[36:39], v[144:147], v[224:227]
  v_mfma_f32_16x16x32_bf16 v[228:231], v[36:39], v[152:155], v[228:231]
  s_waitcnt lgkmcnt(0)
  v_mfma_f32_16x16x32_bf16 v[232:235], v[40:43], v[136:139], v[232:235]
  v_mfma_f32_16x16x32_bf16 v[236:239], v[40:43], v[144:147], v[236:239]
  v_mfma_f32_16x16x32_bf16 v[240:243], v[40:43], v[152:155], v[240:243]
  v_mfma_f32_16x16x32_bf16 v[244:247], v[24:27], v[136:139], v[244:247]
  v_mfma_f32_16x16x32_bf16 v[248:251], v[24:27], v[144:147], v[248:251]
  v_mfma_f32_16x16x32_bf16 v[252:255], v[24:27], v[152:155], v[252:255]
  s_branch L_attA
L_attlast:
  v_mfma_f32_16x16x32_bf16 v[44:47], v[8:11], v[136:139], v[44:47]
  s_xor_b32 s97, s97, s68
  v_mfma_f32_16x16x32_bf16 v[48:51], v[8:11], v[144:147], v[48:51]
  s_add_u32 s66, s66, 1
  s_cmp_ge_u32 s66, 6
  s_cbranch_scc1 L_wo64
L_wb65:
  v_mfma_f32_16x16x32_bf16 v[52:55], v[8:11], v[152:155], v[52:55]
  s_waitcnt lgkmcnt(6)
  v_mfma_f32_16x16x32_bf16 v[160:163], v[36:39], v[136:139], v[160:163]
  v_mfma_f32_16x16x32_bf16 v[164:167], v[36:39], v[144:147], v[164:167]
  v_mfma_f32_16x16x32_bf16 v[168:171], v[36:39], v[152:155], v[168:171]
  ds_read_b64_tr_b16 v[36:37], v124 offset:8192
  ds_read_b64_tr_b16 v[38:39], v124 offset:9216
  v_mfma_f32_16x16x32_bf16 v[172:175], v[40:43], v[136:139], v[172:175]
  v_mfma_f32_16x16x32_bf16 v[176:179], v[40:43], v[144:147], v[176:179]
  v_mfma_f32_16x16x32_bf16 v[180:183], v[40:43], v[152:155], v[180:183]
  ds_read_b64_tr_b16 v[40:41], v125 offset:8192
  ds_read_b64_tr_b16 v[42:43], v125 offset:9216
  s_waitcnt lgkmcnt(6)
  v_mfma_f32_16x16x32_bf16 v[184:187], v[24:27], v[136:139], v[184:187]
  v_mfma_f32_16x16x32_bf16 v[188:191], v[24:27], v[144:147], v[188:191]
  v_mfma_f32_16x16x32_bf16 v[192:195], v[24:27], v[152:155], v[192:195]
  ds_read_b64_tr_b16 v[24:25], v126 offset:8192
  ds_read_b64_tr_b16 v[26:27], v126 offset:9216
  v_mfma_f32_16x16x32_bf16 v[196:199], v[28:31], v[136:139], v[196:199]
  v_mfma_f32_16x16x32_bf16 v[200:203], v[28:31], v[144:147], v[200:203]
  v_mfma_f32_16x16x32_bf16 v[204:207], v[28:31], v[152:155], v[204:207]
  s_waitcnt lgkmcnt(4)
  v_mfma_f32_16x16x32_bf16 v[208:211], v[32:35], v[136:139], v[208:211]
  v_mfma_f32_16x16x32_bf16 v[212:215], v[32:35], v[144:147], v[212:215]
  v_mfma_f32_16x16x32_bf16 v[216:219], v[32:35], v[152:155], v[216:219]
  v_mfma_f32_16x16x32_bf16 v[220:223], v[36:39], v[136:139], v[220:223]
  v_mfma_f32_16x16x32_bf16 v[224:227], v[36:39], v[144:147], v[224:227]
  v_mfma_f32_16x16x32_bf16 v[228:231], v[36:39], v[152:155], v[228:231]
  s_waitcnt lgkmcnt(0)
  v_mfma_f32_16x16x32_bf16 v[232:235], v[40:43], v[136:139], v[232:235]
  v_mfma_f32_16x16x32_bf16 v[236:239], v[40:43], v[144:147], v[236:239]
  v_mfma_f32_16x16x32_bf16 v[240:243], v[40:43], v[152:155], v[240:243]
  v_mfma_f32_16x16x32_bf16 v[244:247], v[24:27], v[136:139], v[244:247]
  v_mfma_f32_16x16x32_bf16 v[248:251], v[24:27], v[144:147], v[248:251]
  v_mfma_f32_16x16x32_bf16 v[252:255], v[24:27], v[152:155], v[252:255]
  s_bitcmp1_b32 s3, 2
  s_cbranch_scc1 L_attdone
  s_waitcnt lgkmcnt(0)
  s_barrier
  s_cmp_lt_u32 s69, s30
  s_cbranch_scc1 L_cp68
L_cq69:
  s_add_u32 m0, s97, 0
  s_bitcmp1_b32 6, s95
  s_cbranch_scc0 L_w66
  s_add_u32 s94, s94, s96
  buffer_load_dwordx4 v0, s[84:87], s94 offen nt lds
L_d67:
  s_add_u32 m0, s97, 8192
  s_bitcmp1_b32 6, s95
  s_cbranch_scc0 L_w70
  s_add_u32 s94, s94, s96
  buffer_load_dwordx4 v0, s[84:87], s94 offen nt lds
L_d71:
  s_add_u32 m0, s97, 16384
  s_bitcmp1_b32 6, s95
  s_cbranch_scc0 L_w72
  s_add_u32 s94, s94, s96
  buffer_load_dwordx4 v0, s[84:87], s94 offen nt lds
L_d73:
  s_add_u32 m0, s97, 24576
  s_bitcmp1_b32 6, s95
  s_cbranch_scc0 L_w74
  s_add_u32 s94, s94, s96
  buffer_load_dwordx4 v0, s[84:87], s94 offen nt lds
L_d75:
  s_getpc_b64 s[68:69]
L_pc76:
  s_sub_u32 s68, s68, L_pc76-L_pc0
  s_subb_u32 s69, s69, 0
  s_lshr_b32 s66, s2, 3
  s_lshl_b32 s66, s66, 2
  s_add_u32 s66, s66, s3
  s_lshl_b32 s66, s66, 9
  v_mbcnt_lo_u32_b32 v16, -1, 0
  v_mbcnt_hi_u32_b32 v16, -1, v16
  v_lshl_add_u32 v16, v16, 3, s66
  v_min_u32 v16, L_table-L_pc0, v16
  global_load_dwordx2 v[64:65], v16, s[68:69]
  s_cmp_eq_u32 s60, 1
  s_cbranch_scc0 L_nopfa
  v_mbcnt_lo_u32_b32 v17, -1, 0
  v_mbcnt_hi_u32_b32 v17, -1, v17
  v_lshrrev_b32 v16, 4, v17
  v_lshlrev_b32 v17, 4, v17
  v_and_b32 v18, 0xf0, v17
  v_lshl_or_b32 v16, v16, 13, v18
  s_lshl_b32 s66, s57, 2
  s_lshr_b32 s68, s56, 1
  s_lshl_b32 s68, s68, 2
  s_add_u32 s68, s68, s3
  s_mov_b32 s86, 4194304
  s_add_u32 s69, s66, 0
  s_lshl_b32 s69, s69, 8
  s_lshl_b32 s67, s68, 17
  s_add_u32 s67, s67, s69
  s_mov_b64 s[84:85], s[50:51]
  buffer_load_dwordx4 v[64:67], v16, s[84:87], s67 offen
  s_add_u32 s67, s67, 32768
  buffer_load_dwordx4 v[64:67], v16, s[84:87], s67 offen
  s_add_u32 s67, s67, 32768
  buffer_load_dwordx4 v[64:67], v16, s[84:87], s67 offen
  s_add_u32 s67, s67, 32768
  buffer_load_dwordx4 v[64:67], v16, s[84:87], s67 offen
L_nopfa:
  v_mov_b32 v57, v12
  v_mbcnt_lo_u32_b32 v22, -1, 0
  v_mbcnt_hi_u32_b32 v22, -1, v22
  v_lshrrev_b32 v16, 4, v22
  v_and_b32 v17, 15, v22
  v_bfe_u32 v18, v22, 2, 2
  v_and_b32 v19, 3, v22
  v_lshl_add_u32 v20, v16, 3, v18
  v_lshlrev_b32 v20, 8, v20
  v_and_b32 v21, 1, v16
  v_lshl_or_b32 v21, v21, 2, v18
  v_lshl_or_b32 v20, v21, 5, v20
  v_lshl_or_b32 v6, v19, 3, v20
  s_lshr_b32 s66, s62, 4
  v_xor_b32 v5, s66, v6
  s_lshr_b32 s67, s3, 1
  s_lshl_b32 s67, s67, 13
  v_lshrrev_b32 v20, 2, v17
  v_lshl_or_b32 v20, v20, 3, v19
  v_lshlrev_b32 v20, 8, v20
  v_lshrrev_b32 v21, 1, v16
  v_and_b32 v7, 7, v17
  v_xor_b32 v21, v21, v7
  v_lshl_or_b32 v20, v21, 5, v20
  v_and_b32 v21, 1, v16
  v_lshl_or_b32 v20, v21, 4, v20
  s_and_b32 s66, s3, 1
  s_lshl_b32 s66, s66, 10
  s_add_u32 s66, s66, s67
  v_add_u32 v7, s66, v20
  v_mul_u32_u24 v20, 256, v17
  v_add_u32 v20, 98304, v20
  v_xor_b32 v21, v16, v17
  v_lshlrev_b32 v21, 4, v21
  v_xor_b32 v8, 0, v21
  v_add_u32 v8, v8, v20
  v_xor_b32 v9, 64, v21
  v_add_u32 v9, v9, v20
  v_xor_b32 v10, 128, v21
  v_add_u32 v10, v10, v20
  v_xor_b32 v11, 192, v21
  v_add_u32 v11, v11, v20
  v_lshrrev_b32 v21, 1, v16
  s_lshr_b32 s66, s62, 8
  v_add_u32 v21, s66, v21
  v_xor_b32 v21, v21, v17
  v_lshl_add_u32 v12, v21, 4, v20
  v_and_b32 v21, 1, v16
  v_lshl_add_u32 v12, v21, 3, v12
  s_lshr_b32 s66, s3, 1
  s_lshl_b32 s66, s66, 2
  v_add_u32 v21, s66, v16
  v_xor_b32 v21, v21, v17
  v_lshl_add_u32 v13, v21, 4, v20
  s_and_b32 s66, s3, 1
  s_lshl_b32 s66, s66, 3
  v_add_u32 v13, s66, v13
  v_lshlrev_b32 v15, 5, v17
  v_add_u32 v15, 159744, v15
  v_lshlrev_b32 v21, 1, v16
  v_mov_b32 v20, 0x98
  v_lshrrev_b32 v21, v21, v20
  v_and_b32 v21, 3, v21
  v_lshl_add_u32 v14, v21, 9, v15
  s_lshl_b32 s66, s3, 2
  v_add_u32 v14, s66, v14
  s_branch L_attdone2
L_attdone:
  v_mov_b32 v57, v12
L_attdone2:
  s_setprio 0
  s_cmp_eq_u32 s60, 1
  s_cselect_b32 s6, 27, 43
  v_readlane_b32 s7, v1, s6
  s_mov_b32 s12, s46
  s_mov_b32 s13, s47
  s_mov_b32 s14, 67108864
  s_mov_b32 s15, 0x20000
  s_mov_b32 s16, s48
  s_mov_b32 s17, s49
  s_mov_b32 s18, 67108864
  s_mov_b32 s19, 0x20000
  v_mbcnt_lo_u32_b32 v19, -1, 0
  v_mbcnt_hi_u32_b32 v19, -1, v19
  v_and_b32 v16, 15, v19
  v_lshlrev_b32 v16, 3, v16
  s_mul_i32 s66, s3, 384
  s_add_u32 s66, s66, 159744
  v_add_u32 v17, s66, v16
  s_xor_b32 s67, s3, 1
  s_mul_i32 s66, s67, 384
  s_add_u32 s66, s66, 159744
  v_add_u32 v18, s66, v16
  v_mov_b32 v45, v57
  ds_write_b64 v17, v[44:45] offset:0
  v_mov_b32 v49, v56
  ds_write_b64 v17, v[48:49] offset:128
  v_mov_b32 v53, v60
  ds_write_b64 v17, v[52:53] offset:256
  s_waitcnt lgkmcnt(0)
  s_barrier
  ds_read_b64 v[32:33], v18 offset:0
  ds_read_b64 v[34:35], v18 offset:128
  ds_read_b64 v[36:37], v18 offset:256
  s_mul_i32 s66, s3, 6144
  s_add_u32 s66, s66, 98304
  s_mul_i32 s67, s67, 6144
  s_add_u32 s67, s67, 98304
  v_lshlrev_b32 v16, 4, v19
  v_add_u32 v17, s66, v16
  v_add_u32 v18, s67, v16
  s_waitcnt lgkmcnt(0)
  v_min_f32 v40, v57, v33
  v_sub_f32 v24, v40, v57
  v_sub_f32 v25, v40, v33
  v_exp_f32 v24, v24
  v_exp_f32 v25, v25
  s_nop 0
  v_mul_f32 v40, v24, v44
  v_fma_f32 v40, v25, v32, v40
  v_rcp_f32 v40, v40
  s_nop 0
  v_mul_f32 v24, v24, v40
  v_min_f32 v41, v56, v35
  v_sub_f32 v26, v41, v56
  v_sub_f32 v27, v41, v35
  v_exp_f32 v26, v26
  v_exp_f32 v27, v27
  s_nop 0
  v_mul_f32 v41, v26, v48
  v_fma_f32 v41, v27, v34, v41
  v_rcp_f32 v41, v41
  s_nop 0
  v_mul_f32 v26, v26, v41
  v_min_f32 v42, v60, v37
  v_sub_f32 v28, v42, v60
  v_sub_f32 v29, v42, v37
  v_exp_f32 v28, v28
  v_exp_f32 v29, v29
  s_nop 0
  v_mul_f32 v42, v28, v52
  v_fma_f32 v42, v29, v36, v42
  v_rcp_f32 v42, v42
  s_nop 0
  v_mul_f32 v28, v28, v42
  v_pk_mul_f32 v[208:209], v[208:209], v[24:25] op_sel_hi:[1,0]
  v_pk_mul_f32 v[210:211], v[210:211], v[24:25] op_sel_hi:[1,0]
  v_pk_mul_f32 v[212:213], v[212:213], v[26:27] op_sel_hi:[1,0]
  v_pk_mul_f32 v[214:215], v[214:215], v[26:27] op_sel_hi:[1,0]
  v_pk_mul_f32 v[216:217], v[216:217], v[28:29] op_sel_hi:[1,0]
  v_pk_mul_f32 v[218:219], v[218:219], v[28:29] op_sel_hi:[1,0]
  v_pk_mul_f32 v[220:221], v[220:221], v[24:25] op_sel_hi:[1,0]
  v_pk_mul_f32 v[222:223], v[222:223], v[24:25] op_sel_hi:[1,0]
  v_pk_mul_f32 v[224:225], v[224:225], v[26:27] op_sel_hi:[1,0]
  v_pk_mul_f32 v[226:227], v[226:227], v[26:27] op_sel_hi:[1,0]
  v_pk_mul_f32 v[228:229], v[228:229], v[28:29] op_sel_hi:[1,0]
  v_pk_mul_f32 v[230:231], v[230:231], v[28:29] op_sel_hi:[1,0]
  v_pk_mul_f32 v[232:233], v[232:233], v[24:25] op_sel_hi:[1,0]
  v_pk_mul_f32 v[234:235], v[234:235], v[24:25] op_sel_hi:[1,0]
  v_pk_mul_f32 v[236:237], v[236:237], v[26:27] op_sel_hi:[1,0]
  v_pk_mul_f32 v[238:239], v[238:239], v[26:27] op_sel_hi:[1,0]
  v_pk_mul_f32 v[240:241], v[240:241], v[28:29] op_sel_hi:[1,0]
  v_pk_mul_f32 v[242:243], v[242:243], v[28:29] op_sel_hi:[1,0]
  v_pk_mul_f32 v[244:245], v[244:245], v[24:25] op_sel_hi:[1,0]
  v_pk_mul_f32 v[246:247], v[246:247], v[24:25] op_sel_hi:[1,0]
  v_pk_mul_f32 v[248:249], v[248:249], v[26:27] op_sel_hi:[1,0]
  v_pk_mul_f32 v[250:251], v[250:251], v[26:27] op_sel_hi:[1,0]
  v_pk_mul_f32 v[252:253], v[252:253], v[28:29] op_sel_hi:[1,0]
  v_pk_mul_f32 v[254:255], v[254:255], v[28:29] op_sel_hi:[1,0]
  v_cvt_pk_bf16_f32 v112, v208, v209
  v_cvt_pk_bf16_f32 v113, v210, v211
  v_cvt_pk_bf16_f32 v114, v212, v213
  v_cvt_pk_bf16_f32 v115, v214, v215
  ds_write_b128 v17, v[112:115] offset:0
  v_cvt_pk_bf16_f32 v116, v216, v217
  v_cvt_pk_bf16_f32 v117, v218, v219
  v_cvt_pk_bf16_f32 v118, v220, v221
  v_cvt_pk_bf16_f32 v119, v222, v223
  ds_write_b128 v17, v[116:119] offset:1024
  v_cvt_pk_bf16_f32 v120, v224, v225
  v_cvt_pk_bf16_f32 v121, v226, v227
  v_cvt_pk_bf16_f32 v122, v228, v229
  v_cvt_pk_bf16_f32 v123, v230, v231
  ds_write_b128 v17, v[120:123] offset:2048
  v_cvt_pk_bf16_f32 v124, v232, v233
  v_cvt_pk_bf16_f32 v125, v234, v235
  v_cvt_pk_bf16_f32 v126, v236, v237
  v_cvt_pk_bf16_f32 v127, v238, v239
  ds_write_b128 v17, v[124:127] offset:3072
  v_cvt_pk_bf16_f32 v128, v240, v241
  v_cvt_pk_bf16_f32 v129, v242, v243
  v_cvt_pk_bf16_f32 v130, v244, v245
  v_cvt_pk_bf16_f32 v131, v246, v247
  ds_write_b128 v17, v[128:131] offset:4096
  v_cvt_pk_bf16_f32 v132, v248, v249
  v_cvt_pk_bf16_f32 v133, v250, v251
  v_cvt_pk_bf16_f32 v134, v252, v253
  v_cvt_pk_bf16_f32 v135, v254, v255
  ds_write_b128 v17, v[132:135] offset:5120
  s_and_b32 s66, s3, 1
  s_lshl_b32 s66, s66, 3
  s_mov_b32 s68, 0xffff0000
  s_waitcnt lgkmcnt(0)
  s_barrier
  ds_read_b128 v[136:139], v18 offset:0
  ds_read_b128 v[140:143], v18 offset:1024
  ds_read_b128 v[144:147], v18 offset:2048
  ds_read_b128 v[148:151], v18 offset:3072
  ds_read_b128 v[152:155], v18 offset:4096
  ds_read_b128 v[156:159], v18 offset:5120
  v_mbcnt_lo_u32_b32 v17, -1, 0
  v_mbcnt_hi_u32_b32 v17, -1, v17
  v_lshrrev_b32 v16, 4, v17
  v_and_b32 v17, 15, v17
  v_lshrrev_b32 v18, 1, v16
  v_add_u32 v18, s66, v18
  v_xor_b32 v18, v18, v17
  v_lshlrev_b32 v18, 4, v18
  v_and_b32 v16, 1, v16
  v_lshl_or_b32 v18, v16, 3, v18
  v_mul_u32_u24 v17, 256, v17
  s_add_u32 s71, s63, 98304
  v_add3_u32 v17, v17, s71, v18
  s_bitcmp1_b32 s3, 2
  s_cbranch_scc1 L_mw0
  s_cmp_eq_u32 s60, 1
  s_cbranch_scc0 L_mw0
  s_waitcnt vmcnt(4)
  s_branch L_mw2
L_mw0:
  s_waitcnt vmcnt(0)
L_mw2:
  s_waitcnt lgkmcnt(0)
  s_barrier
  v_lshlrev_b32 v112, 16, v136
  v_and_b32 v113, s68, v136
  v_pk_fma_f32 v[112:113], v[160:161], v[24:25], v[112:113] op_sel_hi:[1,0,1]
  v_cvt_pk_bf16_f32 v116, v112, v113
  v_lshlrev_b32 v114, 16, v137
  v_and_b32 v115, s68, v137
  v_pk_fma_f32 v[114:115], v[162:163], v[24:25], v[114:115] op_sel_hi:[1,0,1]
  v_cvt_pk_bf16_f32 v117, v114, v115
  ds_write_b64 v17, v[116:117] offset:0
  v_lshlrev_b32 v112, 16, v138
  v_and_b32 v113, s68, v138
  v_pk_fma_f32 v[112:113], v[164:165], v[26:27], v[112:113] op_sel_hi:[1,0,1]
  v_cvt_pk_bf16_f32 v118, v112, v113
  v_lshlrev_b32 v114, 16, v139
  v_and_b32 v115, s68, v139
  v_pk_fma_f32 v[114:115], v[166:167], v[26:27], v[114:115] op_sel_hi:[1,0,1]
  v_cvt_pk_bf16_f32 v119, v114, v115
  ds_write_b64 v17, v[118:119] offset:4096
  v_lshlrev_b32 v112, 16, v140
  v_and_b32 v113, s68, v140
  v_pk_fma_f32 v[112:113], v[168:169], v[28:29], v[112:113] op_sel_hi:[1,0,1]
  v_cvt_pk_bf16_f32 v120, v112, v113
  v_lshlrev_b32 v114, 16, v141
  v_and_b32 v115, s68, v141
  v_pk_fma_f32 v[114:115], v[170:171], v[28:29], v[114:115] op_sel_hi:[1,0,1]
  v_cvt_pk_bf16_f32 v121, v114, v115
  ds_write_b64 v17, v[120:121] offset:8192
  v_xor_b32 v19, 32, v17
  v_lshlrev_b32 v112, 16, v142
  v_and_b32 v113, s68, v142
  v_pk_fma_f32 v[112:113], v[172:173], v[24:25], v[112:113] op_sel_hi:[1,0,1]
  v_cvt_pk_bf16_f32 v122, v112, v113
  v_lshlrev_b32 v114, 16, v143
  v_and_b32 v115, s68, v143
  v_pk_fma_f32 v[114:115], v[174:175], v[24:25], v[114:115] op_sel_hi:[1,0,1]
  v_cvt_pk_bf16_f32 v123, v114, v115
  ds_write_b64 v19, v[122:123] offset:0
  v_lshlrev_b32 v112, 16, v144
  v_and_b32 v113, s68, v144
  v_pk_fma_f32 v[112:113], v[176:177], v[26:27], v[112:113] op_sel_hi:[1,0,1]
  v_cvt_pk_bf16_f32 v116, v112, v113
  v_lshlrev_b32 v114, 16, v145
  v_and_b32 v115, s68, v145
  v_pk_fma_f32 v[114:115], v[178:179], v[26:27], v[114:115] op_sel_hi:[1,0,1]
  v_cvt_pk_bf16_f32 v117, v114, v115
  ds_write_b64 v19, v[116:117] offset:4096
  v_lshlrev_b32 v112, 16, v146
  v_and_b32 v113, s68, v146
  v_pk_fma_f32 v[112:113], v[180:181], v[28:29], v[112:113] op_sel_hi:[1,0,1]
  v_cvt_pk_bf16_f32 v118, v112, v113
  v_lshlrev_b32 v114, 16, v147
  v_and_b32 v115, s68, v147
  v_pk_fma_f32 v[114:115], v[182:183], v[28:29], v[114:115] op_sel_hi:[1,0,1]
  v_cvt_pk_bf16_f32 v119, v114, v115
  ds_write_b64 v19, v[118:119] offset:8192
  v_xor_b32 v19, 64, v17
  v_lshlrev_b32 v112, 16, v148
  v_and_b32 v113, s68, v148
  v_pk_fma_f32 v[112:113], v[184:185], v[24:25], v[112:113] op_sel_hi:[1,0,1]
  v_cvt_pk_bf16_f32 v120, v112, v113
  v_lshlrev_b32 v114, 16, v149
  v_and_b32 v115, s68, v149
  v_pk_fma_f32 v[114:115], v[186:187], v[24:25], v[114:115] op_sel_hi:[1,0,1]
  v_cvt_pk_bf16_f32 v121, v114, v115
  ds_write_b64 v19, v[120:121] offset:0
  v_lshlrev_b32 v112, 16, v150
  v_and_b32 v113, s68, v150
  v_pk_fma_f32 v[112:113], v[188:189], v[26:27], v[112:113] op_sel_hi:[1,0,1]
  v_cvt_pk_bf16_f32 v122, v112, v113
  v_lshlrev_b32 v114, 16, v151
  v_and_b32 v115, s68, v151
  v_pk_fma_f32 v[114:115], v[190:191], v[26:27], v[114:115] op_sel_hi:[1,0,1]
  v_cvt_pk_bf16_f32 v123, v114, v115
  ds_write_b64 v19, v[122:123] offset:4096
  v_lshlrev_b32 v112, 16, v152
  v_and_b32 v113, s68, v152
  v_pk_fma_f32 v[112:113], v[192:193], v[28:29], v[112:113] op_sel_hi:[1,0,1]
  v_cvt_pk_bf16_f32 v116, v112, v113
  v_lshlrev_b32 v114, 16, v153
  v_and_b32 v115, s68, v153
  v_pk_fma_f32 v[114:115], v[194:195], v[28:29], v[114:115] op_sel_hi:[1,0,1]
  v_cvt_pk_bf16_f32 v117, v114, v115
  ds_write_b64 v19, v[116:117] offset:8192
  v_xor_b32 v19, 96, v17
  v_lshlrev_b32 v112, 16, v154
  v_and_b32 v113, s68, v154
  v_pk_fma_f32 v[112:113], v[196:197], v[24:25], v[112:113] op_sel_hi:[1,0,1]
  v_cvt_pk_bf16_f32 v118, v112, v113
  v_lshlrev_b32 v114, 16, v155
  v_and_b32 v115, s68, v155
  v_pk_fma_f32 v[114:115], v[198:199], v[24:25], v[114:115] op_sel_hi:[1,0,1]
  v_cvt_pk_bf16_f32 v119, v114, v115
  ds_write_b64 v19, v[118:119] offset:0
  v_lshlrev_b32 v112, 16, v156
  v_and_b32 v113, s68, v156
  v_pk_fma_f32 v[112:113], v[200:201], v[26:27], v[112:113] op_sel_hi:[1,0,1]
  v_cvt_pk_bf16_f32 v120, v112, v113
  v_lshlrev_b32 v114, 16, v157
  v_and_b32 v115, s68, v157
  v_pk_fma_f32 v[114:115], v[202:203], v[26:27], v[114:115] op_sel_hi:[1,0,1]
  v_cvt_pk_bf16_f32 v121, v114, v115
  ds_write_b64 v19, v[120:121] offset:4096
  v_lshlrev_b32 v112, 16, v158
  v_and_b32 v113, s68, v158
  v_pk_fma_f32 v[112:113], v[204:205], v[28:29], v[112:113] op_sel_hi:[1,0,1]
  v_cvt_pk_bf16_f32 v122, v112, v113
  v_lshlrev_b32 v114, 16, v159
  v_and_b32 v115, s68, v159
  v_pk_fma_f32 v[114:115], v[206:207], v[28:29], v[114:115] op_sel_hi:[1,0,1]
  v_cvt_pk_bf16_f32 v123, v114, v115
  ds_write_b64 v19, v[122:123] offset:8192
  s_mov_b32 s91, 1
  s_mov_b32 s28, s44
  s_mov_b32 s29, s45
  s_mov_b32 s30, 786432
  s_mov_b32 s31, 0x20000
  s_bitcmp1_b32 s3, 2
  s_cbranch_scc1 L_xs
  s_branch L_xs2
L_xs:
  v_mbcnt_lo_u32_b32 v162, -1, 0
  v_mbcnt_hi_u32_b32 v162, -1, v162
  v_lshrrev_b32 v161, 4, v162
  v_and_b32 v162, 15, v162
  v_xor_b32 v162, v162, v161
  v_lshlrev_b32 v162, 4, v162
  v_lshl_or_b32 v162, v161, 10, v162
  s_mul_i32 s66, s62, 3
  s_add_u32 s68, s66, 98304
  s_mul_i32 s67, s56, 49152
  s_lshl_b32 s69, s66, 2
  s_add_u32 s67, s67, s69
  s_lshr_b32 s66, s66, 4
  s_add_u32 s69, s66, 0
  s_and_b32 s69, s69, 0xc0
  v_xor_b32 v160, s69, v162
  s_add_u32 s69, s66, 64
  s_and_b32 s69, s69, 0xc0
  v_xor_b32 v161, s69, v162
  s_add_u32 s69, s66, 128
  s_and_b32 s69, s69, 0xc0
  v_xor_b32 v162, s69, v162
L_xs2:
  s_and_b32 s101, s60, 1
  s_mov_b32 s65, s60
  s_mov_b32 s63, 0
  s_call_b64 s[92:93], L_wide
  s_lshl_b32 s66, s56, 3
  s_add_u32 s66, s66, s57
  s_mul_i32 s66, s66, 49152
  s_add_u32 s66, s66, 12582912
  s_cmp_eq_u32 s60, 2
  s_cbranch_scc1 L_last
  s_bitcmp1_b32 s3, 2
  s_cbranch_scc1 L_apk
  s_barrier
  s_waitcnt vmcnt(0)
  v_mbcnt_lo_u32_b32 v16, -1, 0
  v_mbcnt_hi_u32_b32 v16, -1, v16
  v_lshlrev_b32 v16, 4, v16
  v_add_u32 v17, 4096, v16
  v_add_u32 v18, 8192, v16
  s_mov_b32 s28, s54
  s_mov_b32 s29, s55
  s_mov_b32 s30, 268435456
  s_mov_b32 s31, 0x20000
  s_mul_i32 s67, s3, 12288
  s_add_u32 s70, s66, s67
  v_mfma_f32_16x16x32_bf16 v[160:163], v[72:75], v[36:39], v[160:163]
  v_mfma_f32_16x16x32_bf16 v[164:167], v[72:75], v[40:43], v[164:167]
  v_mfma_f32_16x16x32_bf16 v[168:171], v[72:75], v[44:47], v[168:171]
  v_mfma_f32_16x16x32_bf16 v[172:175], v[76:79], v[36:39], v[172:175]
  v_mfma_f32_16x16x32_bf16 v[176:179], v[76:79], v[40:43], v[176:179]
  v_mfma_f32_16x16x32_bf16 v[180:183], v[76:79], v[44:47], v[180:183]
  v_mfma_f32_16x16x32_bf16 v[184:187], v[80:83], v[36:39], v[184:187]
  v_mfma_f32_16x16x32_bf16 v[188:191], v[80:83], v[40:43], v[188:191]
  v_mfma_f32_16x16x32_bf16 v[192:195], v[80:83], v[44:47], v[192:195]
  v_mfma_f32_16x16x32_bf16 v[196:199], v[84:87], v[36:39], v[196:199]
  v_mfma_f32_16x16x32_bf16 v[200:203], v[84:87], v[40:43], v[200:203]
  v_mfma_f32_16x16x32_bf16 v[204:207], v[84:87], v[44:47], v[204:207]
  v_mfma_f32_16x16x32_bf16 v[208:211], v[88:91], v[36:39], v[208:211]
  v_mfma_f32_16x16x32_bf16 v[212:215], v[88:91], v[40:43], v[212:215]
  v_cvt_pk_bf16_f32 v160, v160, v161
  v_cvt_pk_bf16_f32 v161, v162, v163
  v_cvt_pk_bf16_f32 v162, v172, v173
  v_cvt_pk_bf16_f32 v163, v174, v175
  v_mfma_f32_16x16x32_bf16 v[216:219], v[88:91], v[44:47], v[216:219]
  v_cvt_pk_bf16_f32 v164, v164, v165
  v_cvt_pk_bf16_f32 v165, v166, v167
  v_cvt_pk_bf16_f32 v166, v176, v177
  v_cvt_pk_bf16_f32 v167, v178, v179
  v_mfma_f32_16x16x32_bf16 v[220:223], v[92:95], v[36:39], v[220:223]
  v_cvt_pk_bf16_f32 v168, v168, v169
  v_cvt_pk_bf16_f32 v169, v170, v171
  v_cvt_pk_bf16_f32 v170, v180, v181
  v_cvt_pk_bf16_f32 v171, v182, v183
  v_mfma_f32_16x16x32_bf16 v[224:227], v[92:95], v[40:43], v[224:227]
  s_nop 1
  v_permlane16_swap_b32 v160, v162
  v_permlane16_swap_b32 v161, v163
  buffer_store_dwordx4 v[160:163], v16, s[28:31], s70 offen offset:0 sc1
  v_permlane16_swap_b32 v164, v166
  v_permlane16_swap_b32 v165, v167
  buffer_store_dwordx4 v[164:167], v17, s[28:31], s70 offen offset:0 sc1
  v_permlane16_swap_b32 v168, v170
  v_permlane16_swap_b32 v169, v171
  buffer_store_dwordx4 v[168:171], v18, s[28:31], s70 offen offset:0 sc1
  v_mfma_f32_16x16x32_bf16 v[228:231], v[92:95], v[44:47], v[228:231]
  v_mfma_f32_16x16x32_bf16 v[232:235], v[104:107], v[36:39], v[232:235]
  v_mfma_f32_16x16x32_bf16 v[236:239], v[104:107], v[40:43], v[236:239]
  v_cvt_pk_bf16_f32 v184, v184, v185
  v_cvt_pk_bf16_f32 v185, v186, v187
  v_cvt_pk_bf16_f32 v186, v196, v197
  v_cvt_pk_bf16_f32 v187, v198, v199
  v_mfma_f32_16x16x32_bf16 v[240:243], v[104:107], v[44:47], v[240:243]
  v_cvt_pk_bf16_f32 v188, v188, v189
  v_cvt_pk_bf16_f32 v189, v190, v191
  v_cvt_pk_bf16_f32 v190, v200, v201
  v_cvt_pk_bf16_f32 v191, v202, v203
  v_mfma_f32_16x16x32_bf16 v[244:247], v[108:111], v[36:39], v[244:247]
  v_cvt_pk_bf16_f32 v192, v192, v193
  v_cvt_pk_bf16_f32 v193, v194, v195
  v_cvt_pk_bf16_f32 v194, v204, v205
  v_cvt_pk_bf16_f32 v195, v206, v207
  v_mfma_f32_16x16x32_bf16 v[248:251], v[108:111], v[40:43], v[248:251]
  s_nop 1
  v_permlane16_swap_b32 v184, v186
  v_permlane16_swap_b32 v185, v187
  buffer_store_dwordx4 v[184:187], v16, s[28:31], s70 offen offset:1024 sc1
  v_permlane16_swap_b32 v188, v190
  v_permlane16_swap_b32 v189, v191
  buffer_store_dwordx4 v[188:191], v17, s[28:31], s70 offen offset:1024 sc1
  v_permlane16_swap_b32 v192, v194
  v_permlane16_swap_b32 v193, v195
  buffer_store_dwordx4 v[192:195], v18, s[28:31], s70 offen offset:1024 sc1
  v_mfma_f32_16x16x32_bf16 v[252:255], v[108:111], v[44:47], v[252:255]
  v_cvt_pk_bf16_f32 v208, v208, v209
  v_cvt_pk_bf16_f32 v209, v210, v211
  v_cvt_pk_bf16_f32 v210, v220, v221
  v_cvt_pk_bf16_f32 v211, v222, v223
  v_cvt_pk_bf16_f32 v212, v212, v213
  v_cvt_pk_bf16_f32 v213, v214, v215
  v_cvt_pk_bf16_f32 v214, v224, v225
  v_cvt_pk_bf16_f32 v215, v226, v227
  v_cvt_pk_bf16_f32 v216, v216, v217
  v_cvt_pk_bf16_f32 v217, v218, v219
  v_cvt_pk_bf16_f32 v218, v228, v229
  v_cvt_pk_bf16_f32 v219, v230, v231
  s_nop 1
  v_permlane16_swap_b32 v208, v210
  v_permlane16_swap_b32 v209, v211
  buffer_store_dwordx4 v[208:211], v16, s[28:31], s70 offen offset:2048 sc1
  v_permlane16_swap_b32 v212, v214
  v_permlane16_swap_b32 v213, v215
  buffer_store_dwordx4 v[212:215], v17, s[28:31], s70 offen offset:2048 sc1
  v_permlane16_swap_b32 v216, v218
  v_permlane16_swap_b32 v217, v219
  buffer_store_dwordx4 v[216:219], v18, s[28:31], s70 offen offset:2048 sc1
  v_cvt_pk_bf16_f32 v232, v232, v233
  v_cvt_pk_bf16_f32 v233, v234, v235
  v_cvt_pk_bf16_f32 v234, v244, v245
  v_cvt_pk_bf16_f32 v235, v246, v247
  v_cvt_pk_bf16_f32 v236, v236, v237
  v_cvt_pk_bf16_f32 v237, v238, v239
  v_cvt_pk_bf16_f32 v238, v248, v249
  v_cvt_pk_bf16_f32 v239, v250, v251
  v_cvt_pk_bf16_f32 v240, v240, v241
  v_cvt_pk_bf16_f32 v241, v242, v243
  v_cvt_pk_bf16_f32 v242, v252, v253
  v_cvt_pk_bf16_f32 v243, v254, v255
  s_nop 1
  v_permlane16_swap_b32 v232, v234
  v_permlane16_swap_b32 v233, v235
  buffer_store_dwordx4 v[232:235], v16, s[28:31], s70 offen offset:3072 sc1
  v_permlane16_swap_b32 v236, v238
  v_permlane16_swap_b32 v237, v239
  buffer_store_dwordx4 v[236:239], v17, s[28:31], s70 offen offset:3072 sc1
  v_permlane16_swap_b32 v240, v242
  v_permlane16_swap_b32 v241, v243
  buffer_store_dwordx4 v[240:243], v18, s[28:31], s70 offen offset:3072 sc1
  s_nop 1
L_apk:
  s_mov_b32 s20, s52
  s_mov_b32 s21, s53
  s_mov_b32 s22, 4194304
  s_mov_b32 s23, 0x20000
  s_mov_b32 s91, 1
  s_mov_b32 s101, 0
  s_branch L_q0
L_bpath:
  s_mov_b32 s98, 0
  s_lshl_b32 s99, s60, 3
  s_lshr_b32 s99, 0x62e06, s99
  s_and_b32 s99, s99, 0xff
  s_mov_b32 s63, 49152
L_head:
  s_bitcmp1_b32 s3, 2
  s_cbranch_scc1 L_qk_sync
  s_getpc_b64 s[68:69]
L_pc77:
  s_sub_u32 s68, s68, L_pc77-L_pc0
  s_subb_u32 s69, s69, 0
  s_lshr_b32 s66, s2, 3
  s_lshl_b32 s66, s66, 2
  s_add_u32 s66, s66, s3
  s_lshl_b32 s66, s66, 9
  v_mbcnt_lo_u32_b32 v16, -1, 0
  v_mbcnt_hi_u32_b32 v16, -1, v16
  v_lshl_add_u32 v16, v16, 3, s66
  v_min_u32 v16, L_table-L_pc0, v16
  global_load_dwordx2 v[156:157], v16, s[68:69]
  s_lshl_b32 s66, s58, 2
  s_or_b32 s66, s66, s59
  s_cmp_eq_u32 s66, 2
  s_cbranch_scc0 L_pf78
  v_mbcnt_lo_u32_b32 v17, -1, 0
  v_mbcnt_hi_u32_b32 v17, -1, v17
  v_lshrrev_b32 v16, 4, v17
  v_lshlrev_b32 v17, 4, v17
  v_and_b32 v18, 0xf0, v17
  v_lshl_or_b32 v16, v16, 13, v18
  s_lshl_b32 s66, s57, 2
  s_lshr_b32 s68, s56, 0
  s_lshl_b32 s68, s68, 2
  s_add_u32 s68, s68, s3
  s_mov_b32 s86, 4194304
  s_add_u32 s69, s66, 0
  s_lshl_b32 s69, s69, 17
  s_lshl_b32 s67, s68, 11
  s_add_u32 s67, s67, s69
  s_mov_b64 s[84:85], s[40:41]
  buffer_load_dwordx4 v[156:159], v17, s[84:87], s67 offen
  s_add_u32 s67, s67, 1024
  buffer_load_dwordx4 v[156:159], v17, s[84:87], s67 offen
  s_add_u32 s69, s66, 1
  s_lshl_b32 s69, s69, 17
  s_lshl_b32 s67, s68, 11
  s_add_u32 s67, s67, s69
  s_mov_b64 s[84:85], s[40:41]
  buffer_load_dwordx4 v[156:159], v17, s[84:87], s67 offen
  s_add_u32 s67, s67, 1024
  buffer_load_dwordx4 v[156:159], v17, s[84:87], s67 offen
  s_add_u32 s69, s66, 2
  s_lshl_b32 s69, s69, 17
  s_lshl_b32 s67, s68, 11
  s_add_u32 s67, s67, s69
  s_mov_b64 s[84:85], s[40:41]
  buffer_load_dwordx4 v[156:159], v17, s[84:87], s67 offen
  s_add_u32 s67, s67, 1024
  buffer_load_dwordx4 v[156:159], v17, s[84:87], s67 offen
  s_add_u32 s69, s66, 3
  s_lshl_b32 s69, s69, 17
  s_lshl_b32 s67, s68, 11
  s_add_u32 s67, s67, s69
  s_mov_b64 s[84:85], s[40:41]
  buffer_load_dwordx4 v[156:159], v17, s[84:87], s67 offen
  s_add_u32 s67, s67, 1024
  buffer_load_dwordx4 v[156:159], v17, s[84:87], s67 offen
  s_add_u32 s69, s66, 2
  s_lshl_b32 s69, s69, 17
  s_lshl_b32 s67, s68, 11
  s_add_u32 s67, s67, s69
  s_mov_b64 s[84:85], s[52:53]
  buffer_load_dwordx4 v[156:159], v17, s[84:87], s67 offen
  s_add_u32 s67, s67, 1024
  buffer_load_dwordx4 v[156:159], v17, s[84:87], s67 offen
L_pf78:
  s_lshl_b32 s66, s58, 2
  s_or_b32 s66, s66, s59
  s_cmp_eq_u32 s66, 1
  s_cbranch_scc0 L_pf79
  v_mbcnt_lo_u32_b32 v17, -1, 0
  v_mbcnt_hi_u32_b32 v17, -1, v17
  v_lshrrev_b32 v16, 4, v17
  v_lshlrev_b32 v17, 4, v17
  v_and_b32 v18, 0xf0, v17
  v_lshl_or_b32 v16, v16, 13, v18
  s_lshl_b32 s66, s57, 2
  s_lshr_b32 s68, s56, 0
  s_lshl_b32 s68, s68, 2
  s_add_u32 s68, s68, s3
  s_mov_b32 s86, 4194304
  s_add_u32 s69, s66, 3
  s_lshl_b32 s69, s69, 17
  s_lshl_b32 s67, s68, 11
  s_add_u32 s67, s67, s69
  s_mov_b64 s[84:85], s[52:53]
  buffer_load_dwordx4 v[156:159], v17, s[84:87], s67 offen
  s_add_u32 s67, s67, 1024
  buffer_load_dwordx4 v[156:159], v17, s[84:87], s67 offen
L_pf79:
  s_mov_b32 s6, s99
  v_readlane_b32 s7, v1, s99
  s_sub_u32 s5, s4, 32768
  s_cselect_b32 s5, 65536, s5
  s_add_u32 s5, s5, s62
  s_and_b32 s72, s7, 0xffffff00
  s_and_b32 s73, s7, 7
  s_add_u32 s6, s6, 1
  s_lshl_b32 m0, s73, 2
  s_mul_i32 s42, s73, 5
  s_movrels_b64 s[80:81], s[8:9]
  s_movrels_b32 s82, s10
  v_readlane_b32 s7, v1, s6
  s_lshr_b32 s43, 0xd5210d, s42
  s_lshr_b32 s42, 0x8435b2, s42
  v_lshl_add_u32 v4, v2, s43, v3
  s_lshl_b32 s74, 1, s42
  s_lshl_b32 s88, 16, s43
L_qk_sync:
  s_add_u32 s99, s99, 12
  s_max_u32 s99, s99, 27
  s_cmp_eq_u32 s98, 0
  s_cselect_b32 s66, s4, 110592
  v_add_u32 v16, s66, v7
  v_xor_b32 v17, 64, v16
  v_xor_b32 v18, 128, v16
  v_xor_b32 v19, 192, v16
  s_cmp_eq_u32 s98, 0
  s_cbranch_scc1 L_h80
  s_waitcnt vmcnt(16) lgkmcnt(0)
  s_branch L_h81
L_h80:
  s_waitcnt vmcnt(8) lgkmcnt(0)
L_h81:
  s_barrier
  v_add_u32 v96, s63, v8
  v_add_u32 v97, s63, v9
  v_add_u32 v98, s63, v10
  v_add_u32 v99, s63, v11
  ds_read_b128 v[24:27], v96 offset:0
  ds_read_b128 v[40:43], v96 offset:4096
  ds_read_b128 v[80:83], v96 offset:8192
  ds_read_b128 v[28:31], v97 offset:0
  ds_read_b128 v[44:47], v97 offset:4096
  ds_read_b128 v[84:87], v97 offset:8192
  ds_read_b128 v[32:35], v98 offset:0
  ds_read_b128 v[72:75], v98 offset:4096
  ds_read_b128 v[88:91], v98 offset:8192
  ds_read_b128 v[36:39], v99 offset:0
  ds_read_b128 v[76:79], v99 offset:4096
  ds_read_b128 v[92:95], v99 offset:8192
  ds_read_b128 v[96:99], v16
  ds_read_b128 v[100:103], v17
  ds_read_b128 v[104:107], v18
  ds_read_b128 v[108:111], v19
  s_bitcmp1_b32 s3, 2
  s_cselect_b32 s90, s88, 0
  s_cselect_b32 s42, 4096, 0
  s_add_u32 s90, s90, s72
  s_add_u32 s42, s42, s5
  s_add_u32 m0, s42, 0
  s_nop 0
  buffer_load_dwordx4 v4, s[80:83], s90 offen nt lds
  s_add_u32 m0, s42, 8192
  s_add_u32 s90, s90, s74
  buffer_load_dwordx4 v4, s[80:83], s90 offen nt lds
  s_add_u32 m0, s42, 16384
  s_add_u32 s90, s90, s74
  buffer_load_dwordx4 v4, s[80:83], s90 offen nt lds
  s_add_u32 m0, s42, 24576
  s_add_u32 s90, s90, s74
  buffer_load_dwordx4 v4, s[80:83], s90 offen nt lds
L_sk83:
  s_cmp_eq_u32 s98, 0
  s_cbranch_scc0 L_np82
  s_add_u32 s97, s4, s62
  s_add_u32 s4, s4, 32768
  s_cmp_eq_u32 s4, 98304
  s_cselect_b32 s4, 0, s4
  s_and_b32 s94, s7, 0xffffff00
  s_and_b32 s95, s7, 7
  s_add_u32 s6, s6, 1
  s_lshl_b32 m0, s95, 2
  s_mul_i32 s42, s95, 5
  s_movrels_b64 s[84:85], s[8:9]
  s_movrels_b32 s86, s10
  v_readlane_b32 s7, v1, s6
  s_lshr_b32 s43, 0xd5210d, s42
  s_lshr_b32 s42, 0x8435b2, s42
  v_lshl_add_u32 v0, v2, s43, v3
  s_lshl_b32 s96, 1, s42
  s_lshl_b32 s89, 16, s43
L_np82:
  v_add_u32 v20, s4, v7
  v_xor_b32 v16, 0, v20
  v_xor_b32 v17, 64, v20
  v_xor_b32 v18, 128, v20
  v_xor_b32 v19, 192, v20
  v_mov_b32 v21, 162816
  v_mov_b32 v22, 0
  s_waitcnt lgkmcnt(3)
  v_mfma_f32_16x16x32_bf16 v[112:115], v[96:99], v[24:27], 0
  v_mfma_f32_16x16x32_bf16 v[116:119], v[96:99], v[40:43], 0
  v_mfma_f32_16x16x32_bf16 v[120:123], v[96:99], v[80:83], 0
  s_waitcnt lgkmcnt(2)
  v_mfma_f32_16x16x32_bf16 v[112:115], v[100:103], v[28:31], v[112:115]
  v_mfma_f32_16x16x32_bf16 v[116:119], v[100:103], v[44:47], v[116:119]
  v_mfma_f32_16x16x32_bf16 v[120:123], v[100:103], v[84:87], v[120:123]
  s_waitcnt lgkmcnt(1)
  v_mfma_f32_16x16x32_bf16 v[112:115], v[104:107], v[32:35], v[112:115]
  v_mfma_f32_16x16x32_bf16 v[116:119], v[104:107], v[72:75], v[116:119]
  v_mfma_f32_16x16x32_bf16 v[120:123], v[104:107], v[88:91], v[120:123]
  s_waitcnt lgkmcnt(0)
  v_mfma_f32_16x16x32_bf16 v[112:115], v[108:111], v[36:39], v[112:115]
  v_mfma_f32_16x16x32_bf16 v[116:119], v[108:111], v[76:79], v[116:119]
  v_mfma_f32_16x16x32_bf16 v[120:123], v[108:111], v[92:95], v[120:123]
  ds_write_b32 v21, v22
  v_mbcnt_lo_u32_b32 v21, -1, 0
  v_mbcnt_hi_u32_b32 v21, -1, v21
  v_lshrrev_b32 v21, 4, v21
  v_lshl_add_u32 v21, v21, 3, v15
  s_nop 4
  v_max3_f32 v66, v112, v113, v114
  v_max_f32 v66, v66, v115
  v_max3_f32 v67, v116, v117, v118
  v_max_f32 v67, v67, v119
  v_max3_f32 v68, v120, v121, v122
  v_max_f32 v68, v68, v123
  v_mov_b32 v69, v68
  s_nop 1
  v_permlane32_swap_b32 v66, v67
  v_permlane32_swap_b32 v68, v69
  s_nop 1
  v_max_f32 v66, v66, v67
  v_max_f32 v68, v68, v69
  s_nop 1
  v_permlane16_swap_b32 v66, v68
  s_nop 1
  v_max_f32 v66, v66, v68
  ds_write_b32 v14, v66
  s_cmp_eq_u32 s98, 0
  s_cbranch_scc1 L_h85
  s_waitcnt vmcnt(12) lgkmcnt(0)
  s_branch L_h86
L_h85:
  s_waitcnt vmcnt(4) lgkmcnt(0)
L_h86:
  s_barrier
  ds_read_b64 v[60:61], v21 offset:0
  ds_read_b64 v[62:63], v21 offset:512
  ds_read_b64 v[64:65], v21 offset:1024
  ds_read_b128 v[96:99], v16
  ds_read_b128 v[100:103], v17
  ds_read_b128 v[104:107], v18
  ds_read_b128 v[108:111], v19
  s_cmp_eq_u32 s98, 0
  s_cbranch_scc0 L_sk87
  s_bitcmp1_b32 s3, 2
  s_cselect_b32 s90, s89, 0
  s_cselect_b32 s42, 4096, 0
  s_add_u32 s90, s90, s94
  s_add_u32 s42, s42, s97
  s_add_u32 m0, s42, 0
  s_nop 0
  buffer_load_dwordx4 v0, s[84:87], s90 offen nt lds
  s_add_u32 m0, s42, 8192
  s_add_u32 s90, s90, s96
  buffer_load_dwordx4 v0, s[84:87], s90 offen nt lds
  s_add_u32 m0, s42, 16384
  s_add_u32 s90, s90, s96
  buffer_load_dwordx4 v0, s[84:87], s90 offen nt lds
  s_add_u32 m0, s42, 24576
  s_add_u32 s90, s90, s96
  buffer_load_dwordx4 v0, s[84:87], s90 offen nt lds
L_sk87:
  s_add_u32 s5, s4, s62
  s_add_u32 s4, s4, 32768
  s_cmp_eq_u32 s4, 98304
  s_cselect_b32 s4, 0, s4
  s_and_b32 s72, s7, 0xffffff00
  s_and_b32 s73, s7, 7
  s_add_u32 s6, s6, 1
  s_lshl_b32 m0, s73, 2
  s_mul_i32 s42, s73, 5
  s_movrels_b64 s[80:81], s[8:9]
  s_movrels_b32 s82, s10
  v_readlane_b32 s7, v1, s6
  s_lshr_b32 s43, 0xd5210d, s42
  s_lshr_b32 s42, 0x8435b2, s42
  v_lshl_add_u32 v4, v2, s43, v3
  s_lshl_b32 s74, 1, s42
  s_lshl_b32 s88, 16, s43
  v_add_u32 v20, s4, v7
  v_xor_b32 v16, 0, v20
  v_xor_b32 v17, 64, v20
  v_xor_b32 v18, 128, v20
  v_xor_b32 v19, 192, v20
  s_waitcnt lgkmcnt(3)
  v_mfma_f32_16x16x32_bf16 v[124:127], v[96:99], v[24:27], 0
  v_max_f32 v60, v60, v61
  v_max_f32 v62, v62, v63
  v_max_f32 v64, v64, v65
  v_mov_b32 v61, v60
  v_mov_b32 v63, v62
  v_mov_b32 v65, v64
  s_nop 1
  v_permlane32_swap_b32 v60, v61
  v_permlane32_swap_b32 v62, v63
  v_permlane32_swap_b32 v64, v65
  s_nop 1
  v_max_f32 v60, v60, v61
  v_max_f32 v62, v62, v63
  v_max_f32 v64, v64, v65
  v_mov_b32 v61, v60
  v_mov_b32 v63, v62
  v_mov_b32 v65, v64
  s_nop 1
  v_permlane16_swap_b32 v60, v61
  v_permlane16_swap_b32 v62, v63
  v_permlane16_swap_b32 v64, v65
  s_nop 1
  v_max_f32 v60, v60, v61
  v_max_f32 v62, v62, v63
  v_max_f32 v64, v64, v65
  v_mfma_f32_16x16x32_bf16 v[128:131], v[96:99], v[40:43], 0
  v_pk_add_f32 v[112:113], v[112:113], v[60:61] op_sel_hi:[1,0] neg_lo:[0,1] neg_hi:[0,1]
  v_pk_add_f32 v[114:115], v[114:115], v[60:61] op_sel_hi:[1,0] neg_lo:[0,1] neg_hi:[0,1]
  v_pk_add_f32 v[116:117], v[116:117], v[62:63] op_sel_hi:[1,0] neg_lo:[0,1] neg_hi:[0,1]
  v_mfma_f32_16x16x32_bf16 v[132:135], v[96:99], v[80:83], 0
  v_pk_add_f32 v[118:119], v[118:119], v[62:63] op_sel_hi:[1,0] neg_lo:[0,1] neg_hi:[0,1]
  v_pk_add_f32 v[120:121], v[120:121], v[64:65] op_sel_hi:[1,0] neg_lo:[0,1] neg_hi:[0,1]
  v_pk_add_f32 v[122:123], v[122:123], v[64:65] op_sel_hi:[1,0] neg_lo:[0,1] neg_hi:[0,1]
  s_waitcnt lgkmcnt(2)
  v_mfma_f32_16x16x32_bf16 v[124:127], v[100:103], v[28:31], v[124:127]
  v_exp_f32 v112, v112
  v_exp_f32 v113, v113
  v_exp_f32 v114, v114
  v_mfma_f32_16x16x32_bf16 v[128:131], v[100:103], v[44:47], v[128:131]
  v_exp_f32 v115, v115
  v_exp_f32 v116, v116
  v_exp_f32 v117, v117
  v_mfma_f32_16x16x32_bf16 v[132:135], v[100:103], v[84:87], v[132:135]
  v_exp_f32 v118, v118
  v_exp_f32 v119, v119
  v_exp_f32 v120, v120
  s_waitcnt lgkmcnt(1)
  v_mfma_f32_16x16x32_bf16 v[124:127], v[104:107], v[32:35], v[124:127]
  v_exp_f32 v121, v121
  v_exp_f32 v122, v122
  v_exp_f32 v123, v123
  v_mfma_f32_16x16x32_bf16 v[128:131], v[104:107], v[72:75], v[128:131]
  v_cvt_pk_bf16_f32 v112, v112, v113
  v_cvt_pk_bf16_f32 v113, v114, v115
  v_cvt_pk_bf16_f32 v116, v116, v117
  v_mfma_f32_16x16x32_bf16 v[132:135], v[104:107], v[88:91], v[132:135]
  v_cvt_pk_bf16_f32 v117, v118, v119
  v_cvt_pk_bf16_f32 v120, v120, v121
  v_cvt_pk_bf16_f32 v121, v122, v123
  s_waitcnt lgkmcnt(0)
  v_mfma_f32_16x16x32_bf16 v[124:127], v[108:111], v[36:39], v[124:127]
  v_mfma_f32_16x16x32_bf16 v[128:131], v[108:111], v[76:79], v[128:131]
  v_mfma_f32_16x16x32_bf16 v[132:135], v[108:111], v[92:95], v[132:135]
  s_cmp_eq_u32 s59, 3
  s_cbranch_scc1 L_pe89
  ds_write_b64 v13, v[112:113] offset:0
  ds_write_b64 v13, v[116:117] offset:4096
  ds_write_b64 v13, v[120:121] offset:8192
L_pe89:
  s_waitcnt vmcnt(4) lgkmcnt(0)
  s_barrier
  ds_read_b128 v[96:99], v16
  ds_read_b128 v[100:103], v17
  ds_read_b128 v[104:107], v18
  ds_read_b128 v[108:111], v19
  s_bitcmp1_b32 s3, 2
  s_cselect_b32 s90, s88, 0
  s_cselect_b32 s42, 4096, 0
  s_add_u32 s90, s90, s72
  s_add_u32 s42, s42, s5
  s_bitcmp1_b32 6, s73
  s_cbranch_scc1 L_kv91
  s_add_u32 m0, s42, 0
  s_nop 0
  buffer_load_dwordx4 v4, s[80:83], s90 offen lds
  s_add_u32 m0, s42, 8192
  s_add_u32 s90, s90, s74
  buffer_load_dwordx4 v4, s[80:83], s90 offen lds
  s_add_u32 m0, s42, 16384
  s_add_u32 s90, s90, s74
  buffer_load_dwordx4 v4, s[80:83], s90 offen lds
  s_add_u32 m0, s42, 24576
  s_add_u32 s90, s90, s74
  buffer_load_dwordx4 v4, s[80:83], s90 offen lds
  s_branch L_sk90
L_kv91:
  s_add_u32 m0, s42, 0
  s_nop 0
  buffer_load_dwordx4 v4, s[80:83], s90 offen nt lds
  s_add_u32 m0, s42, 8192
  s_add_u32 s90, s90, s74
  buffer_load_dwordx4 v4, s[80:83], s90 offen nt lds
  s_add_u32 m0, s42, 16384
  s_add_u32 s90, s90, s74
  buffer_load_dwordx4 v4, s[80:83], s90 offen nt lds
  s_add_u32 m0, s42, 24576
  s_add_u32 s90, s90, s74
  buffer_load_dwordx4 v4, s[80:83], s90 offen nt lds
L_sk90:
  s_add_u32 s97, s4, s62
  s_add_u32 s4, s4, 32768
  s_cmp_eq_u32 s4, 98304
  s_cselect_b32 s4, 0, s4
  s_and_b32 s94, s7, 0xffffff00
  s_and_b32 s95, s7, 7
  s_add_u32 s6, s6, 1
  s_lshl_b32 m0, s95, 2
  s_mul_i32 s42, s95, 5
  s_movrels_b64 s[84:85], s[8:9]
  s_movrels_b32 s86, s10
  v_readlane_b32 s7, v1, s6
  s_lshr_b32 s43, 0xd5210d, s42
  s_lshr_b32 s42, 0x8435b2, s42
  v_lshl_add_u32 v0, v2, s43, v3
  s_lshl_b32 s96, 1, s42
  s_lshl_b32 s89, 16, s43
  v_add_u32 v20, s4, v7
  v_xor_b32 v16, 0, v20
  v_xor_b32 v17, 64, v20
  v_xor_b32 v18, 128, v20
  v_xor_b32 v19, 192, v20
  s_waitcnt lgkmcnt(3)
  v_mfma_f32_16x16x32_bf16 v[136:139], v[96:99], v[24:27], 0
  v_pk_add_f32 v[124:125], v[124:125], v[60:61] op_sel_hi:[1,0] neg_lo:[0,1] neg_hi:[0,1]
  v_pk_add_f32 v[126:127], v[126:127], v[60:61] op_sel_hi:[1,0] neg_lo:[0,1] neg_hi:[0,1]
  v_pk_add_f32 v[128:129], v[128:129], v[62:63] op_sel_hi:[1,0] neg_lo:[0,1] neg_hi:[0,1]
  v_mfma_f32_16x16x32_bf16 v[140:143], v[96:99], v[40:43], 0
  v_pk_add_f32 v[130:131], v[130:131], v[62:63] op_sel_hi:[1,0] neg_lo:[0,1] neg_hi:[0,1]
  v_pk_add_f32 v[132:133], v[132:133], v[64:65] op_sel_hi:[1,0] neg_lo:[0,1] neg_hi:[0,1]
  v_pk_add_f32 v[134:135], v[134:135], v[64:65] op_sel_hi:[1,0] neg_lo:[0,1] neg_hi:[0,1]
  v_mfma_f32_16x16x32_bf16 v[144:147], v[96:99], v[80:83], 0
  v_max3_f32 v21, v124, v125, v126
  v_max3_f32 v21, v21, v127, v128
  v_max3_f32 v21, v21, v129, v130
  s_waitcnt lgkmcnt(2)
  v_mfma_f32_16x16x32_bf16 v[136:139], v[100:103], v[28:31], v[136:139]
  v_max3_f32 v21, v21, v131, v132
  v_max3_f32 v21, v21, v133, v134
  v_max_f32 v21, v21, v135
  v_mfma_f32_16x16x32_bf16 v[140:143], v[100:103], v[44:47], v[140:143]
  v_cmp_lt_f32 vcc, s64, v21
  s_cbranch_vccnz L_rb1
L_nb1:
  v_exp_f32 v124, v124
  v_exp_f32 v125, v125
  v_mfma_f32_16x16x32_bf16 v[144:147], v[100:103], v[84:87], v[144:147]
  v_exp_f32 v126, v126
  v_exp_f32 v127, v127
  v_exp_f32 v128, v128
  s_waitcnt lgkmcnt(1)
  v_mfma_f32_16x16x32_bf16 v[136:139], v[104:107], v[32:35], v[136:139]
  v_exp_f32 v129, v129
  v_exp_f32 v130, v130
  v_exp_f32 v131, v131
  v_mfma_f32_16x16x32_bf16 v[140:143], v[104:107], v[72:75], v[140:143]
  v_exp_f32 v132, v132
  v_exp_f32 v133, v133
  v_exp_f32 v134, v134
  v_mfma_f32_16x16x32_bf16 v[144:147], v[104:107], v[88:91], v[144:147]
  v_exp_f32 v135, v135
  v_cvt_pk_bf16_f32 v124, v124, v125
  v_cvt_pk_bf16_f32 v125, v126, v127
  s_waitcnt lgkmcnt(0)
  v_mfma_f32_16x16x32_bf16 v[136:139], v[108:111], v[36:39], v[136:139]
  v_cvt_pk_bf16_f32 v128, v128, v129
  v_cvt_pk_bf16_f32 v129, v130, v131
  v_cvt_pk_bf16_f32 v132, v132, v133
  v_mfma_f32_16x16x32_bf16 v[140:143], v[108:111], v[76:79], v[140:143]
  v_cvt_pk_bf16_f32 v133, v134, v135
  v_mfma_f32_16x16x32_bf16 v[144:147], v[108:111], v[92:95], v[144:147]
  s_cmp_eq_u32 s59, 3
  s_cbranch_scc1 L_pe92
  ds_write_b64 v13, v[124:125] offset:12288
  ds_write_b64 v13, v[128:129] offset:16384
  ds_write_b64 v13, v[132:133] offset:20480
L_pe92:
  s_waitcnt vmcnt(4) lgkmcnt(0)
  s_barrier
  ds_read_b128 v[96:99], v16
  ds_read_b128 v[100:103], v17
  ds_read_b128 v[104:107], v18
  ds_read_b128 v[108:111], v19
  s_bitcmp1_b32 s3, 2
  s_cselect_b32 s90, s89, 0
  s_cselect_b32 s42, 4096, 0
  s_add_u32 s90, s90, s94
  s_add_u32 s42, s42, s97
  s_bitcmp1_b32 6, s95
  s_cbranch_scc1 L_kv94
  s_add_u32 m0, s42, 0
  s_nop 0
  buffer_load_dwordx4 v0, s[84:87], s90 offen lds
  s_add_u32 m0, s42, 8192
  s_add_u32 s90, s90, s96
  buffer_load_dwordx4 v0, s[84:87], s90 offen lds
  s_add_u32 m0, s42, 16384
  s_add_u32 s90, s90, s96
  buffer_load_dwordx4 v0, s[84:87], s90 offen lds
  s_add_u32 m0, s42, 24576
  s_add_u32 s90, s90, s96
  buffer_load_dwordx4 v0, s[84:87], s90 offen lds
  s_branch L_sk93
L_kv94:
  s_add_u32 m0, s42, 0
  s_nop 0
  buffer_load_dwordx4 v0, s[84:87], s90 offen nt lds
  s_add_u32 m0, s42, 8192
  s_add_u32 s90, s90, s96
  buffer_load_dwordx4 v0, s[84:87], s90 offen nt lds
  s_add_u32 m0, s42, 16384
  s_add_u32 s90, s90, s96
  buffer_load_dwordx4 v0, s[84:87], s90 offen nt lds
  s_add_u32 m0, s42, 24576
  s_add_u32 s90, s90, s96
  buffer_load_dwordx4 v0, s[84:87], s90 offen nt lds
L_sk93:
  s_add_u32 s5, s4, s62
  s_add_u32 s4, s4, 32768
  s_cmp_eq_u32 s4, 98304
  s_cselect_b32 s4, 0, s4
  s_and_b32 s72, s7, 0xffffff00
  s_and_b32 s73, s7, 7
  s_add_u32 s6, s6, 1
  s_lshl_b32 m0, s73, 2
  s_mul_i32 s42, s73, 5
  s_movrels_b64 s[80:81], s[8:9]
  s_movrels_b32 s82, s10
  v_readlane_b32 s7, v1, s6
  s_lshr_b32 s43, 0xd5210d, s42
  s_lshr_b32 s42, 0x8435b2, s42
  v_lshl_add_u32 v4, v2, s43, v3
  s_lshl_b32 s74, 1, s42
  s_lshl_b32 s88, 16, s43
  s_waitcnt lgkmcnt(3)
  v_mfma_f32_16x16x32_bf16 v[148:151], v[96:99], v[24:27], 0
  v_pk_add_f32 v[136:137], v[136:137], v[60:61] op_sel_hi:[1,0] neg_lo:[0,1] neg_hi:[0,1]
  v_pk_add_f32 v[138:139], v[138:139], v[60:61] op_sel_hi:[1,0] neg_lo:[0,1] neg_hi:[0,1]
  v_pk_add_f32 v[140:141], v[140:141], v[62:63] op_sel_hi:[1,0] neg_lo:[0,1] neg_hi:[0,1]
  v_mfma_f32_16x16x32_bf16 v[152:155], v[96:99], v[40:43], 0
  v_pk_add_f32 v[142:143], v[142:143], v[62:63] op_sel_hi:[1,0] neg_lo:[0,1] neg_hi:[0,1]
  v_pk_add_f32 v[144:145], v[144:145], v[64:65] op_sel_hi:[1,0] neg_lo:[0,1] neg_hi:[0,1]
  v_pk_add_f32 v[146:147], v[146:147], v[64:65] op_sel_hi:[1,0] neg_lo:[0,1] neg_hi:[0,1]
  v_mfma_f32_16x16x32_bf16 v[156:159], v[96:99], v[80:83], 0
  v_max3_f32 v21, v136, v137, v138
  v_max3_f32 v21, v21, v139, v140
  v_max3_f32 v21, v21, v141, v142
  s_waitcnt lgkmcnt(2)
  v_mfma_f32_16x16x32_bf16 v[148:151], v[100:103], v[28:31], v[148:151]
  v_max3_f32 v21, v21, v143, v144
  v_max3_f32 v21, v21, v145, v146
  v_max_f32 v21, v21, v147
  v_mfma_f32_16x16x32_bf16 v[152:155], v[100:103], v[44:47], v[152:155]
  v_cmp_lt_f32 vcc, s64, v21
  s_cbranch_vccnz L_rb2
L_nb2:
  v_exp_f32 v136, v136
  v_exp_f32 v137, v137
  v_mfma_f32_16x16x32_bf16 v[156:159], v[100:103], v[84:87], v[156:159]
  v_exp_f32 v138, v138
  v_exp_f32 v139, v139
  v_exp_f32 v140, v140
  s_waitcnt lgkmcnt(1)
  v_mfma_f32_16x16x32_bf16 v[148:151], v[104:107], v[32:35], v[148:151]
  v_exp_f32 v141, v141
  v_exp_f32 v142, v142
  v_exp_f32 v143, v143
  v_mfma_f32_16x16x32_bf16 v[152:155], v[104:107], v[72:75], v[152:155]
  v_exp_f32 v144, v144
  v_exp_f32 v145, v145
  v_exp_f32 v146, v146
  v_mfma_f32_16x16x32_bf16 v[156:159], v[104:107], v[88:91], v[156:159]
  v_exp_f32 v147, v147
  v_cvt_pk_bf16_f32 v136, v136, v137
  v_cvt_pk_bf16_f32 v137, v138, v139
  s_waitcnt lgkmcnt(0)
  v_mfma_f32_16x16x32_bf16 v[148:151], v[108:111], v[36:39], v[148:151]
  v_cvt_pk_bf16_f32 v140, v140, v141
  v_cvt_pk_bf16_f32 v141, v142, v143
  v_cvt_pk_bf16_f32 v144, v144, v145
  v_mfma_f32_16x16x32_bf16 v[152:155], v[108:111], v[76:79], v[152:155]
  v_cvt_pk_bf16_f32 v145, v146, v147
  v_mfma_f32_16x16x32_bf16 v[156:159], v[108:111], v[92:95], v[156:159]
  s_cmp_eq_u32 s59, 3
  s_cbranch_scc1 L_pe95
  ds_write_b64 v13, v[136:137] offset:24576
  ds_write_b64 v13, v[140:141] offset:28672
  ds_write_b64 v13, v[144:145] offset:32768
L_pe95:
  v_mov_b32 v20, 162816
  s_nop 6
  v_pk_add_f32 v[148:149], v[148:149], v[60:61] op_sel_hi:[1,0] neg_lo:[0,1] neg_hi:[0,1]
  v_pk_add_f32 v[150:151], v[150:151], v[60:61] op_sel_hi:[1,0] neg_lo:[0,1] neg_hi:[0,1]
  v_pk_add_f32 v[152:153], v[152:153], v[62:63] op_sel_hi:[1,0] neg_lo:[0,1] neg_hi:[0,1]
  v_pk_add_f32 v[154:155], v[154:155], v[62:63] op_sel_hi:[1,0] neg_lo:[0,1] neg_hi:[0,1]
  v_pk_add_f32 v[156:157], v[156:157], v[64:65] op_sel_hi:[1,0] neg_lo:[0,1] neg_hi:[0,1]
  v_pk_add_f32 v[158:159], v[158:159], v[64:65] op_sel_hi:[1,0] neg_lo:[0,1] neg_hi:[0,1]
  v_max3_f32 v21, v148, v149, v150
  v_max3_f32 v21, v21, v151, v152
  v_max3_f32 v21, v21, v153, v154
  v_max3_f32 v21, v21, v155, v156
  v_max3_f32 v21, v21, v157, v158
  v_max_f32 v21, v21, v159
  v_cmp_lt_f32 vcc, s64, v21
  s_cbranch_vccnz L_rb3
L_nb3:
  v_exp_f32 v148, v148
  v_exp_f32 v149, v149
  v_exp_f32 v150, v150
  v_exp_f32 v151, v151
  v_exp_f32 v152, v152
  v_exp_f32 v153, v153
  v_exp_f32 v154, v154
  v_exp_f32 v155, v155
  v_exp_f32 v156, v156
  v_exp_f32 v157, v157
  v_exp_f32 v158, v158
  v_exp_f32 v159, v159
  v_cvt_pk_bf16_f32 v148, v148, v149
  v_cvt_pk_bf16_f32 v149, v150, v151
  v_cvt_pk_bf16_f32 v152, v152, v153
  v_cvt_pk_bf16_f32 v153, v154, v155
  v_cvt_pk_bf16_f32 v156, v156, v157
  v_cvt_pk_bf16_f32 v157, v158, v159
  s_and_b32 s98, s59, 2
  s_lshl_b32 s101, s98, 1
  s_mov_b32 s75, 0
  s_mov_b32 s79, 0
  s_cmp_eq_u32 s59, 3
  s_cbranch_scc1 L_first
  ds_write_b64 v13, v[148:149] offset:36864
  ds_write_b64 v13, v[152:153] offset:40960
  ds_write_b64 v13, v[156:157] offset:45056
  s_mov_b32 s65, 0
  s_waitcnt vmcnt(4) lgkmcnt(0)
  s_barrier
  s_bitcmp1_b32 s3, 2
  s_cbranch_scc0 L_pv_body
  ds_read_b32 v21, v20
  s_waitcnt lgkmcnt(0)
  v_cmp_ne_u32 vcc, 0, v21
  s_cbranch_vccz L_ld_ok
  s_call_b64 s[92:93], L_bfix
L_ld_ok:
  s_add_u32 m0, s5, 0
  s_add_u32 s90, s72, s88
  buffer_load_dwordx4 v4, s[80:83], s72 offen nt lds
  s_add_u32 m0, m0, 4096
  s_nop 0
  buffer_load_dwordx4 v4, s[80:83], s90 offen nt lds
L_sk96:
  s_add_u32 s72, s72, s74
  s_add_u32 m0, s5, 8192
  s_add_u32 s90, s72, s88
  buffer_load_dwordx4 v4, s[80:83], s72 offen nt lds
  s_add_u32 m0, m0, 4096
  s_nop 0
  buffer_load_dwordx4 v4, s[80:83], s90 offen nt lds
L_sk97:
  s_add_u32 s72, s72, s74
  s_add_u32 m0, s5, 16384
  s_add_u32 s90, s72, s88
  buffer_load_dwordx4 v4, s[80:83], s72 offen nt lds
  s_add_u32 m0, m0, 4096
  s_nop 0
  buffer_load_dwordx4 v4, s[80:83], s90 offen nt lds
L_sk98:
  s_add_u32 s72, s72, s74
  s_add_u32 m0, s5, 24576
  s_add_u32 s90, s72, s88
  buffer_load_dwordx4 v4, s[80:83], s72 offen nt lds
  s_add_u32 m0, m0, 4096
  s_nop 0
  buffer_load_dwordx4 v4, s[80:83], s90 offen nt lds
L_sk99:
  s_mov_b32 s70, 0
  s_call_b64 s[92:93], L_load2
  s_branch L_pv_done
L_first:
  s_waitcnt lgkmcnt(0)
  s_barrier
  ds_read_b32 v21, v20
  s_waitcnt lgkmcnt(0)
  v_cmp_ne_u32 vcc, 0, v21
  s_cbranch_vccz L_f_ok
  s_call_b64 s[92:93], L_bfix
L_f_ok:
  s_mov_b32 s101, 0
  s_bitcmp1_b32 s3, 2
  s_cbranch_scc1 L_f_ld
  s_waitcnt vmcnt(0)
  s_branch L_f_go
L_f_ld:
  s_add_u32 m0, s5, 0
  s_add_u32 s90, s72, s88
  buffer_load_dwordx4 v4, s[80:83], s72 offen lds
  s_add_u32 m0, m0, 4096
  s_nop 0
  buffer_load_dwordx4 v4, s[80:83], s90 offen lds
L_sk100:
  s_add_u32 s72, s72, s74
  s_add_u32 m0, s5, 8192
  s_add_u32 s90, s72, s88
  buffer_load_dwordx4 v4, s[80:83], s72 offen lds
  s_add_u32 m0, m0, 4096
  s_nop 0
  buffer_load_dwordx4 v4, s[80:83], s90 offen lds
L_sk101:
  s_add_u32 s72, s72, s74
  s_add_u32 m0, s5, 16384
  s_add_u32 s90, s72, s88
  buffer_load_dwordx4 v4, s[80:83], s72 offen lds
  s_add_u32 m0, m0, 4096
  s_nop 0
  buffer_load_dwordx4 v4, s[80:83], s90 offen lds
L_sk102:
  s_add_u32 s72, s72, s74
  s_add_u32 m0, s5, 24576
  s_add_u32 s90, s72, s88
  buffer_load_dwordx4 v4, s[80:83], s72 offen lds
  s_add_u32 m0, m0, 4096
  s_nop 0
  buffer_load_dwordx4 v4, s[80:83], s90 offen lds
L_sk103:
  s_waitcnt vmcnt(12)
L_f_go:
  s_mov_b32 s65, 0
  s_call_b64 s[92:93], L_qproj
  v_mov_b64 v[48:49], v[24:25]
  v_mov_b64 v[50:51], v[26:27]
  v_mov_b64 v[52:53], v[28:29]
  v_mov_b64 v[54:55], v[30:31]
  v_mov_b64 v[56:57], v[32:33]
  v_mov_b64 v[58:59], v[34:35]
  s_mov_b32 s65, 2
  s_call_b64 s[92:93], L_qproj
  v_mov_b64 v[60:61], v[24:25]
  v_mov_b64 v[62:63], v[26:27]
  v_mov_b64 v[64:65], v[28:29]
  v_mov_b64 v[66:67], v[30:31]
  v_mov_b64 v[68:69], v[32:33]
  v_mov_b64 v[70:71], v[34:35]
  s_barrier
  ds_write_b64 v13, v[112:113] offset:0
  ds_write_b64 v13, v[116:117] offset:4096
  ds_write_b64 v13, v[120:121] offset:8192
  ds_write_b64 v13, v[124:125] offset:12288
  ds_write_b64 v13, v[128:129] offset:16384
  ds_write_b64 v13, v[132:133] offset:20480
  ds_write_b64 v13, v[136:137] offset:24576
  ds_write_b64 v13, v[140:141] offset:28672
  ds_write_b64 v13, v[144:145] offset:32768
  ds_write_b64 v13, v[148:149] offset:36864
  ds_write_b64 v13, v[152:153] offset:40960
  ds_write_b64 v13, v[156:157] offset:45056
  s_mov_b32 s79, 1
  s_mov_b32 s65, 0
  s_mov_b32 s101, 4
  v_mov_b32 v20, 162816
  s_waitcnt vmcnt(8) lgkmcnt(0)
  s_barrier
  s_bitcmp1_b32 s3, 2
  s_cbranch_scc1 L_ld_ok
L_pv_body:
  v_add_u32 v16, s4, v5
  v_xor_b32 v17, 32, v16
  ds_read_b32 v21, v20
  ds_read_b64_tr_b16 v[72:73], v16 offset:0
  ds_read_b64_tr_b16 v[74:75], v16 offset:1024
  ds_read_b64_tr_b16 v[76:77], v17 offset:0
  ds_read_b64_tr_b16 v[78:79], v17 offset:1024
  ds_read_b128 v[80:83], v8 offset:0
  ds_read_b128 v[84:87], v8 offset:4096
  ds_read_b128 v[88:91], v8 offset:8192
  ds_read_b64_tr_b16 v[92:93], v16 offset:8192
  ds_read_b64_tr_b16 v[94:95], v16 offset:9216
  ds_read_b64_tr_b16 v[96:97], v17 offset:8192
  ds_read_b64_tr_b16 v[98:99], v17 offset:9216
  ds_read_b128 v[100:103], v9 offset:0
  ds_read_b128 v[104:107], v9 offset:4096
  ds_read_b128 v[108:111], v9 offset:8192
  s_waitcnt lgkmcnt(7)
  v_cmp_ne_u32 vcc, 0, v21
  s_cbranch_vccnz L_pv_fix
L_pv_go:
  v_mov_b32 v144, 0x3f803f80
  v_mov_b32 v145, 0x3f803f80
  v_mov_b32 v146, 0x3f803f80
  v_mov_b32 v147, 0x3f803f80
  s_nop 1
  v_mfma_f32_16x16x32_bf16 v[24:27], v[72:75], v[80:83], 0
  s_add_u32 s4, s4, 32768
  v_mfma_f32_16x16x32_bf16 v[28:31], v[72:75], v[84:87], 0
  s_cmp_eq_u32 s4, 98304
  s_cselect_b32 s4, 0, s4
  v_mfma_f32_16x16x32_bf16 v[32:35], v[72:75], v[88:91], 0
  v_add_u32 v18, s4, v5
  v_mfma_f32_16x16x32_bf16 v[36:39], v[76:79], v[80:83], 0
  v_xor_b32 v19, 32, v18
  v_mfma_f32_16x16x32_bf16 v[40:43], v[76:79], v[84:87], 0
  v_mfma_f32_16x16x32_bf16 v[44:47], v[76:79], v[88:91], 0
  v_mfma_f32_16x16x32_bf16 v[148:151], v[144:147], v[80:83], 0
  v_mfma_f32_16x16x32_bf16 v[152:155], v[144:147], v[84:87], 0
  v_mfma_f32_16x16x32_bf16 v[156:159], v[144:147], v[88:91], 0
  ds_read_b64_tr_b16 v[72:73], v16 offset:16384
  ds_read_b64_tr_b16 v[74:75], v16 offset:17408
  ds_read_b64_tr_b16 v[76:77], v17 offset:16384
  ds_read_b64_tr_b16 v[78:79], v17 offset:17408
  ds_read_b128 v[80:83], v10 offset:0
  ds_read_b128 v[84:87], v10 offset:4096
  ds_read_b128 v[88:91], v10 offset:8192
  s_waitcnt lgkmcnt(7)
  v_mfma_f32_16x16x32_bf16 v[24:27], v[92:95], v[100:103], v[24:27]
  v_mfma_f32_16x16x32_bf16 v[28:31], v[92:95], v[104:107], v[28:31]
  v_mfma_f32_16x16x32_bf16 v[32:35], v[92:95], v[108:111], v[32:35]
  v_mfma_f32_16x16x32_bf16 v[36:39], v[96:99], v[100:103], v[36:39]
  v_mfma_f32_16x16x32_bf16 v[40:43], v[96:99], v[104:107], v[40:43]
  v_mfma_f32_16x16x32_bf16 v[44:47], v[96:99], v[108:111], v[44:47]
  v_mfma_f32_16x16x32_bf16 v[148:151], v[144:147], v[100:103], v[148:151]
  v_mfma_f32_16x16x32_bf16 v[152:155], v[144:147], v[104:107], v[152:155]
  v_mfma_f32_16x16x32_bf16 v[156:159], v[144:147], v[108:111], v[156:159]
  ds_read_b64_tr_b16 v[92:93], v16 offset:24576
  ds_read_b64_tr_b16 v[94:95], v16 offset:25600
  ds_read_b64_tr_b16 v[96:97], v17 offset:24576
  ds_read_b64_tr_b16 v[98:99], v17 offset:25600
  ds_read_b128 v[100:103], v11 offset:0
  ds_read_b128 v[104:107], v11 offset:4096
  ds_read_b128 v[108:111], v11 offset:8192
  s_waitcnt lgkmcnt(7)
  v_mfma_f32_16x16x32_bf16 v[24:27], v[72:75], v[80:83], v[24:27]
  v_mfma_f32_16x16x32_bf16 v[28:31], v[72:75], v[84:87], v[28:31]
  v_mfma_f32_16x16x32_bf16 v[32:35], v[72:75], v[88:91], v[32:35]
  v_mfma_f32_16x16x32_bf16 v[36:39], v[76:79], v[80:83], v[36:39]
  v_mfma_f32_16x16x32_bf16 v[40:43], v[76:79], v[84:87], v[40:43]
  v_mfma_f32_16x16x32_bf16 v[44:47], v[76:79], v[88:91], v[44:47]
  v_mfma_f32_16x16x32_bf16 v[148:151], v[144:147], v[80:83], v[148:151]
  v_mfma_f32_16x16x32_bf16 v[152:155], v[144:147], v[84:87], v[152:155]
  v_mfma_f32_16x16x32_bf16 v[156:159], v[144:147], v[88:91], v[156:159]
  s_waitcnt vmcnt(0) lgkmcnt(0)
  s_barrier
  ds_read_b64_tr_b16 v[72:73], v18 offset:0
  ds_read_b64_tr_b16 v[74:75], v18 offset:1024
  ds_read_b64_tr_b16 v[76:77], v19 offset:0
  ds_read_b64_tr_b16 v[78:79], v19 offset:1024
  ds_read_b128 v[80:83], v8 offset:12288
  ds_read_b128 v[84:87], v8 offset:16384
  ds_read_b128 v[88:91], v8 offset:20480
  v_mfma_f32_16x16x32_bf16 v[24:27], v[92:95], v[100:103], v[24:27]
  s_add_u32 s4, s4, 32768
  v_mfma_f32_16x16x32_bf16 v[28:31], v[92:95], v[104:107], v[28:31]
  s_cmp_eq_u32 s4, 98304
  s_cselect_b32 s4, 0, s4
  v_mfma_f32_16x16x32_bf16 v[32:35], v[92:95], v[108:111], v[32:35]
  v_add_u32 v16, s4, v5
  v_mfma_f32_16x16x32_bf16 v[36:39], v[96:99], v[100:103], v[36:39]
  v_xor_b32 v17, 32, v16
  v_mfma_f32_16x16x32_bf16 v[40:43], v[96:99], v[104:107], v[40:43]
  v_mfma_f32_16x16x32_bf16 v[44:47], v[96:99], v[108:111], v[44:47]
  v_mfma_f32_16x16x32_bf16 v[148:151], v[144:147], v[100:103], v[148:151]
  v_mfma_f32_16x16x32_bf16 v[152:155], v[144:147], v[104:107], v[152:155]
  v_mfma_f32_16x16x32_bf16 v[156:159], v[144:147], v[108:111], v[156:159]
  ds_read_b64_tr_b16 v[92:93], v18 offset:8192
  ds_read_b64_tr_b16 v[94:95], v18 offset:9216
  ds_read_b64_tr_b16 v[96:97], v19 offset:8192
  ds_read_b64_tr_b16 v[98:99], v19 offset:9216
  ds_read_b128 v[100:103], v9 offset:12288
  ds_read_b128 v[104:107], v9 offset:16384
  ds_read_b128 v[108:111], v9 offset:20480
  s_waitcnt lgkmcnt(7)
  v_mfma_f32_16x16x32_bf16 v[24:27], v[72:75], v[80:83], v[24:27]
  v_mfma_f32_16x16x32_bf16 v[28:31], v[72:75], v[84:87], v[28:31]
  v_mfma_f32_16x16x32_bf16 v[32:35], v[72:75], v[88:91], v[32:35]
  v_mfma_f32_16x16x32_bf16 v[36:39], v[76:79], v[80:83], v[36:39]
  v_mfma_f32_16x16x32_bf16 v[40:43], v[76:79], v[84:87], v[40:43]
  v_mfma_f32_16x16x32_bf16 v[44:47], v[76:79], v[88:91], v[44:47]
  v_mfma_f32_16x16x32_bf16 v[148:151], v[144:147], v[80:83], v[148:151]
  v_mfma_f32_16x16x32_bf16 v[152:155], v[144:147], v[84:87], v[152:155]
  v_mfma_f32_16x16x32_bf16 v[156:159], v[144:147], v[88:91], v[156:159]
  ds_read_b64_tr_b16 v[72:73], v18 offset:16384
  ds_read_b64_tr_b16 v[74:75], v18 offset:17408
  ds_read_b64_tr_b16 v[76:77], v19 offset:16384
  ds_read_b64_tr_b16 v[78:79], v19 offset:17408
  ds_read_b128 v[80:83], v10 offset:12288
  ds_read_b128 v[84:87], v10 offset:16384
  ds_read_b128 v[88:91], v10 offset:20480
  s_waitcnt lgkmcnt(7)
  v_mfma_f32_16x16x32_bf16 v[24:27], v[92:95], v[100:103], v[24:27]
  v_mfma_f32_16x16x32_bf16 v[28:31], v[92:95], v[104:107], v[28:31]
  v_mfma_f32_16x16x32_bf16 v[32:35], v[92:95], v[108:111], v[32:35]
  v_mfma_f32_16x16x32_bf16 v[36:39], v[96:99], v[100:103], v[36:39]
  v_mfma_f32_16x16x32_bf16 v[40:43], v[96:99], v[104:107], v[40:43]
  v_mfma_f32_16x16x32_bf16 v[44:47], v[96:99], v[108:111], v[44:47]
  v_mfma_f32_16x16x32_bf16 v[148:151], v[144:147], v[100:103], v[148:151]
  v_mfma_f32_16x16x32_bf16 v[152:155], v[144:147], v[104:107], v[152:155]
  v_mfma_f32_16x16x32_bf16 v[156:159], v[144:147], v[108:111], v[156:159]
  ds_read_b64_tr_b16 v[92:93], v18 offset:24576
  ds_read_b64_tr_b16 v[94:95], v18 offset:25600
  ds_read_b64_tr_b16 v[96:97], v19 offset:24576
  ds_read_b64_tr_b16 v[98:99], v19 offset:25600
  ds_read_b128 v[100:103], v11 offset:12288
  ds_read_b128 v[104:107], v11 offset:16384
  ds_read_b128 v[108:111], v11 offset:20480
  s_waitcnt lgkmcnt(7)
  v_mfma_f32_16x16x32_bf16 v[24:27], v[72:75], v[80:83], v[24:27]
  v_mfma_f32_16x16x32_bf16 v[28:31], v[72:75], v[84:87], v[28:31]
  v_mfma_f32_16x16x32_bf16 v[32:35], v[72:75], v[88:91], v[32:35]
  v_mfma_f32_16x16x32_bf16 v[36:39], v[76:79], v[80:83], v[36:39]
  v_mfma_f32_16x16x32_bf16 v[40:43], v[76:79], v[84:87], v[40:43]
  v_mfma_f32_16x16x32_bf16 v[44:47], v[76:79], v[88:91], v[44:47]
  v_mfma_f32_16x16x32_bf16 v[148:151], v[144:147], v[80:83], v[148:151]
  v_mfma_f32_16x16x32_bf16 v[152:155], v[144:147], v[84:87], v[152:155]
  v_mfma_f32_16x16x32_bf16 v[156:159], v[144:147], v[88:91], v[156:159]
  s_waitcnt lgkmcnt(0)
  s_barrier
  v_xor_b32 v22, 32, v12
  ds_write_b64 v12, v[48:49] offset:0
  ds_write_b64 v12, v[50:51] offset:4096
  ds_write_b64 v12, v[52:53] offset:8192
  ds_write_b64 v22, v[54:55] offset:0
  ds_write_b64 v22, v[56:57] offset:4096
  ds_write_b64 v22, v[58:59] offset:8192
  ds_read_b64_tr_b16 v[72:73], v16 offset:0
  ds_read_b64_tr_b16 v[74:75], v16 offset:1024
  ds_read_b64_tr_b16 v[76:77], v17 offset:0
  ds_read_b64_tr_b16 v[78:79], v17 offset:1024
  ds_read_b128 v[80:83], v8 offset:24576
  ds_read_b128 v[84:87], v8 offset:28672
  ds_read_b128 v[88:91], v8 offset:32768
  v_mfma_f32_16x16x32_bf16 v[24:27], v[92:95], v[100:103], v[24:27]
  s_add_u32 s4, s4, 32768
  s_cmp_eq_u32 s4, 98304
  s_cselect_b32 s4, 0, s4
  v_mfma_f32_16x16x32_bf16 v[28:31], v[92:95], v[104:107], v[28:31]
  v_add_u32 v18, s4, v5
  v_xor_b32 v19, 32, v18
  v_mfma_f32_16x16x32_bf16 v[32:35], v[92:95], v[108:111], v[32:35]
  v_mfma_f32_16x16x32_bf16 v[36:39], v[96:99], v[100:103], v[36:39]
  v_mfma_f32_16x16x32_bf16 v[40:43], v[96:99], v[104:107], v[40:43]
  v_mfma_f32_16x16x32_bf16 v[44:47], v[96:99], v[108:111], v[44:47]
  v_mfma_f32_16x16x32_bf16 v[148:151], v[144:147], v[100:103], v[148:151]
  v_mfma_f32_16x16x32_bf16 v[152:155], v[144:147], v[104:107], v[152:155]
  v_mfma_f32_16x16x32_bf16 v[156:159], v[144:147], v[108:111], v[156:159]
  ds_read_b64_tr_b16 v[92:93], v16 offset:8192
  ds_read_b64_tr_b16 v[94:95], v16 offset:9216
  ds_read_b64_tr_b16 v[96:97], v17 offset:8192
  ds_read_b64_tr_b16 v[98:99], v17 offset:9216
  ds_read_b128 v[100:103], v9 offset:24576
  ds_read_b128 v[104:107], v9 offset:28672
  ds_read_b128 v[108:111], v9 offset:32768
  s_waitcnt lgkmcnt(7)
  v_mfma_f32_16x16x32_bf16 v[24:27], v[72:75], v[80:83], v[24:27]
  v_mfma_f32_16x16x32_bf16 v[28:31], v[72:75], v[84:87], v[28:31]
  v_mov_b64 v[48:49], v[60:61]
  v_mov_b64 v[50:51], v[62:63]
  v_mfma_f32_16x16x32_bf16 v[32:35], v[72:75], v[88:91], v[32:35]
  v_mov_b64 v[52:53], v[64:65]
  v_mov_b64 v[54:55], v[66:67]
  v_mfma_f32_16x16x32_bf16 v[36:39], v[76:79], v[80:83], v[36:39]
  v_mov_b64 v[56:57], v[68:69]
  v_mov_b64 v[58:59], v[70:71]
  v_mfma_f32_16x16x32_bf16 v[40:43], v[76:79], v[84:87], v[40:43]
  v_mfma_f32_16x16x32_bf16 v[44:47], v[76:79], v[88:91], v[44:47]
  v_mfma_f32_16x16x32_bf16 v[148:151], v[144:147], v[80:83], v[148:151]
  v_mfma_f32_16x16x32_bf16 v[152:155], v[144:147], v[84:87], v[152:155]
  v_mfma_f32_16x16x32_bf16 v[156:159], v[144:147], v[88:91], v[156:159]
  ds_read_b64_tr_b16 v[72:73], v16 offset:16384
  ds_read_b64_tr_b16 v[74:75], v16 offset:17408
  ds_read_b64_tr_b16 v[76:77], v17 offset:16384
  ds_read_b64_tr_b16 v[78:79], v17 offset:17408
  ds_read_b128 v[80:83], v10 offset:24576
  ds_read_b128 v[84:87], v10 offset:28672
  ds_read_b128 v[88:91], v10 offset:32768
  s_waitcnt lgkmcnt(7)
  v_mfma_f32_16x16x32_bf16 v[24:27], v[92:95], v[100:103], v[24:27]
  v_mfma_f32_16x16x32_bf16 v[28:31], v[92:95], v[104:107], v[28:31]
  v_mfma_f32_16x16x32_bf16 v[32:35], v[92:95], v[108:111], v[32:35]
  v_mfma_f32_16x16x32_bf16 v[36:39], v[96:99], v[100:103], v[36:39]
  v_mfma_f32_16x16x32_bf16 v[40:43], v[96:99], v[104:107], v[40:43]
  v_mfma_f32_16x16x32_bf16 v[44:47], v[96:99], v[108:111], v[44:47]
  v_mfma_f32_16x16x32_bf16 v[148:151], v[144:147], v[100:103], v[148:151]
  v_mfma_f32_16x16x32_bf16 v[152:155], v[144:147], v[104:107], v[152:155]
  v_mfma_f32_16x16x32_bf16 v[156:159], v[144:147], v[108:111], v[156:159]
  ds_read_b64_tr_b16 v[92:93], v16 offset:24576
  ds_read_b64_tr_b16 v[94:95], v16 offset:25600
  ds_read_b64_tr_b16 v[96:97], v17 offset:24576
  ds_read_b64_tr_b16 v[98:99], v17 offset:25600
  ds_read_b128 v[100:103], v11 offset:24576
  ds_read_b128 v[104:107], v11 offset:28672
  ds_read_b128 v[108:111], v11 offset:32768
  s_waitcnt lgkmcnt(7)
  v_mfma_f32_16x16x32_bf16 v[24:27], v[72:75], v[80:83], v[24:27]
  v_mfma_f32_16x16x32_bf16 v[28:31], v[72:75], v[84:87], v[28:31]
  v_mfma_f32_16x16x32_bf16 v[32:35], v[72:75], v[88:91], v[32:35]
  v_mfma_f32_16x16x32_bf16 v[36:39], v[76:79], v[80:83], v[36:39]
  v_mfma_f32_16x16x32_bf16 v[40:43], v[76:79], v[84:87], v[40:43]
  v_mfma_f32_16x16x32_bf16 v[44:47], v[76:79], v[88:91], v[44:47]
  v_mfma_f32_16x16x32_bf16 v[148:151], v[144:147], v[80:83], v[148:151]
  v_mfma_f32_16x16x32_bf16 v[152:155], v[144:147], v[84:87], v[152:155]
  v_mfma_f32_16x16x32_bf16 v[156:159], v[144:147], v[88:91], v[156:159]
  s_waitcnt lgkmcnt(0)
  s_barrier
  ds_read_b64_tr_b16 v[72:73], v18 offset:0
  ds_read_b64_tr_b16 v[74:75], v18 offset:1024
  ds_read_b64_tr_b16 v[76:77], v19 offset:0
  ds_read_b64_tr_b16 v[78:79], v19 offset:1024
  ds_read_b128 v[80:83], v8 offset:36864
  ds_read_b128 v[84:87], v8 offset:40960
  ds_read_b128 v[88:91], v8 offset:45056
  v_mfma_f32_16x16x32_bf16 v[24:27], v[92:95], v[100:103], v[24:27]
  s_add_u32 s4, s4, 32768
  v_mfma_f32_16x16x32_bf16 v[28:31], v[92:95], v[104:107], v[28:31]
  s_cmp_eq_u32 s4, 98304
  s_cselect_b32 s4, 0, s4
  v_mfma_f32_16x16x32_bf16 v[32:35], v[92:95], v[108:111], v[32:35]
  v_mfma_f32_16x16x32_bf16 v[36:39], v[96:99], v[100:103], v[36:39]
  v_mfma_f32_16x16x32_bf16 v[40:43], v[96:99], v[104:107], v[40:43]
  v_mfma_f32_16x16x32_bf16 v[44:47], v[96:99], v[108:111], v[44:47]
  v_mfma_f32_16x16x32_bf16 v[148:151], v[144:147], v[100:103], v[148:151]
  v_mfma_f32_16x16x32_bf16 v[152:155], v[144:147], v[104:107], v[152:155]
  v_mfma_f32_16x16x32_bf16 v[156:159], v[144:147], v[108:111], v[156:159]
  ds_read_b64_tr_b16 v[92:93], v18 offset:8192
  ds_read_b64_tr_b16 v[94:95], v18 offset:9216
  ds_read_b64_tr_b16 v[96:97], v19 offset:8192
  ds_read_b64_tr_b16 v[98:99], v19 offset:9216
  ds_read_b128 v[100:103], v9 offset:36864
  ds_read_b128 v[104:107], v9 offset:40960
  ds_read_b128 v[108:111], v9 offset:45056
  s_waitcnt lgkmcnt(7)
  v_mfma_f32_16x16x32_bf16 v[24:27], v[72:75], v[80:83], v[24:27]
  v_mfma_f32_16x16x32_bf16 v[28:31], v[72:75], v[84:87], v[28:31]
  v_mfma_f32_16x16x32_bf16 v[32:35], v[72:75], v[88:91], v[32:35]
  v_mfma_f32_16x16x32_bf16 v[36:39], v[76:79], v[80:83], v[36:39]
  v_mfma_f32_16x16x32_bf16 v[40:43], v[76:79], v[84:87], v[40:43]
  v_mfma_f32_16x16x32_bf16 v[44:47], v[76:79], v[88:91], v[44:47]
  v_mfma_f32_16x16x32_bf16 v[148:151], v[144:147], v[80:83], v[148:151]
  v_mfma_f32_16x16x32_bf16 v[152:155], v[144:147], v[84:87], v[152:155]
  v_mfma_f32_16x16x32_bf16 v[156:159], v[144:147], v[88:91], v[156:159]
  ds_read_b64_tr_b16 v[72:73], v18 offset:16384
  ds_read_b64_tr_b16 v[74:75], v18 offset:17408
  ds_read_b64_tr_b16 v[76:77], v19 offset:16384
  ds_read_b64_tr_b16 v[78:79], v19 offset:17408
  ds_read_b128 v[80:83], v10 offset:36864
  ds_read_b128 v[84:87], v10 offset:40960
  ds_read_b128 v[88:91], v10 offset:45056
  s_waitcnt lgkmcnt(7)
  v_mfma_f32_16x16x32_bf16 v[24:27], v[92:95], v[100:103], v[24:27]
  v_mfma_f32_16x16x32_bf16 v[28:31], v[92:95], v[104:107], v[28:31]
  v_mfma_f32_16x16x32_bf16 v[32:35], v[92:95], v[108:111], v[32:35]
  v_mfma_f32_16x16x32_bf16 v[36:39], v[96:99], v[100:103], v[36:39]
  v_mfma_f32_16x16x32_bf16 v[40:43], v[96:99], v[104:107], v[40:43]
  v_mfma_f32_16x16x32_bf16 v[44:47], v[96:99], v[108:111], v[44:47]
  v_mfma_f32_16x16x32_bf16 v[148:151], v[144:147], v[100:103], v[148:151]
  v_mfma_f32_16x16x32_bf16 v[152:155], v[144:147], v[104:107], v[152:155]
  v_mfma_f32_16x16x32_bf16 v[156:159], v[144:147], v[108:111], v[156:159]
  ds_read_b64_tr_b16 v[92:93], v18 offset:24576
  ds_read_b64_tr_b16 v[94:95], v18 offset:25600
  ds_read_b64_tr_b16 v[96:97], v19 offset:24576
  ds_read_b64_tr_b16 v[98:99], v19 offset:25600
  ds_read_b128 v[100:103], v11 offset:36864
  ds_read_b128 v[104:107], v11 offset:40960
  ds_read_b128 v[108:111], v11 offset:45056
  s_waitcnt lgkmcnt(7)
  v_mfma_f32_16x16x32_bf16 v[24:27], v[72:75], v[80:83], v[24:27]
  v_mfma_f32_16x16x32_bf16 v[28:31], v[72:75], v[84:87], v[28:31]
  v_mfma_f32_16x16x32_bf16 v[32:35], v[72:75], v[88:91], v[32:35]
  v_mfma_f32_16x16x32_bf16 v[36:39], v[76:79], v[80:83], v[36:39]
  v_mfma_f32_16x16x32_bf16 v[40:43], v[76:79], v[84:87], v[40:43]
  v_mfma_f32_16x16x32_bf16 v[44:47], v[76:79], v[88:91], v[44:47]
  v_mfma_f32_16x16x32_bf16 v[148:151], v[144:147], v[80:83], v[148:151]
  v_mfma_f32_16x16x32_bf16 v[152:155], v[144:147], v[84:87], v[152:155]
  v_mfma_f32_16x16x32_bf16 v[156:159], v[144:147], v[88:91], v[156:159]
  s_waitcnt lgkmcnt(0)
  s_barrier
  v_mfma_f32_16x16x32_bf16 v[24:27], v[92:95], v[100:103], v[24:27]
  v_mfma_f32_16x16x32_bf16 v[28:31], v[92:95], v[104:107], v[28:31]
  v_mfma_f32_16x16x32_bf16 v[32:35], v[92:95], v[108:111], v[32:35]
  v_mfma_f32_16x16x32_bf16 v[36:39], v[96:99], v[100:103], v[36:39]
  v_mfma_f32_16x16x32_bf16 v[40:43], v[96:99], v[104:107], v[40:43]
  v_mfma_f32_16x16x32_bf16 v[44:47], v[96:99], v[108:111], v[44:47]
  v_mfma_f32_16x16x32_bf16 v[148:151], v[144:147], v[100:103], v[148:151]
  v_mfma_f32_16x16x32_bf16 v[152:155], v[144:147], v[104:107], v[152:155]
  v_mfma_f32_16x16x32_bf16 v[156:159], v[144:147], v[108:111], v[156:159]
  s_nop 7
  v_rcp_f32 v148, v148
  v_rcp_f32 v152, v152
  v_rcp_f32 v156, v156
  v_pk_mul_f32 v[24:25], v[24:25], v[148:149] op_sel_hi:[1,0]
  v_pk_mul_f32 v[26:27], v[26:27], v[148:149] op_sel_hi:[1,0]
  v_cvt_pk_bf16_f32 v24, v24, v25
  v_cvt_pk_bf16_f32 v25, v26, v27
  v_pk_mul_f32 v[28:29], v[28:29], v[152:153] op_sel_hi:[1,0]
  v_pk_mul_f32 v[30:31], v[30:31], v[152:153] op_sel_hi:[1,0]
  v_cvt_pk_bf16_f32 v26, v28, v29
  v_cvt_pk_bf16_f32 v27, v30, v31
  v_pk_mul_f32 v[32:33], v[32:33], v[156:157] op_sel_hi:[1,0]
  v_pk_mul_f32 v[34:35], v[34:35], v[156:157] op_sel_hi:[1,0]
  v_cvt_pk_bf16_f32 v28, v32, v33
  v_cvt_pk_bf16_f32 v29, v34, v35
  v_pk_mul_f32 v[36:37], v[36:37], v[148:149] op_sel_hi:[1,0]
  v_pk_mul_f32 v[38:39], v[38:39], v[148:149] op_sel_hi:[1,0]
  v_cvt_pk_bf16_f32 v30, v36, v37
  v_cvt_pk_bf16_f32 v31, v38, v39
  v_pk_mul_f32 v[40:41], v[40:41], v[152:153] op_sel_hi:[1,0]
  v_pk_mul_f32 v[42:43], v[42:43], v[152:153] op_sel_hi:[1,0]
  v_cvt_pk_bf16_f32 v32, v40, v41
  v_cvt_pk_bf16_f32 v33, v42, v43
  v_pk_mul_f32 v[44:45], v[44:45], v[156:157] op_sel_hi:[1,0]
  v_pk_mul_f32 v[46:47], v[46:47], v[156:157] op_sel_hi:[1,0]
  v_cvt_pk_bf16_f32 v34, v44, v45
  v_cvt_pk_bf16_f32 v35, v46, v47
  v_xor_b32 v22, 32, v12
  ds_write_b64 v12, v[24:25] offset:49152
  ds_write_b64 v12, v[26:27] offset:53248
  ds_write_b64 v12, v[28:29] offset:57344
  ds_write_b64 v22, v[30:31] offset:49152
  ds_write_b64 v22, v[32:33] offset:53248
  ds_write_b64 v22, v[34:35] offset:57344
L_pv_done:
  s_mov_b32 s101, 0
  s_sub_u32 s59, s59, 1
  s_mov_b32 s65, 2
  s_cmp_eq_u32 s60, 2
  s_cbranch_scc0 L_ob
  s_mov_b32 s65, 1
  s_mov_b32 s101, 2
  s_mov_b32 s12, s34
  s_mov_b32 s13, s35
  s_mov_b32 s14, 16777216
  s_mov_b32 s15, 0x20000
  s_mov_b32 s16, s36
  s_mov_b32 s17, s37
  s_mov_b32 s18, 16777216
  s_mov_b32 s19, 0x20000
  s_mov_b32 s28, s32
  s_mov_b32 s29, s33
  s_mov_b32 s30, 786432
  s_mov_b32 s31, 0x20000
L_ob:
  s_mov_b32 s63, 16
  s_call_b64 s[92:93], L_wide
  s_mov_b32 s63, 0
  s_cmp_eq_u32 s59, 0
  s_cbranch_scc1 L_bdone
  s_bitcmp1_b32 s3, 2
  s_cbranch_scc1 L_head
  v_mfma_f32_16x16x32_bf16 v[160:163], v[72:75], v[36:39], v[160:163]
  v_mfma_f32_16x16x32_bf16 v[164:167], v[72:75], v[40:43], v[164:167]
  v_mfma_f32_16x16x32_bf16 v[168:171], v[72:75], v[44:47], v[168:171]
  v_mfma_f32_16x16x32_bf16 v[172:175], v[76:79], v[36:39], v[172:175]
  v_mfma_f32_16x16x32_bf16 v[176:179], v[76:79], v[40:43], v[176:179]
  v_mfma_f32_16x16x32_bf16 v[180:183], v[76:79], v[44:47], v[180:183]
  v_mfma_f32_16x16x32_bf16 v[184:187], v[80:83], v[36:39], v[184:187]
  v_mfma_f32_16x16x32_bf16 v[188:191], v[80:83], v[40:43], v[188:191]
  v_mfma_f32_16x16x32_bf16 v[192:195], v[80:83], v[44:47], v[192:195]
  v_mfma_f32_16x16x32_bf16 v[196:199], v[84:87], v[36:39], v[196:199]
  v_mfma_f32_16x16x32_bf16 v[200:203], v[84:87], v[40:43], v[200:203]
  v_mfma_f32_16x16x32_bf16 v[204:207], v[84:87], v[44:47], v[204:207]
  v_mfma_f32_16x16x32_bf16 v[208:211], v[88:91], v[36:39], v[208:211]
  v_mfma_f32_16x16x32_bf16 v[212:215], v[88:91], v[40:43], v[212:215]
  v_mfma_f32_16x16x32_bf16 v[216:219], v[88:91], v[44:47], v[216:219]
  v_mfma_f32_16x16x32_bf16 v[220:223], v[92:95], v[36:39], v[220:223]
  v_mfma_f32_16x16x32_bf16 v[224:227], v[92:95], v[40:43], v[224:227]
  v_mfma_f32_16x16x32_bf16 v[228:231], v[92:95], v[44:47], v[228:231]
  v_mfma_f32_16x16x32_bf16 v[232:235], v[104:107], v[36:39], v[232:235]
  v_mfma_f32_16x16x32_bf16 v[236:239], v[104:107], v[40:43], v[236:239]
  v_mfma_f32_16x16x32_bf16 v[240:243], v[104:107], v[44:47], v[240:243]
  v_mfma_f32_16x16x32_bf16 v[244:247], v[108:111], v[36:39], v[244:247]
  v_mfma_f32_16x16x32_bf16 v[248:251], v[108:111], v[40:43], v[248:251]
  v_mfma_f32_16x16x32_bf16 v[252:255], v[108:111], v[44:47], v[252:255]
  s_branch L_head
L_bdone:
  s_lshl_b32 s66, s56, 4
  s_lshl_b32 s67, s58, 3
  s_add_u32 s66, s66, s67
  s_add_u32 s66, s66, s57
  s_mul_i32 s66, s66, 49152
  s_cmp_eq_u32 s60, 2
  s_cbranch_scc0 L_last
  s_bitcmp1_b32 s3, 2
  s_cbranch_scc1 L_bpk2
  s_barrier
  v_mbcnt_lo_u32_b32 v16, -1, 0
  v_mbcnt_hi_u32_b32 v16, -1, v16
  v_lshlrev_b32 v16, 4, v16
  v_add_u32 v17, 4096, v16
  v_add_u32 v18, 8192, v16
  s_mov_b32 s28, s54
  s_mov_b32 s29, s55
  s_mov_b32 s30, 268435456
  s_mov_b32 s31, 0x20000
  s_mul_i32 s67, s3, 12288
  s_add_u32 s70, s66, s67
  v_mfma_f32_16x16x32_bf16 v[160:163], v[72:75], v[36:39], v[160:163]
  v_mfma_f32_16x16x32_bf16 v[164:167], v[72:75], v[40:43], v[164:167]
  v_mfma_f32_16x16x32_bf16 v[168:171], v[72:75], v[44:47], v[168:171]
  v_mfma_f32_16x16x32_bf16 v[172:175], v[76:79], v[36:39], v[172:175]
  v_mfma_f32_16x16x32_bf16 v[176:179], v[76:79], v[40:43], v[176:179]
  v_mfma_f32_16x16x32_bf16 v[180:183], v[76:79], v[44:47], v[180:183]
  v_mfma_f32_16x16x32_bf16 v[184:187], v[80:83], v[36:39], v[184:187]
  v_mfma_f32_16x16x32_bf16 v[188:191], v[80:83], v[40:43], v[188:191]
  v_mfma_f32_16x16x32_bf16 v[192:195], v[80:83], v[44:47], v[192:195]
  v_mfma_f32_16x16x32_bf16 v[196:199], v[84:87], v[36:39], v[196:199]
  v_mfma_f32_16x16x32_bf16 v[200:203], v[84:87], v[40:43], v[200:203]
  v_mfma_f32_16x16x32_bf16 v[204:207], v[84:87], v[44:47], v[204:207]
  v_mfma_f32_16x16x32_bf16 v[208:211], v[88:91], v[36:39], v[208:211]
  v_mfma_f32_16x16x32_bf16 v[212:215], v[88:91], v[40:43], v[212:215]
  v_cvt_pk_bf16_f32 v160, v160, v161
  v_cvt_pk_bf16_f32 v161, v162, v163
  v_cvt_pk_bf16_f32 v162, v172, v173
  v_cvt_pk_bf16_f32 v163, v174, v175
  v_mfma_f32_16x16x32_bf16 v[216:219], v[88:91], v[44:47], v[216:219]
  v_cvt_pk_bf16_f32 v164, v164, v165
  v_cvt_pk_bf16_f32 v165, v166, v167
  v_cvt_pk_bf16_f32 v166, v176, v177
  v_cvt_pk_bf16_f32 v167, v178, v179
  v_mfma_f32_16x16x32_bf16 v[220:223], v[92:95], v[36:39], v[220:223]
  v_cvt_pk_bf16_f32 v168, v168, v169
  v_cvt_pk_bf16_f32 v169, v170, v171
  v_cvt_pk_bf16_f32 v170, v180, v181
  v_cvt_pk_bf16_f32 v171, v182, v183
  v_mfma_f32_16x16x32_bf16 v[224:227], v[92:95], v[40:43], v[224:227]
  s_nop 1
  v_permlane16_swap_b32 v160, v162
  v_permlane16_swap_b32 v161, v163
  buffer_store_dwordx4 v[160:163], v16, s[28:31], s70 offen offset:0 sc1
  v_permlane16_swap_b32 v164, v166
  v_permlane16_swap_b32 v165, v167
  buffer_store_dwordx4 v[164:167], v17, s[28:31], s70 offen offset:0 sc1
  v_permlane16_swap_b32 v168, v170
  v_permlane16_swap_b32 v169, v171
  buffer_store_dwordx4 v[168:171], v18, s[28:31], s70 offen offset:0 sc1
  v_mfma_f32_16x16x32_bf16 v[228:231], v[92:95], v[44:47], v[228:231]
  v_mfma_f32_16x16x32_bf16 v[232:235], v[104:107], v[36:39], v[232:235]
  v_mfma_f32_16x16x32_bf16 v[236:239], v[104:107], v[40:43], v[236:239]
  v_cvt_pk_bf16_f32 v184, v184, v185
  v_cvt_pk_bf16_f32 v185, v186, v187
  v_cvt_pk_bf16_f32 v186, v196, v197
  v_cvt_pk_bf16_f32 v187, v198, v199
  v_mfma_f32_16x16x32_bf16 v[240:243], v[104:107], v[44:47], v[240:243]
  v_cvt_pk_bf16_f32 v188, v188, v189
  v_cvt_pk_bf16_f32 v189, v190, v191
  v_cvt_pk_bf16_f32 v190, v200, v201
  v_cvt_pk_bf16_f32 v191, v202, v203
  v_mfma_f32_16x16x32_bf16 v[244:247], v[108:111], v[36:39], v[244:247]
  v_cvt_pk_bf16_f32 v192, v192, v193
  v_cvt_pk_bf16_f32 v193, v194, v195
  v_cvt_pk_bf16_f32 v194, v204, v205
  v_cvt_pk_bf16_f32 v195, v206, v207
  v_mfma_f32_16x16x32_bf16 v[248:251], v[108:111], v[40:43], v[248:251]
  s_nop 1
  v_permlane16_swap_b32 v184, v186
  v_permlane16_swap_b32 v185, v187
  buffer_store_dwordx4 v[184:187], v16, s[28:31], s70 offen offset:1024 sc1
  v_permlane16_swap_b32 v188, v190
  v_permlane16_swap_b32 v189, v191
  buffer_store_dwordx4 v[188:191], v17, s[28:31], s70 offen offset:1024 sc1
  v_permlane16_swap_b32 v192, v194
  v_permlane16_swap_b32 v193, v195
  buffer_store_dwordx4 v[192:195], v18, s[28:31], s70 offen offset:1024 sc1
  v_mfma_f32_16x16x32_bf16 v[252:255], v[108:111], v[44:47], v[252:255]
  v_cvt_pk_bf16_f32 v208, v208, v209
  v_cvt_pk_bf16_f32 v209, v210, v211
  v_cvt_pk_bf16_f32 v210, v220, v221
  v_cvt_pk_bf16_f32 v211, v222, v223
  v_cvt_pk_bf16_f32 v212, v212, v213
  v_cvt_pk_bf16_f32 v213, v214, v215
  v_cvt_pk_bf16_f32 v214, v224, v225
  v_cvt_pk_bf16_f32 v215, v226, v227
  v_cvt_pk_bf16_f32 v216, v216, v217
  v_cvt_pk_bf16_f32 v217, v218, v219
  v_cvt_pk_bf16_f32 v218, v228, v229
  v_cvt_pk_bf16_f32 v219, v230, v231
  s_nop 1
  v_permlane16_swap_b32 v208, v210
  v_permlane16_swap_b32 v209, v211
  buffer_store_dwordx4 v[208:211], v16, s[28:31], s70 offen offset:2048 sc1
  v_permlane16_swap_b32 v212, v214
  v_permlane16_swap_b32 v213, v215
  buffer_store_dwordx4 v[212:215], v17, s[28:31], s70 offen offset:2048 sc1
  v_permlane16_swap_b32 v216, v218
  v_permlane16_swap_b32 v217, v219
  buffer_store_dwordx4 v[216:219], v18, s[28:31], s70 offen offset:2048 sc1
  v_cvt_pk_bf16_f32 v232, v232, v233
  v_cvt_pk_bf16_f32 v233, v234, v235
  v_cvt_pk_bf16_f32 v234, v244, v245
  v_cvt_pk_bf16_f32 v235, v246, v247
  v_cvt_pk_bf16_f32 v236, v236, v237
  v_cvt_pk_bf16_f32 v237, v238, v239
  v_cvt_pk_bf16_f32 v238, v248, v249
  v_cvt_pk_bf16_f32 v239, v250, v251
  v_cvt_pk_bf16_f32 v240, v240, v241
  v_cvt_pk_bf16_f32 v241, v242, v243
  v_cvt_pk_bf16_f32 v242, v252, v253
  v_cvt_pk_bf16_f32 v243, v254, v255
  s_nop 1
  v_permlane16_swap_b32 v232, v234
  v_permlane16_swap_b32 v233, v235
  buffer_store_dwordx4 v[232:235], v16, s[28:31], s70 offen offset:3072 sc1
  v_permlane16_swap_b32 v236, v238
  v_permlane16_swap_b32 v237, v239
  buffer_store_dwordx4 v[236:239], v17, s[28:31], s70 offen offset:3072 sc1
  v_permlane16_swap_b32 v240, v242
  v_permlane16_swap_b32 v241, v243
  buffer_store_dwordx4 v[240:243], v18, s[28:31], s70 offen offset:3072 sc1
  s_nop 1
L_bpk2:
  s_mov_b32 s20, s40
  s_mov_b32 s21, s41
  s_mov_b32 s22, 4194304
  s_mov_b32 s23, 0x20000
  s_mov_b32 s91, 1
  s_branch L_apath
L_last:
  s_bitcmp1_b32 s3, 2
  s_cbranch_scc1 L_bpk
  v_mbcnt_lo_u32_b32 v16, -1, 0
  v_mbcnt_hi_u32_b32 v16, -1, v16
  v_lshlrev_b32 v16, 4, v16
  v_add_u32 v17, 4096, v16
  v_add_u32 v18, 8192, v16
  s_mov_b32 s28, s54
  s_mov_b32 s29, s55
  s_mov_b32 s30, 268435456
  s_mov_b32 s31, 0x20000
  s_mul_i32 s67, s3, 12288
  s_add_u32 s70, s66, s67
  v_mfma_f32_16x16x32_bf16 v[160:163], v[72:75], v[36:39], v[160:163]
  v_mfma_f32_16x16x32_bf16 v[164:167], v[72:75], v[40:43], v[164:167]
  v_mfma_f32_16x16x32_bf16 v[168:171], v[72:75], v[44:47], v[168:171]
  v_mfma_f32_16x16x32_bf16 v[172:175], v[76:79], v[36:39], v[172:175]
  v_mfma_f32_16x16x32_bf16 v[176:179], v[76:79], v[40:43], v[176:179]
  v_mfma_f32_16x16x32_bf16 v[180:183], v[76:79], v[44:47], v[180:183]
  v_mfma_f32_16x16x32_bf16 v[184:187], v[80:83], v[36:39], v[184:187]
  v_mfma_f32_16x16x32_bf16 v[188:191], v[80:83], v[40:43], v[188:191]
  v_mfma_f32_16x16x32_bf16 v[192:195], v[80:83], v[44:47], v[192:195]
  v_mfma_f32_16x16x32_bf16 v[196:199], v[84:87], v[36:39], v[196:199]
  v_mfma_f32_16x16x32_bf16 v[200:203], v[84:87], v[40:43], v[200:203]
  v_mfma_f32_16x16x32_bf16 v[204:207], v[84:87], v[44:47], v[204:207]
  v_mfma_f32_16x16x32_bf16 v[208:211], v[88:91], v[36:39], v[208:211]
  v_mfma_f32_16x16x32_bf16 v[212:215], v[88:91], v[40:43], v[212:215]
  v_cvt_pk_bf16_f32 v160, v160, v161
  v_cvt_pk_bf16_f32 v161, v162, v163
  v_cvt_pk_bf16_f32 v162, v172, v173
  v_cvt_pk_bf16_f32 v163, v174, v175
  v_mfma_f32_16x16x32_bf16 v[216:219], v[88:91], v[44:47], v[216:219]
  v_cvt_pk_bf16_f32 v164, v164, v165
  v_cvt_pk_bf16_f32 v165, v166, v167
  v_cvt_pk_bf16_f32 v166, v176, v177
  v_cvt_pk_bf16_f32 v167, v178, v179
  v_mfma_f32_16x16x32_bf16 v[220:223], v[92:95], v[36:39], v[220:223]
  v_cvt_pk_bf16_f32 v168, v168, v169
  v_cvt_pk_bf16_f32 v169, v170, v171
  v_cvt_pk_bf16_f32 v170, v180, v181
  v_cvt_pk_bf16_f32 v171, v182, v183
  v_mfma_f32_16x16x32_bf16 v[224:227], v[92:95], v[40:43], v[224:227]
  s_nop 1
  v_permlane16_swap_b32 v160, v162
  v_permlane16_swap_b32 v161, v163
  buffer_store_dwordx4 v[160:163], v16, s[28:31], s70 offen offset:0 sc1
  v_permlane16_swap_b32 v164, v166
  v_permlane16_swap_b32 v165, v167
  buffer_store_dwordx4 v[164:167], v17, s[28:31], s70 offen offset:0 sc1
  v_permlane16_swap_b32 v168, v170
  v_permlane16_swap_b32 v169, v171
  buffer_store_dwordx4 v[168:171], v18, s[28:31], s70 offen offset:0 sc1
  v_mfma_f32_16x16x32_bf16 v[228:231], v[92:95], v[44:47], v[228:231]
  v_mfma_f32_16x16x32_bf16 v[232:235], v[104:107], v[36:39], v[232:235]
  v_mfma_f32_16x16x32_bf16 v[236:239], v[104:107], v[40:43], v[236:239]
  v_cvt_pk_bf16_f32 v184, v184, v185
  v_cvt_pk_bf16_f32 v185, v186, v187
  v_cvt_pk_bf16_f32 v186, v196, v197
  v_cvt_pk_bf16_f32 v187, v198, v199
  v_mfma_f32_16x16x32_bf16 v[240:243], v[104:107], v[44:47], v[240:243]
  v_cvt_pk_bf16_f32 v188, v188, v189
  v_cvt_pk_bf16_f32 v189, v190, v191
  v_cvt_pk_bf16_f32 v190, v200, v201
  v_cvt_pk_bf16_f32 v191, v202, v203
  v_mfma_f32_16x16x32_bf16 v[244:247], v[108:111], v[36:39], v[244:247]
  v_cvt_pk_bf16_f32 v192, v192, v193
  v_cvt_pk_bf16_f32 v193, v194, v195
  v_cvt_pk_bf16_f32 v194, v204, v205
  v_cvt_pk_bf16_f32 v195, v206, v207
  v_mfma_f32_16x16x32_bf16 v[248:251], v[108:111], v[40:43], v[248:251]
  s_nop 1
  v_permlane16_swap_b32 v184, v186
  v_permlane16_swap_b32 v185, v187
  buffer_store_dwordx4 v[184:187], v16, s[28:31], s70 offen offset:1024 sc1
  v_permlane16_swap_b32 v188, v190
  v_permlane16_swap_b32 v189, v191
  buffer_store_dwordx4 v[188:191], v17, s[28:31], s70 offen offset:1024 sc1
  v_permlane16_swap_b32 v192, v194
  v_permlane16_swap_b32 v193, v195
  buffer_store_dwordx4 v[192:195], v18, s[28:31], s70 offen offset:1024 sc1
  v_mfma_f32_16x16x32_bf16 v[252:255], v[108:111], v[44:47], v[252:255]
  v_cvt_pk_bf16_f32 v208, v208, v209
  v_cvt_pk_bf16_f32 v209, v210, v211
  v_cvt_pk_bf16_f32 v210, v220, v221
  v_cvt_pk_bf16_f32 v211, v222, v223
  v_cvt_pk_bf16_f32 v212, v212, v213
  v_cvt_pk_bf16_f32 v213, v214, v215
  v_cvt_pk_bf16_f32 v214, v224, v225
  v_cvt_pk_bf16_f32 v215, v226, v227
  v_cvt_pk_bf16_f32 v216, v216, v217
  v_cvt_pk_bf16_f32 v217, v218, v219
  v_cvt_pk_bf16_f32 v218, v228, v229
  v_cvt_pk_bf16_f32 v219, v230, v231
  s_nop 1
  v_permlane16_swap_b32 v208, v210
  v_permlane16_swap_b32 v209, v211
  buffer_store_dwordx4 v[208:211], v16, s[28:31], s70 offen offset:2048 sc1
  v_permlane16_swap_b32 v212, v214
  v_permlane16_swap_b32 v213, v215
  buffer_store_dwordx4 v[212:215], v17, s[28:31], s70 offen offset:2048 sc1
  v_permlane16_swap_b32 v216, v218
  v_permlane16_swap_b32 v217, v219
  buffer_store_dwordx4 v[216:219], v18, s[28:31], s70 offen offset:2048 sc1
  v_cvt_pk_bf16_f32 v232, v232, v233
  v_cvt_pk_bf16_f32 v233, v234, v235
  v_cvt_pk_bf16_f32 v234, v244, v245
  v_cvt_pk_bf16_f32 v235, v246, v247
  v_cvt_pk_bf16_f32 v236, v236, v237
  v_cvt_pk_bf16_f32 v237, v238, v239
  v_cvt_pk_bf16_f32 v238, v248, v249
  v_cvt_pk_bf16_f32 v239, v250, v251
  v_cvt_pk_bf16_f32 v240, v240, v241
  v_cvt_pk_bf16_f32 v241, v242, v243
  v_cvt_pk_bf16_f32 v242, v252, v253
  v_cvt_pk_bf16_f32 v243, v254, v255
  s_nop 1
  v_permlane16_swap_b32 v232, v234
  v_permlane16_swap_b32 v233, v235
  buffer_store_dwordx4 v[232:235], v16, s[28:31], s70 offen offset:3072 sc1
  v_permlane16_swap_b32 v236, v238
  v_permlane16_swap_b32 v237, v239
  buffer_store_dwordx4 v[236:239], v17, s[28:31], s70 offen offset:3072 sc1
  v_permlane16_swap_b32 v240, v242
  v_permlane16_swap_b32 v241, v243
  buffer_store_dwordx4 v[240:243], v18, s[28:31], s70 offen offset:3072 sc1
  s_nop 1
  v_mov_b32 v16, 162828
  v_mov_b32 v17, 1
  s_load_dwordx4 s[8:11], s[0:1], 80
  s_waitcnt lgkmcnt(0)
  s_mov_b64 s[16:17], s[10:11]
  s_mov_b32 s10, 1572864
  s_mov_b32 s11, 0x20000
  s_mov_b32 s12, s54
  s_mov_b32 s13, s55
  s_mov_b32 s14, 268435456
  s_mov_b32 s15, 0x20000
  s_waitcnt vmcnt(0)
  s_mov_b64 exec, 1
  ds_add_rtn_u32 v17, v16, v17
  s_lshl_b32 s66, s58, 3
  s_add_u32 s66, s66, s57
  s_lshl_b32 s68, s66, 2
  s_add_u32 s69, s68, 163072
  v_mov_b32 v20, s69
  ds_read_b32 v20, v20
  s_lshl_b32 s69, s56, 8
  s_add_u32 s68, s68, s69
  s_add_u32 s68, s68, 33554432
  s_lshl_b32 s66, 1, s66
  s_add_u32 s67, s57, 16
  s_lshl_b32 s67, s58, s67
  s_or_b32 s66, s66, s67
  s_lshl_b32 s67, s56, 4
  v_mov_b32 v16, s67
  v_mov_b32 v18, s66
  v_mov_b32 v19, 0
  s_waitcnt lgkmcnt(0)
  v_readfirstlane_b32 s67, v17
  v_add_u32 v20, 1, v20
  s_mov_b64 exec, -1
  s_nop 2
  s_cmp_eq_u32 s67, 3
  s_cbranch_scc0 L_fin
  s_mov_b64 exec, 1
  buffer_store_dword v20, off, s[12:15], s68 sc1
  global_atomic_or_x2 v[20:21], v16, v[18:19], s[16:17] sc0 sc1
  s_waitcnt vmcnt(0)
  v_readfirstlane_b32 s67, v20
  v_readfirstlane_b32 s27, v21
  s_mov_b64 exec, -1
  s_nop 2
  s_or_b32 s67, s67, s66
  s_cmp_eq_u32 s67, 16777215
  s_cbranch_scc0 L_fin
L_ab_loop:
  s_cmp_eq_u32 s27, 0
  s_cbranch_scc1 L_fin
  s_ff1_i32_b32 s28, s27
  s_bitset0_b32 s27, s28
  s_mul_i32 s18, s28, 3
  s_mov_b32 s19, 2
  s_call_b64 s[92:93], L_reduce
  s_add_u32 s18, s18, 1
  s_mov_b32 s19, 2
  s_call_b64 s[92:93], L_reduce
  s_add_u32 s18, s18, 1
  s_mov_b32 s19, 2
  s_call_b64 s[92:93], L_reduce
  s_add_u32 s18, s18, 1
  s_branch L_ab_loop
  s_branch L_fin
L_bpk:
  s_cmp_eq_u32 s3, 7
  s_cbranch_scc1 L_fin
  s_load_dwordx4 s[8:11], s[0:1], 80
  s_waitcnt lgkmcnt(0)
  s_mov_b64 s[16:17], s[10:11]
  s_mov_b32 s10, 1572864
  s_mov_b32 s11, 0x20000
  s_mov_b32 s12, s54
  s_mov_b32 s13, s55
  s_mov_b32 s14, 268435456
  s_mov_b32 s15, 0x20000
  s_lshl_b32 s18, s58, 3
  s_add_u32 s18, s18, s57
  s_mul_i32 s18, s18, 3
  s_add_u32 s18, s18, s3
  s_sub_u32 s18, s18, 4
  s_sub_u32 s19, s3, 4
  s_min_u32 s19, s19, 1
  s_call_b64 s[92:93], L_reduce
L_fin:
L_end:
  s_endpgm
L_r0first:
  v_max3_f32 v20, v112, v113, v114
  v_max3_f32 v20, v20, v115, v116
  v_max3_f32 v20, v20, v117, v118
  v_max_f32 v20, v20, v119
  v_mov_b32 v45, v20
  s_nop 1
  v_permlane32_swap_b32 v20, v45
  s_nop 1
  v_max_f32 v20, v20, v45
  v_mov_b32 v45, v20
  s_nop 1
  v_permlane16_swap_b32 v20, v45
  s_nop 1
  v_max_f32 v20, v20, v45
  v_max3_f32 v21, v120, v121, v122
  v_max3_f32 v21, v21, v123, v124
  v_max3_f32 v21, v21, v125, v126
  v_max_f32 v21, v21, v127
  v_mov_b32 v45, v21
  s_nop 1
  v_permlane32_swap_b32 v21, v45
  s_nop 1
  v_max_f32 v21, v21, v45
  v_mov_b32 v45, v21
  s_nop 1
  v_permlane16_swap_b32 v21, v45
  s_nop 1
  v_max_f32 v21, v21, v45
  v_max3_f32 v22, v128, v129, v130
  v_max3_f32 v22, v22, v131, v132
  v_max3_f32 v22, v22, v133, v134
  v_max_f32 v22, v22, v135
  v_mov_b32 v45, v22
  s_nop 1
  v_permlane32_swap_b32 v22, v45
  s_nop 1
  v_max_f32 v22, v22, v45
  v_mov_b32 v45, v22
  s_nop 1
  v_permlane16_swap_b32 v22, v45
  s_nop 1
  v_max_f32 v22, v22, v45
  v_sub_f32 v112, v112, v20
  v_sub_f32 v113, v113, v20
  v_sub_f32 v114, v114, v20
  v_sub_f32 v115, v115, v20
  v_sub_f32 v116, v116, v20
  v_sub_f32 v117, v117, v20
  v_sub_f32 v118, v118, v20
  v_sub_f32 v119, v119, v20
  v_sub_f32 v120, v120, v21
  v_sub_f32 v121, v121, v21
  v_sub_f32 v122, v122, v21
  v_sub_f32 v123, v123, v21
  v_sub_f32 v124, v124, v21
  v_sub_f32 v125, v125, v21
  v_sub_f32 v126, v126, v21
  v_sub_f32 v127, v127, v21
  v_sub_f32 v128, v128, v22
  v_sub_f32 v129, v129, v22
  v_sub_f32 v130, v130, v22
  v_sub_f32 v131, v131, v22
  v_sub_f32 v132, v132, v22
  v_sub_f32 v133, v133, v22
  v_sub_f32 v134, v134, v22
  v_sub_f32 v135, v135, v22
  s_mov_b32 s79, 1
  s_branch L_n0f
L_r0:
  v_max3_f32 v20, v112, v113, v114
  v_max3_f32 v20, v20, v115, v116
  v_max3_f32 v20, v20, v117, v118
  v_max_f32 v20, v20, v119
  v_mov_b32 v45, v20
  s_nop 1
  v_permlane32_swap_b32 v20, v45
  s_nop 1
  v_max_f32 v20, v20, v45
  v_mov_b32 v45, v20
  s_nop 1
  v_permlane16_swap_b32 v20, v45
  s_nop 1
  v_max_f32 v20, v20, v45
  v_max3_f32 v21, v120, v121, v122
  v_max3_f32 v21, v21, v123, v124
  v_max3_f32 v21, v21, v125, v126
  v_max_f32 v21, v21, v127
  v_mov_b32 v45, v21
  s_nop 1
  v_permlane32_swap_b32 v21, v45
  s_nop 1
  v_max_f32 v21, v21, v45
  v_mov_b32 v45, v21
  s_nop 1
  v_permlane16_swap_b32 v21, v45
  s_nop 1
  v_max_f32 v21, v21, v45
  v_max3_f32 v22, v128, v129, v130
  v_max3_f32 v22, v22, v131, v132
  v_max3_f32 v22, v22, v133, v134
  v_max_f32 v22, v22, v135
  v_mov_b32 v45, v22
  s_nop 1
  v_permlane32_swap_b32 v22, v45
  s_nop 1
  v_max_f32 v22, v22, v45
  v_mov_b32 v45, v22
  s_nop 1
  v_permlane16_swap_b32 v22, v45
  s_nop 1
  v_max_f32 v22, v22, v45
  v_max_f32 v20, 0, v20
  v_exp_f32 v45, -v20
  s_nop 0
  v_mul_f32 v44, v44, v45
  v_mul_f32 v160, v160, v45
  v_mul_f32 v161, v161, v45
  v_mul_f32 v162, v162, v45
  v_mul_f32 v163, v163, v45
  v_mul_f32 v172, v172, v45
  v_mul_f32 v173, v173, v45
  v_mul_f32 v174, v174, v45
  v_mul_f32 v175, v175, v45
  v_mul_f32 v184, v184, v45
  v_mul_f32 v185, v185, v45
  v_mul_f32 v186, v186, v45
  v_mul_f32 v187, v187, v45
  v_mul_f32 v196, v196, v45
  v_mul_f32 v197, v197, v45
  v_mul_f32 v198, v198, v45
  v_mul_f32 v199, v199, v45
  v_mul_f32 v208, v208, v45
  v_mul_f32 v209, v209, v45
  v_mul_f32 v210, v210, v45
  v_mul_f32 v211, v211, v45
  v_mul_f32 v220, v220, v45
  v_mul_f32 v221, v221, v45
  v_mul_f32 v222, v222, v45
  v_mul_f32 v223, v223, v45
  v_mul_f32 v232, v232, v45
  v_mul_f32 v233, v233, v45
  v_mul_f32 v234, v234, v45
  v_mul_f32 v235, v235, v45
  v_mul_f32 v244, v244, v45
  v_mul_f32 v245, v245, v45
  v_mul_f32 v246, v246, v45
  v_mul_f32 v247, v247, v45
  v_max_f32 v21, 0, v21
  v_exp_f32 v45, -v21
  s_nop 0
  v_mul_f32 v48, v48, v45
  v_mul_f32 v164, v164, v45
  v_mul_f32 v165, v165, v45
  v_mul_f32 v166, v166, v45
  v_mul_f32 v167, v167, v45
  v_mul_f32 v176, v176, v45
  v_mul_f32 v177, v177, v45
  v_mul_f32 v178, v178, v45
  v_mul_f32 v179, v179, v45
  v_mul_f32 v188, v188, v45
  v_mul_f32 v189, v189, v45
  v_mul_f32 v190, v190, v45
  v_mul_f32 v191, v191, v45
  v_mul_f32 v200, v200, v45
  v_mul_f32 v201, v201, v45
  v_mul_f32 v202, v202, v45
  v_mul_f32 v203, v203, v45
  v_mul_f32 v212, v212, v45
  v_mul_f32 v213, v213, v45
  v_mul_f32 v214, v214, v45
  v_mul_f32 v215, v215, v45
  v_mul_f32 v224, v224, v45
  v_mul_f32 v225, v225, v45
  v_mul_f32 v226, v226, v45
  v_mul_f32 v227, v227, v45
  v_mul_f32 v236, v236, v45
  v_mul_f32 v237, v237, v45
  v_mul_f32 v238, v238, v45
  v_mul_f32 v239, v239, v45
  v_mul_f32 v248, v248, v45
  v_mul_f32 v249, v249, v45
  v_mul_f32 v250, v250, v45
  v_mul_f32 v251, v251, v45
  v_max_f32 v22, 0, v22
  v_exp_f32 v45, -v22
  s_nop 0
  v_mul_f32 v52, v52, v45
  v_mul_f32 v168, v168, v45
  v_mul_f32 v169, v169, v45
  v_mul_f32 v170, v170, v45
  v_mul_f32 v171, v171, v45
  v_mul_f32 v180, v180, v45
  v_mul_f32 v181, v181, v45
  v_mul_f32 v182, v182, v45
  v_mul_f32 v183, v183, v45
  v_mul_f32 v192, v192, v45
  v_mul_f32 v193, v193, v45
  v_mul_f32 v194, v194, v45
  v_mul_f32 v195, v195, v45
  v_mul_f32 v204, v204, v45
  v_mul_f32 v205, v205, v45
  v_mul_f32 v206, v206, v45
  v_mul_f32 v207, v207, v45
  v_mul_f32 v216, v216, v45
  v_mul_f32 v217, v217, v45
  v_mul_f32 v218, v218, v45
  v_mul_f32 v219, v219, v45
  v_mul_f32 v228, v228, v45
  v_mul_f32 v229, v229, v45
  v_mul_f32 v230, v230, v45
  v_mul_f32 v231, v231, v45
  v_mul_f32 v240, v240, v45
  v_mul_f32 v241, v241, v45
  v_mul_f32 v242, v242, v45
  v_mul_f32 v243, v243, v45
  v_mul_f32 v252, v252, v45
  v_mul_f32 v253, v253, v45
  v_mul_f32 v254, v254, v45
  v_mul_f32 v255, v255, v45
  v_sub_f32 v112, v112, v20
  v_sub_f32 v113, v113, v20
  v_sub_f32 v114, v114, v20
  v_sub_f32 v115, v115, v20
  v_sub_f32 v116, v116, v20
  v_sub_f32 v117, v117, v20
  v_sub_f32 v118, v118, v20
  v_sub_f32 v119, v119, v20
  v_sub_f32 v120, v120, v21
  v_sub_f32 v121, v121, v21
  v_sub_f32 v122, v122, v21
  v_sub_f32 v123, v123, v21
  v_sub_f32 v124, v124, v21
  v_sub_f32 v125, v125, v21
  v_sub_f32 v126, v126, v21
  v_sub_f32 v127, v127, v21
  v_sub_f32 v128, v128, v22
  v_sub_f32 v129, v129, v22
  v_sub_f32 v130, v130, v22
  v_sub_f32 v131, v131, v22
  v_sub_f32 v132, v132, v22
  v_sub_f32 v133, v133, v22
  v_sub_f32 v134, v134, v22
  v_sub_f32 v135, v135, v22
  s_mov_b32 s79, 1
  s_branch L_n0l
L_r0bf:
  s_call_b64 s[92:93], L_fix1
  s_branch L_n0bf
L_r1f:
  s_call_b64 s[92:93], L_scale1
  s_branch L_n1f
L_r0bl:
  s_call_b64 s[92:93], L_fix1
  s_branch L_n0bl
L_r1l:
  s_call_b64 s[92:93], L_scale1
  s_branch L_n1l
L_scale1:
  v_max3_f32 v20, v136, v137, v138
  v_max3_f32 v20, v20, v139, v140
  v_max3_f32 v20, v20, v141, v142
  v_max_f32 v20, v20, v143
  v_mov_b32 v45, v20
  s_nop 1
  v_permlane32_swap_b32 v20, v45
  s_nop 1
  v_max_f32 v20, v20, v45
  v_mov_b32 v45, v20
  s_nop 1
  v_permlane16_swap_b32 v20, v45
  s_nop 1
  v_max_f32 v20, v20, v45
  v_max3_f32 v21, v144, v145, v146
  v_max3_f32 v21, v21, v147, v148
  v_max3_f32 v21, v21, v149, v150
  v_max_f32 v21, v21, v151
  v_mov_b32 v45, v21
  s_nop 1
  v_permlane32_swap_b32 v21, v45
  s_nop 1
  v_max_f32 v21, v21, v45
  v_mov_b32 v45, v21
  s_nop 1
  v_permlane16_swap_b32 v21, v45
  s_nop 1
  v_max_f32 v21, v21, v45
  v_max3_f32 v22, v152, v153, v154
  v_max3_f32 v22, v22, v155, v156
  v_max3_f32 v22, v22, v157, v158
  v_max_f32 v22, v22, v159
  v_mov_b32 v45, v22
  s_nop 1
  v_permlane32_swap_b32 v22, v45
  s_nop 1
  v_max_f32 v22, v22, v45
  v_mov_b32 v45, v22
  s_nop 1
  v_permlane16_swap_b32 v22, v45
  s_nop 1
  v_max_f32 v22, v22, v45
  v_max_f32 v20, 0, v20
  v_exp_f32 v45, -v20
  s_nop 0
  v_mul_f32 v44, v44, v45
  v_mul_f32 v160, v160, v45
  v_mul_f32 v161, v161, v45
  v_mul_f32 v162, v162, v45
  v_mul_f32 v163, v163, v45
  v_mul_f32 v172, v172, v45
  v_mul_f32 v173, v173, v45
  v_mul_f32 v174, v174, v45
  v_mul_f32 v175, v175, v45
  v_mul_f32 v184, v184, v45
  v_mul_f32 v185, v185, v45
  v_mul_f32 v186, v186, v45
  v_mul_f32 v187, v187, v45
  v_mul_f32 v196, v196, v45
  v_mul_f32 v197, v197, v45
  v_mul_f32 v198, v198, v45
  v_mul_f32 v199, v199, v45
  v_mul_f32 v208, v208, v45
  v_mul_f32 v209, v209, v45
  v_mul_f32 v210, v210, v45
  v_mul_f32 v211, v211, v45
  v_mul_f32 v220, v220, v45
  v_mul_f32 v221, v221, v45
  v_mul_f32 v222, v222, v45
  v_mul_f32 v223, v223, v45
  v_mul_f32 v232, v232, v45
  v_mul_f32 v233, v233, v45
  v_mul_f32 v234, v234, v45
  v_mul_f32 v235, v235, v45
  v_mul_f32 v244, v244, v45
  v_mul_f32 v245, v245, v45
  v_mul_f32 v246, v246, v45
  v_mul_f32 v247, v247, v45
  v_lshlrev_b32 v116, 16, v112
  v_and_b32 v117, 0xffff0000, v112
  v_mul_f32 v116, v116, v45
  v_mul_f32 v117, v117, v45
  v_cvt_pk_bf16_f32 v112, v116, v117
  v_lshlrev_b32 v116, 16, v113
  v_and_b32 v117, 0xffff0000, v113
  v_mul_f32 v116, v116, v45
  v_mul_f32 v117, v117, v45
  v_cvt_pk_bf16_f32 v113, v116, v117
  v_lshlrev_b32 v116, 16, v114
  v_and_b32 v117, 0xffff0000, v114
  v_mul_f32 v116, v116, v45
  v_mul_f32 v117, v117, v45
  v_cvt_pk_bf16_f32 v114, v116, v117
  v_lshlrev_b32 v116, 16, v115
  v_and_b32 v117, 0xffff0000, v115
  v_mul_f32 v116, v116, v45
  v_mul_f32 v117, v117, v45
  v_cvt_pk_bf16_f32 v115, v116, v117
  v_max_f32 v21, 0, v21
  v_exp_f32 v45, -v21
  s_nop 0
  v_mul_f32 v48, v48, v45
  v_mul_f32 v164, v164, v45
  v_mul_f32 v165, v165, v45
  v_mul_f32 v166, v166, v45
  v_mul_f32 v167, v167, v45
  v_mul_f32 v176, v176, v45
  v_mul_f32 v177, v177, v45
  v_mul_f32 v178, v178, v45
  v_mul_f32 v179, v179, v45
  v_mul_f32 v188, v188, v45
  v_mul_f32 v189, v189, v45
  v_mul_f32 v190, v190, v45
  v_mul_f32 v191, v191, v45
  v_mul_f32 v200, v200, v45
  v_mul_f32 v201, v201, v45
  v_mul_f32 v202, v202, v45
  v_mul_f32 v203, v203, v45
  v_mul_f32 v212, v212, v45
  v_mul_f32 v213, v213, v45
  v_mul_f32 v214, v214, v45
  v_mul_f32 v215, v215, v45
  v_mul_f32 v224, v224, v45
  v_mul_f32 v225, v225, v45
  v_mul_f32 v226, v226, v45
  v_mul_f32 v227, v227, v45
  v_mul_f32 v236, v236, v45
  v_mul_f32 v237, v237, v45
  v_mul_f32 v238, v238, v45
  v_mul_f32 v239, v239, v45
  v_mul_f32 v248, v248, v45
  v_mul_f32 v249, v249, v45
  v_mul_f32 v250, v250, v45
  v_mul_f32 v251, v251, v45
  v_lshlrev_b32 v124, 16, v120
  v_and_b32 v125, 0xffff0000, v120
  v_mul_f32 v124, v124, v45
  v_mul_f32 v125, v125, v45
  v_cvt_pk_bf16_f32 v120, v124, v125
  v_lshlrev_b32 v124, 16, v121
  v_and_b32 v125, 0xffff0000, v121
  v_mul_f32 v124, v124, v45
  v_mul_f32 v125, v125, v45
  v_cvt_pk_bf16_f32 v121, v124, v125
  v_lshlrev_b32 v124, 16, v122
  v_and_b32 v125, 0xffff0000, v122
  v_mul_f32 v124, v124, v45
  v_mul_f32 v125, v125, v45
  v_cvt_pk_bf16_f32 v122, v124, v125
  v_lshlrev_b32 v124, 16, v123
  v_and_b32 v125, 0xffff0000, v123
  v_mul_f32 v124, v124, v45
  v_mul_f32 v125, v125, v45
  v_cvt_pk_bf16_f32 v123, v124, v125
  v_max_f32 v22, 0, v22
  v_exp_f32 v45, -v22
  s_nop 0
  v_mul_f32 v52, v52, v45
  v_mul_f32 v168, v168, v45
  v_mul_f32 v169, v169, v45
  v_mul_f32 v170, v170, v45
  v_mul_f32 v171, v171, v45
  v_mul_f32 v180, v180, v45
  v_mul_f32 v181, v181, v45
  v_mul_f32 v182, v182, v45
  v_mul_f32 v183, v183, v45
  v_mul_f32 v192, v192, v45
  v_mul_f32 v193, v193, v45
  v_mul_f32 v194, v194, v45
  v_mul_f32 v195, v195, v45
  v_mul_f32 v204, v204, v45
  v_mul_f32 v205, v205, v45
  v_mul_f32 v206, v206, v45
  v_mul_f32 v207, v207, v45
  v_mul_f32 v216, v216, v45
  v_mul_f32 v217, v217, v45
  v_mul_f32 v218, v218, v45
  v_mul_f32 v219, v219, v45
  v_mul_f32 v228, v228, v45
  v_mul_f32 v229, v229, v45
  v_mul_f32 v230, v230, v45
  v_mul_f32 v231, v231, v45
  v_mul_f32 v240, v240, v45
  v_mul_f32 v241, v241, v45
  v_mul_f32 v242, v242, v45
  v_mul_f32 v243, v243, v45
  v_mul_f32 v252, v252, v45
  v_mul_f32 v253, v253, v45
  v_mul_f32 v254, v254, v45
  v_mul_f32 v255, v255, v45
  v_lshlrev_b32 v132, 16, v128
  v_and_b32 v133, 0xffff0000, v128
  v_mul_f32 v132, v132, v45
  v_mul_f32 v133, v133, v45
  v_cvt_pk_bf16_f32 v128, v132, v133
  v_lshlrev_b32 v132, 16, v129
  v_and_b32 v133, 0xffff0000, v129
  v_mul_f32 v132, v132, v45
  v_mul_f32 v133, v133, v45
  v_cvt_pk_bf16_f32 v129, v132, v133
  v_lshlrev_b32 v132, 16, v130
  v_and_b32 v133, 0xffff0000, v130
  v_mul_f32 v132, v132, v45
  v_mul_f32 v133, v133, v45
  v_cvt_pk_bf16_f32 v130, v132, v133
  v_lshlrev_b32 v132, 16, v131
  v_and_b32 v133, 0xffff0000, v131
  v_mul_f32 v132, v132, v45
  v_mul_f32 v133, v133, v45
  v_cvt_pk_bf16_f32 v131, v132, v133
L_fix1:
  v_sub_f32 v136, v136, v20
  v_sub_f32 v137, v137, v20
  v_sub_f32 v138, v138, v20
  v_sub_f32 v139, v139, v20
  v_sub_f32 v140, v140, v20
  v_sub_f32 v141, v141, v20
  v_sub_f32 v142, v142, v20
  v_sub_f32 v143, v143, v20
  v_sub_f32 v144, v144, v21
  v_sub_f32 v145, v145, v21
  v_sub_f32 v146, v146, v21
  v_sub_f32 v147, v147, v21
  v_sub_f32 v148, v148, v21
  v_sub_f32 v149, v149, v21
  v_sub_f32 v150, v150, v21
  v_sub_f32 v151, v151, v21
  v_sub_f32 v152, v152, v22
  v_sub_f32 v153, v153, v22
  v_sub_f32 v154, v154, v22
  v_sub_f32 v155, v155, v22
  v_sub_f32 v156, v156, v22
  v_sub_f32 v157, v157, v22
  v_sub_f32 v158, v158, v22
  v_sub_f32 v159, v159, v22
  v_sub_f32 v12, v12, v20
  v_sub_f32 v13, v13, v20
  v_sub_f32 v14, v14, v20
  v_sub_f32 v15, v15, v20
  v_sub_f32 v56, v56, v21
  v_sub_f32 v57, v57, v21
  v_sub_f32 v58, v58, v21
  v_sub_f32 v59, v59, v21
  v_sub_f32 v60, v60, v22
  v_sub_f32 v61, v61, v22
  v_sub_f32 v62, v62, v22
  v_sub_f32 v63, v63, v22
  s_mov_b32 s79, 0
  s_setpc_b64 s[92:93]
L_wo6:
  s_mov_b64 s[84:85], s[20:21]
  s_mov_b32 s86, 4194304
  s_mov_b32 s96, 256
  s_mov_b32 s95, 3
  v_lshl_add_u32 v0, v2, 10, v3
  s_lshl_b32 s94, s57, 4
  s_add_u32 s94, s94, s66
  s_sub_u32 s94, s94, 6
  s_lshl_b32 s94, s94, 15
  s_and_b32 s42, s3, 4
  s_lshl_b32 s42, s42, 12
  s_add_u32 s94, s94, s42
  s_branch L_wb7
L_cp12:
  s_mov_b32 m0, 159744
  s_add_u32 s69, s69, 8192
  buffer_load_dwordx4 v0, s[28:31], s69 offen lds
  s_add_u32 s69, s69, 8192
  buffer_load_dwordx4 v0, s[28:31], s69 offen lds
  s_branch L_cq13
L_w10:
  buffer_load_dwordx4 v0, s[84:87], s94 offen lds
  s_branch L_d11
L_w14:
  s_add_u32 s94, s94, s96
  buffer_load_dwordx4 v0, s[84:87], s94 offen lds
  s_branch L_d15
L_w16:
  s_add_u32 s94, s94, s96
  buffer_load_dwordx4 v0, s[84:87], s94 offen lds
  s_branch L_d17
L_w18:
  s_add_u32 s94, s94, s96
  buffer_load_dwordx4 v0, s[84:87], s94 offen lds
  s_branch L_d19
L_wo20:
  s_mov_b64 s[80:81], s[20:21]
  s_mov_b32 s82, 4194304
  s_mov_b32 s74, 256
  s_mov_b32 s73, 3
  v_lshl_add_u32 v4, v2, 10, v3
  s_lshl_b32 s72, s57, 4
  s_add_u32 s72, s72, s66
  s_sub_u32 s72, s72, 6
  s_lshl_b32 s72, s72, 15
  s_and_b32 s42, s3, 4
  s_lshl_b32 s42, s42, 12
  s_add_u32 s72, s72, s42
  s_branch L_wb21
L_cp26:
  s_mov_b32 m0, 159744
  s_add_u32 s69, s69, 8192
  buffer_load_dwordx4 v4, s[28:31], s69 offen lds
  s_add_u32 s69, s69, 8192
  buffer_load_dwordx4 v4, s[28:31], s69 offen lds
  s_branch L_cq27
L_w24:
  buffer_load_dwordx4 v4, s[80:83], s72 offen lds
  s_branch L_d25
L_w28:
  s_add_u32 s72, s72, s74
  buffer_load_dwordx4 v4, s[80:83], s72 offen lds
  s_branch L_d29
L_w30:
  s_add_u32 s72, s72, s74
  buffer_load_dwordx4 v4, s[80:83], s72 offen lds
  s_branch L_d31
L_w32:
  s_add_u32 s72, s72, s74
  buffer_load_dwordx4 v4, s[80:83], s72 offen lds
  s_branch L_d33
L_wo34:
  s_mov_b64 s[84:85], s[20:21]
  s_mov_b32 s86, 4194304
  s_mov_b32 s96, 256
  s_mov_b32 s95, 3
  v_lshl_add_u32 v0, v2, 10, v3
  s_lshl_b32 s94, s57, 4
  s_add_u32 s94, s94, s66
  s_sub_u32 s94, s94, 6
  s_lshl_b32 s94, s94, 15
  s_and_b32 s42, s3, 4
  s_lshl_b32 s42, s42, 12
  s_add_u32 s94, s94, s42
  s_branch L_wb35
L_cp40:
  s_mov_b32 m0, 159744
  s_add_u32 s69, s69, 8192
  buffer_load_dwordx4 v0, s[28:31], s69 offen lds
  s_add_u32 s69, s69, 8192
  buffer_load_dwordx4 v0, s[28:31], s69 offen lds
  s_branch L_cq41
L_w38:
  buffer_load_dwordx4 v0, s[84:87], s94 offen lds
  s_branch L_d39
L_w42:
  s_add_u32 s94, s94, s96
  buffer_load_dwordx4 v0, s[84:87], s94 offen lds
  s_branch L_d43
L_w44:
  s_add_u32 s94, s94, s96
  buffer_load_dwordx4 v0, s[84:87], s94 offen lds
  s_branch L_d45
L_w46:
  s_add_u32 s94, s94, s96
  buffer_load_dwordx4 v0, s[84:87], s94 offen lds
  s_branch L_d47
L_wo48:
  s_mov_b64 s[80:81], s[20:21]
  s_mov_b32 s82, 4194304
  s_mov_b32 s74, 256
  s_mov_b32 s73, 3
  v_lshl_add_u32 v4, v2, 10, v3
  s_lshl_b32 s72, s57, 4
  s_add_u32 s72, s72, s66
  s_sub_u32 s72, s72, 6
  s_lshl_b32 s72, s72, 15
  s_and_b32 s42, s3, 4
  s_lshl_b32 s42, s42, 12
  s_add_u32 s72, s72, s42
  s_branch L_wb49
L_cp54:
  s_mov_b32 m0, 159744
  s_add_u32 s69, s69, 8192
  buffer_load_dwordx4 v4, s[28:31], s69 offen lds
  s_add_u32 s69, s69, 8192
  buffer_load_dwordx4 v4, s[28:31], s69 offen lds
  s_branch L_cq55
L_w52:
  buffer_load_dwordx4 v4, s[80:83], s72 offen lds
  s_branch L_d53
L_w56:
  s_add_u32 s72, s72, s74
  buffer_load_dwordx4 v4, s[80:83], s72 offen lds
  s_branch L_d57
L_w58:
  s_add_u32 s72, s72, s74
  buffer_load_dwordx4 v4, s[80:83], s72 offen lds
  s_branch L_d59
L_w60:
  s_add_u32 s72, s72, s74
  buffer_load_dwordx4 v4, s[80:83], s72 offen lds
  s_branch L_d61
L_wo62:
  s_mov_b64 s[84:85], s[20:21]
  s_mov_b32 s86, 4194304
  s_mov_b32 s96, 256
  s_mov_b32 s95, 3
  v_lshl_add_u32 v0, v2, 10, v3
  s_lshl_b32 s94, s57, 4
  s_add_u32 s94, s94, s66
  s_sub_u32 s94, s94, 6
  s_lshl_b32 s94, s94, 15
  s_and_b32 s42, s3, 4
  s_lshl_b32 s42, s42, 12
  s_add_u32 s94, s94, s42
  s_branch L_wb63
L_wo64:
  s_mov_b64 s[84:85], s[20:21]
  s_mov_b32 s86, 4194304
  s_mov_b32 s96, 256
  s_mov_b32 s95, 3
  v_lshl_add_u32 v0, v2, 10, v3
  s_lshl_b32 s94, s57, 4
  s_add_u32 s94, s94, s66
  s_sub_u32 s94, s94, 6
  s_lshl_b32 s94, s94, 15
  s_and_b32 s42, s3, 4
  s_lshl_b32 s42, s42, 12
  s_add_u32 s94, s94, s42
  s_branch L_wb65
L_cp68:
  s_mov_b32 m0, 159744
  s_add_u32 s69, s69, 8192
  buffer_load_dwordx4 v0, s[28:31], s69 offen lds
  s_add_u32 s69, s69, 8192
  buffer_load_dwordx4 v0, s[28:31], s69 offen lds
  s_branch L_cq69
L_w66:
  buffer_load_dwordx4 v0, s[84:87], s94 offen lds
  s_branch L_d67
L_w70:
  s_add_u32 s94, s94, s96
  buffer_load_dwordx4 v0, s[84:87], s94 offen lds
  s_branch L_d71
L_w72:
  s_add_u32 s94, s94, s96
  buffer_load_dwordx4 v0, s[84:87], s94 offen lds
  s_branch L_d73
L_w74:
  s_add_u32 s94, s94, s96
  buffer_load_dwordx4 v0, s[84:87], s94 offen lds
  s_branch L_d75
L_pv_fix:
  s_cmp_eq_u32 s79, 0
  s_cbranch_scc0 L_pv_go
  s_call_b64 s[92:93], L_bfix
  s_branch L_pv_body
L_rb1:
  v_max3_f32 v21, v124, v125, v126
  v_max_f32 v21, v21, v127
  v_mov_b32 v22, v21
  s_nop 1
  v_permlane32_swap_b32 v21, v22
  s_nop 1
  v_max_f32 v21, v21, v22
  v_mov_b32 v22, v21
  s_nop 1
  v_permlane16_swap_b32 v21, v22
  s_nop 1
  v_max_f32 v21, v21, v22
  v_max_f32 v21, 0, v21
  v_exp_f32 v22, -v21
  v_add_f32 v60, v60, v21
  v_sub_f32 v124, v124, v21
  v_sub_f32 v125, v125, v21
  v_sub_f32 v126, v126, v21
  v_sub_f32 v127, v127, v21
  v_lshlrev_b32 v114, 16, v112
  v_and_b32 v115, 0xffff0000, v112
  v_mul_f32 v114, v114, v22
  v_mul_f32 v115, v115, v22
  v_cvt_pk_bf16_f32 v112, v114, v115
  v_lshlrev_b32 v114, 16, v113
  v_and_b32 v115, 0xffff0000, v113
  v_mul_f32 v114, v114, v22
  v_mul_f32 v115, v115, v22
  v_cvt_pk_bf16_f32 v113, v114, v115
  v_max3_f32 v21, v128, v129, v130
  v_max_f32 v21, v21, v131
  v_mov_b32 v22, v21
  s_nop 1
  v_permlane32_swap_b32 v21, v22
  s_nop 1
  v_max_f32 v21, v21, v22
  v_mov_b32 v22, v21
  s_nop 1
  v_permlane16_swap_b32 v21, v22
  s_nop 1
  v_max_f32 v21, v21, v22
  v_max_f32 v21, 0, v21
  v_exp_f32 v22, -v21
  v_add_f32 v62, v62, v21
  v_sub_f32 v128, v128, v21
  v_sub_f32 v129, v129, v21
  v_sub_f32 v130, v130, v21
  v_sub_f32 v131, v131, v21
  v_lshlrev_b32 v118, 16, v116
  v_and_b32 v119, 0xffff0000, v116
  v_mul_f32 v118, v118, v22
  v_mul_f32 v119, v119, v22
  v_cvt_pk_bf16_f32 v116, v118, v119
  v_lshlrev_b32 v118, 16, v117
  v_and_b32 v119, 0xffff0000, v117
  v_mul_f32 v118, v118, v22
  v_mul_f32 v119, v119, v22
  v_cvt_pk_bf16_f32 v117, v118, v119
  v_max3_f32 v21, v132, v133, v134
  v_max_f32 v21, v21, v135
  v_mov_b32 v22, v21
  s_nop 1
  v_permlane32_swap_b32 v21, v22
  s_nop 1
  v_max_f32 v21, v21, v22
  v_mov_b32 v22, v21
  s_nop 1
  v_permlane16_swap_b32 v21, v22
  s_nop 1
  v_max_f32 v21, v21, v22
  v_max_f32 v21, 0, v21
  v_exp_f32 v22, -v21
  v_add_f32 v64, v64, v21
  v_sub_f32 v132, v132, v21
  v_sub_f32 v133, v133, v21
  v_sub_f32 v134, v134, v21
  v_sub_f32 v135, v135, v21
  v_lshlrev_b32 v122, 16, v120
  v_and_b32 v123, 0xffff0000, v120
  v_mul_f32 v122, v122, v22
  v_mul_f32 v123, v123, v22
  v_cvt_pk_bf16_f32 v120, v122, v123
  v_lshlrev_b32 v122, 16, v121
  v_and_b32 v123, 0xffff0000, v121
  v_mul_f32 v122, v122, v22
  v_mul_f32 v123, v123, v22
  v_cvt_pk_bf16_f32 v121, v122, v123
  s_lshl_b32 s66, s3, 2
  v_add_u32 v21, s66, v15
  ds_write_b32 v21, v60 offset:0
  ds_write_b32 v21, v62 offset:512
  ds_write_b32 v21, v64 offset:1024
  v_mov_b32 v21, 162816
  v_mov_b32 v22, 1
  ds_write_b32 v21, v22
  s_branch L_nb1
L_rb2:
  v_max3_f32 v21, v136, v137, v138
  v_max_f32 v21, v21, v139
  v_mov_b32 v22, v21
  s_nop 1
  v_permlane32_swap_b32 v21, v22
  s_nop 1
  v_max_f32 v21, v21, v22
  v_mov_b32 v22, v21
  s_nop 1
  v_permlane16_swap_b32 v21, v22
  s_nop 1
  v_max_f32 v21, v21, v22
  v_max_f32 v21, 0, v21
  v_exp_f32 v22, -v21
  v_add_f32 v60, v60, v21
  v_sub_f32 v136, v136, v21
  v_sub_f32 v137, v137, v21
  v_sub_f32 v138, v138, v21
  v_sub_f32 v139, v139, v21
  v_lshlrev_b32 v114, 16, v112
  v_and_b32 v115, 0xffff0000, v112
  v_mul_f32 v114, v114, v22
  v_mul_f32 v115, v115, v22
  v_cvt_pk_bf16_f32 v112, v114, v115
  v_lshlrev_b32 v114, 16, v113
  v_and_b32 v115, 0xffff0000, v113
  v_mul_f32 v114, v114, v22
  v_mul_f32 v115, v115, v22
  v_cvt_pk_bf16_f32 v113, v114, v115
  v_lshlrev_b32 v114, 16, v124
  v_and_b32 v115, 0xffff0000, v124
  v_mul_f32 v114, v114, v22
  v_mul_f32 v115, v115, v22
  v_cvt_pk_bf16_f32 v124, v114, v115
  v_lshlrev_b32 v114, 16, v125
  v_and_b32 v115, 0xffff0000, v125
  v_mul_f32 v114, v114, v22
  v_mul_f32 v115, v115, v22
  v_cvt_pk_bf16_f32 v125, v114, v115
  v_max3_f32 v21, v140, v141, v142
  v_max_f32 v21, v21, v143
  v_mov_b32 v22, v21
  s_nop 1
  v_permlane32_swap_b32 v21, v22
  s_nop 1
  v_max_f32 v21, v21, v22
  v_mov_b32 v22, v21
  s_nop 1
  v_permlane16_swap_b32 v21, v22
  s_nop 1
  v_max_f32 v21, v21, v22
  v_max_f32 v21, 0, v21
  v_exp_f32 v22, -v21
  v_add_f32 v62, v62, v21
  v_sub_f32 v140, v140, v21
  v_sub_f32 v141, v141, v21
  v_sub_f32 v142, v142, v21
  v_sub_f32 v143, v143, v21
  v_lshlrev_b32 v118, 16, v116
  v_and_b32 v119, 0xffff0000, v116
  v_mul_f32 v118, v118, v22
  v_mul_f32 v119, v119, v22
  v_cvt_pk_bf16_f32 v116, v118, v119
  v_lshlrev_b32 v118, 16, v117
  v_and_b32 v119, 0xffff0000, v117
  v_mul_f32 v118, v118, v22
  v_mul_f32 v119, v119, v22
  v_cvt_pk_bf16_f32 v117, v118, v119
  v_lshlrev_b32 v118, 16, v128
  v_and_b32 v119, 0xffff0000, v128
  v_mul_f32 v118, v118, v22
  v_mul_f32 v119, v119, v22
  v_cvt_pk_bf16_f32 v128, v118, v119
  v_lshlrev_b32 v118, 16, v129
  v_and_b32 v119, 0xffff0000, v129
  v_mul_f32 v118, v118, v22
  v_mul_f32 v119, v119, v22
  v_cvt_pk_bf16_f32 v129, v118, v119
  v_max3_f32 v21, v144, v145, v146
  v_max_f32 v21, v21, v147
  v_mov_b32 v22, v21
  s_nop 1
  v_permlane32_swap_b32 v21, v22
  s_nop 1
  v_max_f32 v21, v21, v22
  v_mov_b32 v22, v21
  s_nop 1
  v_permlane16_swap_b32 v21, v22
  s_nop 1
  v_max_f32 v21, v21, v22
  v_max_f32 v21, 0, v21
  v_exp_f32 v22, -v21
  v_add_f32 v64, v64, v21
  v_sub_f32 v144, v144, v21
  v_sub_f32 v145, v145, v21
  v_sub_f32 v146, v146, v21
  v_sub_f32 v147, v147, v21
  v_lshlrev_b32 v122, 16, v120
  v_and_b32 v123, 0xffff0000, v120
  v_mul_f32 v122, v122, v22
  v_mul_f32 v123, v123, v22
  v_cvt_pk_bf16_f32 v120, v122, v123
  v_lshlrev_b32 v122, 16, v121
  v_and_b32 v123, 0xffff0000, v121
  v_mul_f32 v122, v122, v22
  v_mul_f32 v123, v123, v22
  v_cvt_pk_bf16_f32 v121, v122, v123
  v_lshlrev_b32 v122, 16, v132
  v_and_b32 v123, 0xffff0000, v132
  v_mul_f32 v122, v122, v22
  v_mul_f32 v123, v123, v22
  v_cvt_pk_bf16_f32 v132, v122, v123
  v_lshlrev_b32 v122, 16, v133
  v_and_b32 v123, 0xffff0000, v133
  v_mul_f32 v122, v122, v22
  v_mul_f32 v123, v123, v22
  v_cvt_pk_bf16_f32 v133, v122, v123
  s_lshl_b32 s66, s3, 2
  v_add_u32 v21, s66, v15
  ds_write_b32 v21, v60 offset:0
  ds_write_b32 v21, v62 offset:512
  ds_write_b32 v21, v64 offset:1024
  v_mov_b32 v21, 162816
  v_mov_b32 v22, 1
  ds_write_b32 v21, v22
  s_branch L_nb2
L_rb3:
  v_max3_f32 v21, v148, v149, v150
  v_max_f32 v21, v21, v151
  v_mov_b32 v22, v21
  s_nop 1
  v_permlane32_swap_b32 v21, v22
  s_nop 1
  v_max_f32 v21, v21, v22
  v_mov_b32 v22, v21
  s_nop 1
  v_permlane16_swap_b32 v21, v22
  s_nop 1
  v_max_f32 v21, v21, v22
  v_max_f32 v21, 0, v21
  v_exp_f32 v22, -v21
  v_add_f32 v60, v60, v21
  v_sub_f32 v148, v148, v21
  v_sub_f32 v149, v149, v21
  v_sub_f32 v150, v150, v21
  v_sub_f32 v151, v151, v21
  v_lshlrev_b32 v114, 16, v112
  v_and_b32 v115, 0xffff0000, v112
  v_mul_f32 v114, v114, v22
  v_mul_f32 v115, v115, v22
  v_cvt_pk_bf16_f32 v112, v114, v115
  v_lshlrev_b32 v114, 16, v113
  v_and_b32 v115, 0xffff0000, v113
  v_mul_f32 v114, v114, v22
  v_mul_f32 v115, v115, v22
  v_cvt_pk_bf16_f32 v113, v114, v115
  v_lshlrev_b32 v114, 16, v124
  v_and_b32 v115, 0xffff0000, v124
  v_mul_f32 v114, v114, v22
  v_mul_f32 v115, v115, v22
  v_cvt_pk_bf16_f32 v124, v114, v115
  v_lshlrev_b32 v114, 16, v125
  v_and_b32 v115, 0xffff0000, v125
  v_mul_f32 v114, v114, v22
  v_mul_f32 v115, v115, v22
  v_cvt_pk_bf16_f32 v125, v114, v115
  v_lshlrev_b32 v114, 16, v136
  v_and_b32 v115, 0xffff0000, v136
  v_mul_f32 v114, v114, v22
  v_mul_f32 v115, v115, v22
  v_cvt_pk_bf16_f32 v136, v114, v115
  v_lshlrev_b32 v114, 16, v137
  v_and_b32 v115, 0xffff0000, v137
  v_mul_f32 v114, v114, v22
  v_mul_f32 v115, v115, v22
  v_cvt_pk_bf16_f32 v137, v114, v115
  v_max3_f32 v21, v152, v153, v154
  v_max_f32 v21, v21, v155
  v_mov_b32 v22, v21
  s_nop 1
  v_permlane32_swap_b32 v21, v22
  s_nop 1
  v_max_f32 v21, v21, v22
  v_mov_b32 v22, v21
  s_nop 1
  v_permlane16_swap_b32 v21, v22
  s_nop 1
  v_max_f32 v21, v21, v22
  v_max_f32 v21, 0, v21
  v_exp_f32 v22, -v21
  v_add_f32 v62, v62, v21
  v_sub_f32 v152, v152, v21
  v_sub_f32 v153, v153, v21
  v_sub_f32 v154, v154, v21
  v_sub_f32 v155, v155, v21
  v_lshlrev_b32 v118, 16, v116
  v_and_b32 v119, 0xffff0000, v116
  v_mul_f32 v118, v118, v22
  v_mul_f32 v119, v119, v22
  v_cvt_pk_bf16_f32 v116, v118, v119
  v_lshlrev_b32 v118, 16, v117
  v_and_b32 v119, 0xffff0000, v117
  v_mul_f32 v118, v118, v22
  v_mul_f32 v119, v119, v22
  v_cvt_pk_bf16_f32 v117, v118, v119
  v_lshlrev_b32 v118, 16, v128
  v_and_b32 v119, 0xffff0000, v128
  v_mul_f32 v118, v118, v22
  v_mul_f32 v119, v119, v22
  v_cvt_pk_bf16_f32 v128, v118, v119
  v_lshlrev_b32 v118, 16, v129
  v_and_b32 v119, 0xffff0000, v129
  v_mul_f32 v118, v118, v22
  v_mul_f32 v119, v119, v22
  v_cvt_pk_bf16_f32 v129, v118, v119
  v_lshlrev_b32 v118, 16, v140
  v_and_b32 v119, 0xffff0000, v140
  v_mul_f32 v118, v118, v22
  v_mul_f32 v119, v119, v22
  v_cvt_pk_bf16_f32 v140, v118, v119
  v_lshlrev_b32 v118, 16, v141
  v_and_b32 v119, 0xffff0000, v141
  v_mul_f32 v118, v118, v22
  v_mul_f32 v119, v119, v22
  v_cvt_pk_bf16_f32 v141, v118, v119
  v_max3_f32 v21, v156, v157, v158
  v_max_f32 v21, v21, v159
  v_mov_b32 v22, v21
  s_nop 1
  v_permlane32_swap_b32 v21, v22
  s_nop 1
  v_max_f32 v21, v21, v22
  v_mov_b32 v22, v21
  s_nop 1
  v_permlane16_swap_b32 v21, v22
  s_nop 1
  v_max_f32 v21, v21, v22
  v_max_f32 v21, 0, v21
  v_exp_f32 v22, -v21
  v_add_f32 v64, v64, v21
  v_sub_f32 v156, v156, v21
  v_sub_f32 v157, v157, v21
  v_sub_f32 v158, v158, v21
  v_sub_f32 v159, v159, v21
  v_lshlrev_b32 v122, 16, v120
  v_and_b32 v123, 0xffff0000, v120
  v_mul_f32 v122, v122, v22
  v_mul_f32 v123, v123, v22
  v_cvt_pk_bf16_f32 v120, v122, v123
  v_lshlrev_b32 v122, 16, v121
  v_and_b32 v123, 0xffff0000, v121
  v_mul_f32 v122, v122, v22
  v_mul_f32 v123, v123, v22
  v_cvt_pk_bf16_f32 v121, v122, v123
  v_lshlrev_b32 v122, 16, v132
  v_and_b32 v123, 0xffff0000, v132
  v_mul_f32 v122, v122, v22
  v_mul_f32 v123, v123, v22
  v_cvt_pk_bf16_f32 v132, v122, v123
  v_lshlrev_b32 v122, 16, v133
  v_and_b32 v123, 0xffff0000, v133
  v_mul_f32 v122, v122, v22
  v_mul_f32 v123, v123, v22
  v_cvt_pk_bf16_f32 v133, v122, v123
  v_lshlrev_b32 v122, 16, v144
  v_and_b32 v123, 0xffff0000, v144
  v_mul_f32 v122, v122, v22
  v_mul_f32 v123, v123, v22
  v_cvt_pk_bf16_f32 v144, v122, v123
  v_lshlrev_b32 v122, 16, v145
  v_and_b32 v123, 0xffff0000, v145
  v_mul_f32 v122, v122, v22
  v_mul_f32 v123, v123, v22
  v_cvt_pk_bf16_f32 v145, v122, v123
  s_lshl_b32 s66, s3, 2
  v_add_u32 v21, s66, v15
  ds_write_b32 v21, v60 offset:0
  ds_write_b32 v21, v62 offset:512
  ds_write_b32 v21, v64 offset:1024
  v_mov_b32 v21, 162816
  v_mov_b32 v22, 1
  ds_write_b32 v21, v22
  s_branch L_nb3
L_bfix:
  s_waitcnt lgkmcnt(0)
  ds_read_b128 v[72:75], v15 offset:0
  ds_read_b128 v[76:79], v15 offset:16
  s_waitcnt lgkmcnt(0)
  v_max3_f32 v61, v60, v72, v73
  v_max3_f32 v61, v61, v74, v75
  v_max3_f32 v61, v61, v76, v77
  v_max3_f32 v61, v61, v78, v79
  v_sub_f32 v60, v60, v61
  v_exp_f32 v60, v60
  s_nop 0
  v_lshlrev_b32 v114, 16, v112
  v_and_b32 v115, 0xffff0000, v112
  v_mul_f32 v114, v114, v60
  v_mul_f32 v115, v115, v60
  v_cvt_pk_bf16_f32 v112, v114, v115
  v_lshlrev_b32 v114, 16, v113
  v_and_b32 v115, 0xffff0000, v113
  v_mul_f32 v114, v114, v60
  v_mul_f32 v115, v115, v60
  v_cvt_pk_bf16_f32 v113, v114, v115
  v_lshlrev_b32 v114, 16, v124
  v_and_b32 v115, 0xffff0000, v124
  v_mul_f32 v114, v114, v60
  v_mul_f32 v115, v115, v60
  v_cvt_pk_bf16_f32 v124, v114, v115
  v_lshlrev_b32 v114, 16, v125
  v_and_b32 v115, 0xffff0000, v125
  v_mul_f32 v114, v114, v60
  v_mul_f32 v115, v115, v60
  v_cvt_pk_bf16_f32 v125, v114, v115
  v_lshlrev_b32 v114, 16, v136
  v_and_b32 v115, 0xffff0000, v136
  v_mul_f32 v114, v114, v60
  v_mul_f32 v115, v115, v60
  v_cvt_pk_bf16_f32 v136, v114, v115
  v_lshlrev_b32 v114, 16, v137
  v_and_b32 v115, 0xffff0000, v137
  v_mul_f32 v114, v114, v60
  v_mul_f32 v115, v115, v60
  v_cvt_pk_bf16_f32 v137, v114, v115
  v_lshlrev_b32 v114, 16, v148
  v_and_b32 v115, 0xffff0000, v148
  v_mul_f32 v114, v114, v60
  v_mul_f32 v115, v115, v60
  v_cvt_pk_bf16_f32 v148, v114, v115
  v_lshlrev_b32 v114, 16, v149
  v_and_b32 v115, 0xffff0000, v149
  v_mul_f32 v114, v114, v60
  v_mul_f32 v115, v115, v60
  v_cvt_pk_bf16_f32 v149, v114, v115
  ds_read_b128 v[72:75], v15 offset:512
  ds_read_b128 v[76:79], v15 offset:528
  s_waitcnt lgkmcnt(0)
  v_max3_f32 v63, v62, v72, v73
  v_max3_f32 v63, v63, v74, v75
  v_max3_f32 v63, v63, v76, v77
  v_max3_f32 v63, v63, v78, v79
  v_sub_f32 v62, v62, v63
  v_exp_f32 v62, v62
  s_nop 0
  v_lshlrev_b32 v118, 16, v116
  v_and_b32 v119, 0xffff0000, v116
  v_mul_f32 v118, v118, v62
  v_mul_f32 v119, v119, v62
  v_cvt_pk_bf16_f32 v116, v118, v119
  v_lshlrev_b32 v118, 16, v117
  v_and_b32 v119, 0xffff0000, v117
  v_mul_f32 v118, v118, v62
  v_mul_f32 v119, v119, v62
  v_cvt_pk_bf16_f32 v117, v118, v119
  v_lshlrev_b32 v118, 16, v128
  v_and_b32 v119, 0xffff0000, v128
  v_mul_f32 v118, v118, v62
  v_mul_f32 v119, v119, v62
  v_cvt_pk_bf16_f32 v128, v118, v119
  v_lshlrev_b32 v118, 16, v129
  v_and_b32 v119, 0xffff0000, v129
  v_mul_f32 v118, v118, v62
  v_mul_f32 v119, v119, v62
  v_cvt_pk_bf16_f32 v129, v118, v119
  v_lshlrev_b32 v118, 16, v140
  v_and_b32 v119, 0xffff0000, v140
  v_mul_f32 v118, v118, v62
  v_mul_f32 v119, v119, v62
  v_cvt_pk_bf16_f32 v140, v118, v119
  v_lshlrev_b32 v118, 16, v141
  v_and_b32 v119, 0xffff0000, v141
  v_mul_f32 v118, v118, v62
  v_mul_f32 v119, v119, v62
  v_cvt_pk_bf16_f32 v141, v118, v119
  v_lshlrev_b32 v118, 16, v152
  v_and_b32 v119, 0xffff0000, v152
  v_mul_f32 v118, v118, v62
  v_mul_f32 v119, v119, v62
  v_cvt_pk_bf16_f32 v152, v118, v119
  v_lshlrev_b32 v118, 16, v153
  v_and_b32 v119, 0xffff0000, v153
  v_mul_f32 v118, v118, v62
  v_mul_f32 v119, v119, v62
  v_cvt_pk_bf16_f32 v153, v118, v119
  ds_read_b128 v[72:75], v15 offset:1024
  ds_read_b128 v[76:79], v15 offset:1040
  s_waitcnt lgkmcnt(0)
  v_max3_f32 v65, v64, v72, v73
  v_max3_f32 v65, v65, v74, v75
  v_max3_f32 v65, v65, v76, v77
  v_max3_f32 v65, v65, v78, v79
  v_sub_f32 v64, v64, v65
  v_exp_f32 v64, v64
  s_nop 0
  v_lshlrev_b32 v122, 16, v120
  v_and_b32 v123, 0xffff0000, v120
  v_mul_f32 v122, v122, v64
  v_mul_f32 v123, v123, v64
  v_cvt_pk_bf16_f32 v120, v122, v123
  v_lshlrev_b32 v122, 16, v121
  v_and_b32 v123, 0xffff0000, v121
  v_mul_f32 v122, v122, v64
  v_mul_f32 v123, v123, v64
  v_cvt_pk_bf16_f32 v121, v122, v123
  v_lshlrev_b32 v122, 16, v132
  v_and_b32 v123, 0xffff0000, v132
  v_mul_f32 v122, v122, v64
  v_mul_f32 v123, v123, v64
  v_cvt_pk_bf16_f32 v132, v122, v123
  v_lshlrev_b32 v122, 16, v133
  v_and_b32 v123, 0xffff0000, v133
  v_mul_f32 v122, v122, v64
  v_mul_f32 v123, v123, v64
  v_cvt_pk_bf16_f32 v133, v122, v123
  v_lshlrev_b32 v122, 16, v144
  v_and_b32 v123, 0xffff0000, v144
  v_mul_f32 v122, v122, v64
  v_mul_f32 v123, v123, v64
  v_cvt_pk_bf16_f32 v144, v122, v123
  v_lshlrev_b32 v122, 16, v145
  v_and_b32 v123, 0xffff0000, v145
  v_mul_f32 v122, v122, v64
  v_mul_f32 v123, v123, v64
  v_cvt_pk_bf16_f32 v145, v122, v123
  v_lshlrev_b32 v122, 16, v156
  v_and_b32 v123, 0xffff0000, v156
  v_mul_f32 v122, v122, v64
  v_mul_f32 v123, v123, v64
  v_cvt_pk_bf16_f32 v156, v122, v123
  v_lshlrev_b32 v122, 16, v157
  v_and_b32 v123, 0xffff0000, v157
  v_mul_f32 v122, v122, v64
  v_mul_f32 v123, v123, v64
  v_cvt_pk_bf16_f32 v157, v122, v123
  s_mov_b32 s79, 1
  s_cmp_eq_u32 s59, 3
  s_cbranch_scc1 L_bfix_ret
  s_barrier
  ds_write_b64 v13, v[112:113] offset:0
  ds_write_b64 v13, v[116:117] offset:4096
  ds_write_b64 v13, v[120:121] offset:8192
  ds_write_b64 v13, v[124:125] offset:12288
  ds_write_b64 v13, v[128:129] offset:16384
  ds_write_b64 v13, v[132:133] offset:20480
  ds_write_b64 v13, v[136:137] offset:24576
  ds_write_b64 v13, v[140:141] offset:28672
  ds_write_b64 v13, v[144:145] offset:32768
  ds_write_b64 v13, v[148:149] offset:36864
  ds_write_b64 v13, v[152:153] offset:40960
  ds_write_b64 v13, v[156:157] offset:45056
  s_waitcnt lgkmcnt(0)
  s_barrier
L_bfix_ret:
  s_setpc_b64 s[92:93]
L_reduce:
  s_lshl_b32 s25, s18, 10
  s_mul_i32 s24, s56, 786432
  s_add_u32 s24, s24, s25
  s_mul_i32 s26, s56, 393216
  s_add_u32 s25, s25, s26
  s_add_u32 s25, s25, 12582912
  s_mul_i32 s66, s18, 171
  s_lshr_b32 s66, s66, 11
  s_mul_i32 s67, s66, 12
  s_sub_u32 s67, s18, s67
  s_lshr_b32 s68, s67, 2
  s_and_b32 s67, s67, 3
  s_mul_i32 s26, s56, 98304
  s_lshl_b32 s68, s68, 15
  s_lshl_b32 s66, s66, 8
  s_lshl_b32 s67, s67, 6
  s_add_u32 s26, s26, s68
  s_add_u32 s26, s26, s66
  s_add_u32 s26, s26, s67
  v_mbcnt_lo_u32_b32 v24, -1, 0
  v_mbcnt_hi_u32_b32 v24, -1, v24
  v_lshlrev_b32 v25, 4, v24
  v_and_b32 v26, 15, v24
  v_lshlrev_b32 v26, 11, v26
  v_bfe_u32 v27, v24, 4, 1
  v_lshl_add_u32 v26, v27, 5, v26
  v_bfe_u32 v27, v24, 5, 1
  v_lshl_add_u32 v26, v27, 4, v26
  v_mov_b32 v27, 162824
  s_lshl_b32 s66, s56, 4
  v_mov_b32 v28, s66
  v_and_b32 v40, 15, v24
  v_lshlrev_b32 v40, 2, v40
  v_add_u32 v41, 163072, v40
  ds_read_b32 v41, v41
  s_lshl_b32 s68, s56, 8
  s_add_u32 s68, s68, 33554432
  v_mov_b32 v42, 162828
  s_waitcnt lgkmcnt(0)
  v_add_u32 v41, 1, v41
  s_mov_b32 s69, 0xffff0000
  s_mov_b32 s21, 0
  s_mov_b32 s23, 0
L_rd_poll:
  s_mov_b32 s20, 16777215
  s_cmp_eq_u32 s19, 2
  s_cbranch_scc1 L_rd_have
  s_cmp_eq_u32 s19, 1
  s_cbranch_scc1 L_rd_lds
  s_cmp_eq_u32 s23, 1
  s_cbranch_scc0 L_rd_go
L_rd_own:
  ds_read_b32 v29, v42
  s_waitcnt lgkmcnt(0)
  v_cmp_gt_u32 vcc, 4, v29
  s_cbranch_vccz L_rd_go
  s_sleep 2
  s_branch L_rd_own
L_rd_go:
  s_add_u32 s23, s23, 1
  buffer_load_dword v29, v40, s[12:15], s68 offen sc1
  s_waitcnt vmcnt(0)
  v_cmp_eq_u32 vcc, v29, v41
  s_nop 3
  s_and_b32 s20, vcc_lo, 0xffff
  s_and_b32 s66, s20, 0xff00
  s_lshl_b32 s66, s66, 8
  s_or_b32 s20, s20, s66
  v_mov_b32 v29, s20
  ds_write_b32 v27, v29
  s_branch L_rd_have
L_rd_lds:
  ds_read_b32 v29, v27
  s_waitcnt lgkmcnt(0)
  v_readfirstlane_b32 s20, v29
  s_nop 3
  s_cmp_lt_i32 s20, 0
  s_cbranch_scc1 L_rd_ret
L_rd_have:
  s_lshr_b32 s22, s20, 1
  s_and_b32 s22, s22, s20
  s_lshr_b32 s66, s22, 2
  s_and_b32 s22, s22, s66
  s_and_b32 s22, s22, 0x111111
  s_andn2_b32 s22, s22, s21
  s_cbranch_scc1 L_rd_work
  s_sleep 4
  s_cmp_eq_u32 s19, 0
  s_cbranch_scc0 L_rd_poll
  s_cmp_lt_u32 s23, 2000
  s_cbranch_scc1 L_rd_poll
  s_lshl_b32 s66, s58, 3
  s_add_u32 s66, s66, s57
  s_lshl_b32 s66, 1, s66
  v_mov_b32 v30, 0
  v_mov_b32 v31, s66
  s_mov_b64 exec, 1
  global_atomic_or_x2 v[32:33], v28, v[30:31], s[16:17] sc0 sc1
  s_waitcnt vmcnt(0)
  v_readfirstlane_b32 s20, v32
  s_mov_b64 exec, -1
  s_nop 3
  s_cmp_eq_u32 s20, 16777215
  s_cselect_b32 s20, s20, -1
  v_mov_b32 v29, s20
  ds_write_b32 v27, v29
  s_cbranch_scc0 L_rd_ret
  s_mov_b32 s19, 2
  s_branch L_rd_poll
L_rd_work:
  s_bitcmp1_b32 s22, 0
  s_cbranch_scc0 L_rg104
  s_add_u32 s66, s24, 0
  buffer_load_dwordx4 v[64:67], v25, s[12:15], s66 offen sc1
  s_add_u32 s66, s24, 49152
  buffer_load_dwordx4 v[68:71], v25, s[12:15], s66 offen sc1
  s_add_u32 s66, s24, 98304
  buffer_load_dwordx4 v[72:75], v25, s[12:15], s66 offen sc1
  s_add_u32 s66, s24, 147456
  buffer_load_dwordx4 v[76:79], v25, s[12:15], s66 offen sc1
L_rg104:
  s_bitcmp1_b32 s22, 4
  s_cbranch_scc0 L_rg105
  s_add_u32 s66, s24, 196608
  buffer_load_dwordx4 v[80:83], v25, s[12:15], s66 offen sc1
  s_add_u32 s66, s24, 245760
  buffer_load_dwordx4 v[84:87], v25, s[12:15], s66 offen sc1
  s_add_u32 s66, s24, 294912
  buffer_load_dwordx4 v[88:91], v25, s[12:15], s66 offen sc1
  s_add_u32 s66, s24, 344064
  buffer_load_dwordx4 v[92:95], v25, s[12:15], s66 offen sc1
L_rg105:
  s_bitcmp1_b32 s22, 8
  s_cbranch_scc0 L_rg106
  s_add_u32 s66, s24, 393216
  buffer_load_dwordx4 v[96:99], v25, s[12:15], s66 offen sc1
  s_add_u32 s66, s24, 442368
  buffer_load_dwordx4 v[100:103], v25, s[12:15], s66 offen sc1
  s_add_u32 s66, s24, 491520
  buffer_load_dwordx4 v[104:107], v25, s[12:15], s66 offen sc1
  s_add_u32 s66, s24, 540672
  buffer_load_dwordx4 v[108:111], v25, s[12:15], s66 offen sc1
L_rg106:
  s_bitcmp1_b32 s22, 12
  s_cbranch_scc0 L_rg107
  s_add_u32 s66, s24, 589824
  buffer_load_dwordx4 v[112:115], v25, s[12:15], s66 offen sc1
  s_add_u32 s66, s24, 638976
  buffer_load_dwordx4 v[116:119], v25, s[12:15], s66 offen sc1
  s_add_u32 s66, s24, 688128
  buffer_load_dwordx4 v[120:123], v25, s[12:15], s66 offen sc1
  s_add_u32 s66, s24, 737280
  buffer_load_dwordx4 v[124:127], v25, s[12:15], s66 offen sc1
L_rg107:
  s_bitcmp1_b32 s22, 16
  s_cbranch_scc0 L_rg108
  s_add_u32 s66, s25, 0
  buffer_load_dwordx4 v[128:131], v25, s[12:15], s66 offen sc1
  s_add_u32 s66, s25, 49152
  buffer_load_dwordx4 v[132:135], v25, s[12:15], s66 offen sc1
  s_add_u32 s66, s25, 98304
  buffer_load_dwordx4 v[136:139], v25, s[12:15], s66 offen sc1
  s_add_u32 s66, s25, 147456
  buffer_load_dwordx4 v[140:143], v25, s[12:15], s66 offen sc1
L_rg108:
  s_bitcmp1_b32 s22, 20
  s_cbranch_scc0 L_rg109
  s_add_u32 s66, s25, 196608
  buffer_load_dwordx4 v[144:147], v25, s[12:15], s66 offen sc1
  s_add_u32 s66, s25, 245760
  buffer_load_dwordx4 v[148:151], v25, s[12:15], s66 offen sc1
  s_add_u32 s66, s25, 294912
  buffer_load_dwordx4 v[152:155], v25, s[12:15], s66 offen sc1
  s_add_u32 s66, s25, 344064
  buffer_load_dwordx4 v[156:159], v25, s[12:15], s66 offen sc1
L_rg109:
  s_waitcnt vmcnt(0)
  s_bitcmp1_b32 s22, 0
  s_cbranch_scc0 L_rs110
  v_lshlrev_b32 v160, 16, v64
  v_and_b32 v161, s69, v64
  v_lshlrev_b32 v162, 16, v65
  v_and_b32 v163, s69, v65
  v_lshlrev_b32 v164, 16, v66
  v_and_b32 v165, s69, v66
  v_lshlrev_b32 v166, 16, v67
  v_and_b32 v167, s69, v67
  v_lshlrev_b32 v30, 16, v68
  v_and_b32 v31, s69, v68
  v_pk_add_f32 v[160:161], v[160:161], v[30:31]
  v_lshlrev_b32 v32, 16, v69
  v_and_b32 v33, s69, v69
  v_pk_add_f32 v[162:163], v[162:163], v[32:33]
  v_lshlrev_b32 v30, 16, v70
  v_and_b32 v31, s69, v70
  v_pk_add_f32 v[164:165], v[164:165], v[30:31]
  v_lshlrev_b32 v32, 16, v71
  v_and_b32 v33, s69, v71
  v_pk_add_f32 v[166:167], v[166:167], v[32:33]
  v_lshlrev_b32 v30, 16, v72
  v_and_b32 v31, s69, v72
  v_pk_add_f32 v[160:161], v[160:161], v[30:31]
  v_lshlrev_b32 v32, 16, v73
  v_and_b32 v33, s69, v73
  v_pk_add_f32 v[162:163], v[162:163], v[32:33]
  v_lshlrev_b32 v30, 16, v74
  v_and_b32 v31, s69, v74
  v_pk_add_f32 v[164:165], v[164:165], v[30:31]
  v_lshlrev_b32 v32, 16, v75
  v_and_b32 v33, s69, v75
  v_pk_add_f32 v[166:167], v[166:167], v[32:33]
  v_lshlrev_b32 v30, 16, v76
  v_and_b32 v31, s69, v76
  v_pk_add_f32 v[160:161], v[160:161], v[30:31]
  v_lshlrev_b32 v32, 16, v77
  v_and_b32 v33, s69, v77
  v_pk_add_f32 v[162:163], v[162:163], v[32:33]
  v_lshlrev_b32 v30, 16, v78
  v_and_b32 v31, s69, v78
  v_pk_add_f32 v[164:165], v[164:165], v[30:31]
  v_lshlrev_b32 v32, 16, v79
  v_and_b32 v33, s69, v79
  v_pk_add_f32 v[166:167], v[166:167], v[32:33]
L_rs110:
  s_bitcmp1_b32 s22, 4
  s_cbranch_scc0 L_rs111
  v_lshlrev_b32 v168, 16, v80
  v_and_b32 v169, s69, v80
  v_lshlrev_b32 v170, 16, v81
  v_and_b32 v171, s69, v81
  v_lshlrev_b32 v172, 16, v82
  v_and_b32 v173, s69, v82
  v_lshlrev_b32 v174, 16, v83
  v_and_b32 v175, s69, v83
  v_lshlrev_b32 v30, 16, v84
  v_and_b32 v31, s69, v84
  v_pk_add_f32 v[168:169], v[168:169], v[30:31]
  v_lshlrev_b32 v32, 16, v85
  v_and_b32 v33, s69, v85
  v_pk_add_f32 v[170:171], v[170:171], v[32:33]
  v_lshlrev_b32 v30, 16, v86
  v_and_b32 v31, s69, v86
  v_pk_add_f32 v[172:173], v[172:173], v[30:31]
  v_lshlrev_b32 v32, 16, v87
  v_and_b32 v33, s69, v87
  v_pk_add_f32 v[174:175], v[174:175], v[32:33]
  v_lshlrev_b32 v30, 16, v88
  v_and_b32 v31, s69, v88
  v_pk_add_f32 v[168:169], v[168:169], v[30:31]
  v_lshlrev_b32 v32, 16, v89
  v_and_b32 v33, s69, v89
  v_pk_add_f32 v[170:171], v[170:171], v[32:33]
  v_lshlrev_b32 v30, 16, v90
  v_and_b32 v31, s69, v90
  v_pk_add_f32 v[172:173], v[172:173], v[30:31]
  v_lshlrev_b32 v32, 16, v91
  v_and_b32 v33, s69, v91
  v_pk_add_f32 v[174:175], v[174:175], v[32:33]
  v_lshlrev_b32 v30, 16, v92
  v_and_b32 v31, s69, v92
  v_pk_add_f32 v[168:169], v[168:169], v[30:31]
  v_lshlrev_b32 v32, 16, v93
  v_and_b32 v33, s69, v93
  v_pk_add_f32 v[170:171], v[170:171], v[32:33]
  v_lshlrev_b32 v30, 16, v94
  v_and_b32 v31, s69, v94
  v_pk_add_f32 v[172:173], v[172:173], v[30:31]
  v_lshlrev_b32 v32, 16, v95
  v_and_b32 v33, s69, v95
  v_pk_add_f32 v[174:175], v[174:175], v[32:33]
L_rs111:
  s_bitcmp1_b32 s22, 8
  s_cbranch_scc0 L_rs112
  v_lshlrev_b32 v176, 16, v96
  v_and_b32 v177, s69, v96
  v_lshlrev_b32 v178, 16, v97
  v_and_b32 v179, s69, v97
  v_lshlrev_b32 v180, 16, v98
  v_and_b32 v181, s69, v98
  v_lshlrev_b32 v182, 16, v99
  v_and_b32 v183, s69, v99
  v_lshlrev_b32 v30, 16, v100
  v_and_b32 v31, s69, v100
  v_pk_add_f32 v[176:177], v[176:177], v[30:31]
  v_lshlrev_b32 v32, 16, v101
  v_and_b32 v33, s69, v101
  v_pk_add_f32 v[178:179], v[178:179], v[32:33]
  v_lshlrev_b32 v30, 16, v102
  v_and_b32 v31, s69, v102
  v_pk_add_f32 v[180:181], v[180:181], v[30:31]
  v_lshlrev_b32 v32, 16, v103
  v_and_b32 v33, s69, v103
  v_pk_add_f32 v[182:183], v[182:183], v[32:33]
  v_lshlrev_b32 v30, 16, v104
  v_and_b32 v31, s69, v104
  v_pk_add_f32 v[176:177], v[176:177], v[30:31]
  v_lshlrev_b32 v32, 16, v105
  v_and_b32 v33, s69, v105
  v_pk_add_f32 v[178:179], v[178:179], v[32:33]
  v_lshlrev_b32 v30, 16, v106
  v_and_b32 v31, s69, v106
  v_pk_add_f32 v[180:181], v[180:181], v[30:31]
  v_lshlrev_b32 v32, 16, v107
  v_and_b32 v33, s69, v107
  v_pk_add_f32 v[182:183], v[182:183], v[32:33]
  v_lshlrev_b32 v30, 16, v108
  v_and_b32 v31, s69, v108
  v_pk_add_f32 v[176:177], v[176:177], v[30:31]
  v_lshlrev_b32 v32, 16, v109
  v_and_b32 v33, s69, v109
  v_pk_add_f32 v[178:179], v[178:179], v[32:33]
  v_lshlrev_b32 v30, 16, v110
  v_and_b32 v31, s69, v110
  v_pk_add_f32 v[180:181], v[180:181], v[30:31]
  v_lshlrev_b32 v32, 16, v111
  v_and_b32 v33, s69, v111
  v_pk_add_f32 v[182:183], v[182:183], v[32:33]
L_rs112:
  s_bitcmp1_b32 s22, 12
  s_cbranch_scc0 L_rs113
  v_lshlrev_b32 v184, 16, v112
  v_and_b32 v185, s69, v112
  v_lshlrev_b32 v186, 16, v113
  v_and_b32 v187, s69, v113
  v_lshlrev_b32 v188, 16, v114
  v_and_b32 v189, s69, v114
  v_lshlrev_b32 v190, 16, v115
  v_and_b32 v191, s69, v115
  v_lshlrev_b32 v30, 16, v116
  v_and_b32 v31, s69, v116
  v_pk_add_f32 v[184:185], v[184:185], v[30:31]
  v_lshlrev_b32 v32, 16, v117
  v_and_b32 v33, s69, v117
  v_pk_add_f32 v[186:187], v[186:187], v[32:33]
  v_lshlrev_b32 v30, 16, v118
  v_and_b32 v31, s69, v118
  v_pk_add_f32 v[188:189], v[188:189], v[30:31]
  v_lshlrev_b32 v32, 16, v119
  v_and_b32 v33, s69, v119
  v_pk_add_f32 v[190:191], v[190:191], v[32:33]
  v_lshlrev_b32 v30, 16, v120
  v_and_b32 v31, s69, v120
  v_pk_add_f32 v[184:185], v[184:185], v[30:31]
  v_lshlrev_b32 v32, 16, v121
  v_and_b32 v33, s69, v121
  v_pk_add_f32 v[186:187], v[186:187], v[32:33]
  v_lshlrev_b32 v30, 16, v122
  v_and_b32 v31, s69, v122
  v_pk_add_f32 v[188:189], v[188:189], v[30:31]
  v_lshlrev_b32 v32, 16, v123
  v_and_b32 v33, s69, v123
  v_pk_add_f32 v[190:191], v[190:191], v[32:33]
  v_lshlrev_b32 v30, 16, v124
  v_and_b32 v31, s69, v124
  v_pk_add_f32 v[184:185], v[184:185], v[30:31]
  v_lshlrev_b32 v32, 16, v125
  v_and_b32 v33, s69, v125
  v_pk_add_f32 v[186:187], v[186:187], v[32:33]
  v_lshlrev_b32 v30, 16, v126
  v_and_b32 v31, s69, v126
  v_pk_add_f32 v[188:189], v[188:189], v[30:31]
  v_lshlrev_b32 v32, 16, v127
  v_and_b32 v33, s69, v127
  v_pk_add_f32 v[190:191], v[190:191], v[32:33]
L_rs113:
  s_bitcmp1_b32 s22, 16
  s_cbranch_scc0 L_rs114
  v_lshlrev_b32 v192, 16, v128
  v_and_b32 v193, s69, v128
  v_lshlrev_b32 v194, 16, v129
  v_and_b32 v195, s69, v129
  v_lshlrev_b32 v196, 16, v130
  v_and_b32 v197, s69, v130
  v_lshlrev_b32 v198, 16, v131
  v_and_b32 v199, s69, v131
  v_lshlrev_b32 v30, 16, v132
  v_and_b32 v31, s69, v132
  v_pk_add_f32 v[192:193], v[192:193], v[30:31]
  v_lshlrev_b32 v32, 16, v133
  v_and_b32 v33, s69, v133
  v_pk_add_f32 v[194:195], v[194:195], v[32:33]
  v_lshlrev_b32 v30, 16, v134
  v_and_b32 v31, s69, v134
  v_pk_add_f32 v[196:197], v[196:197], v[30:31]
  v_lshlrev_b32 v32, 16, v135
  v_and_b32 v33, s69, v135
  v_pk_add_f32 v[198:199], v[198:199], v[32:33]
  v_lshlrev_b32 v30, 16, v136
  v_and_b32 v31, s69, v136
  v_pk_add_f32 v[192:193], v[192:193], v[30:31]
  v_lshlrev_b32 v32, 16, v137
  v_and_b32 v33, s69, v137
  v_pk_add_f32 v[194:195], v[194:195], v[32:33]
  v_lshlrev_b32 v30, 16, v138
  v_and_b32 v31, s69, v138
  v_pk_add_f32 v[196:197], v[196:197], v[30:31]
  v_lshlrev_b32 v32, 16, v139
  v_and_b32 v33, s69, v139
  v_pk_add_f32 v[198:199], v[198:199], v[32:33]
  v_lshlrev_b32 v30, 16, v140
  v_and_b32 v31, s69, v140
  v_pk_add_f32 v[192:193], v[192:193], v[30:31]
  v_lshlrev_b32 v32, 16, v141
  v_and_b32 v33, s69, v141
  v_pk_add_f32 v[194:195], v[194:195], v[32:33]
  v_lshlrev_b32 v30, 16, v142
  v_and_b32 v31, s69, v142
  v_pk_add_f32 v[196:197], v[196:197], v[30:31]
  v_lshlrev_b32 v32, 16, v143
  v_and_b32 v33, s69, v143
  v_pk_add_f32 v[198:199], v[198:199], v[32:33]
L_rs114:
  s_bitcmp1_b32 s22, 20
  s_cbranch_scc0 L_rs115
  v_lshlrev_b32 v200, 16, v144
  v_and_b32 v201, s69, v144
  v_lshlrev_b32 v202, 16, v145
  v_and_b32 v203, s69, v145
  v_lshlrev_b32 v204, 16, v146
  v_and_b32 v205, s69, v146
  v_lshlrev_b32 v206, 16, v147
  v_and_b32 v207, s69, v147
  v_lshlrev_b32 v30, 16, v148
  v_and_b32 v31, s69, v148
  v_pk_add_f32 v[200:201], v[200:201], v[30:31]
  v_lshlrev_b32 v32, 16, v149
  v_and_b32 v33, s69, v149
  v_pk_add_f32 v[202:203], v[202:203], v[32:33]
  v_lshlrev_b32 v30, 16, v150
  v_and_b32 v31, s69, v150
  v_pk_add_f32 v[204:205], v[204:205], v[30:31]
  v_lshlrev_b32 v32, 16, v151
  v_and_b32 v33, s69, v151
  v_pk_add_f32 v[206:207], v[206:207], v[32:33]
  v_lshlrev_b32 v30, 16, v152
  v_and_b32 v31, s69, v152
  v_pk_add_f32 v[200:201], v[200:201], v[30:31]
  v_lshlrev_b32 v32, 16, v153
  v_and_b32 v33, s69, v153
  v_pk_add_f32 v[202:203], v[202:203], v[32:33]
  v_lshlrev_b32 v30, 16, v154
  v_and_b32 v31, s69, v154
  v_pk_add_f32 v[204:205], v[204:205], v[30:31]
  v_lshlrev_b32 v32, 16, v155
  v_and_b32 v33, s69, v155
  v_pk_add_f32 v[206:207], v[206:207], v[32:33]
  v_lshlrev_b32 v30, 16, v156
  v_and_b32 v31, s69, v156
  v_pk_add_f32 v[200:201], v[200:201], v[30:31]
  v_lshlrev_b32 v32, 16, v157
  v_and_b32 v33, s69, v157
  v_pk_add_f32 v[202:203], v[202:203], v[32:33]
  v_lshlrev_b32 v30, 16, v158
  v_and_b32 v31, s69, v158
  v_pk_add_f32 v[204:205], v[204:205], v[30:31]
  v_lshlrev_b32 v32, 16, v159
  v_and_b32 v33, s69, v159
  v_pk_add_f32 v[206:207], v[206:207], v[32:33]
L_rs115:
  s_or_b32 s21, s21, s22
  s_cmp_eq_u32 s21, 0x111111
  s_cbranch_scc0 L_rd_poll
  v_pk_add_f32 v[160:161], v[160:161], v[168:169]
  v_pk_add_f32 v[162:163], v[162:163], v[170:171]
  v_pk_add_f32 v[164:165], v[164:165], v[172:173]
  v_pk_add_f32 v[166:167], v[166:167], v[174:175]
  v_pk_add_f32 v[176:177], v[176:177], v[184:185]
  v_pk_add_f32 v[178:179], v[178:179], v[186:187]
  v_pk_add_f32 v[180:181], v[180:181], v[188:189]
  v_pk_add_f32 v[182:183], v[182:183], v[190:191]
  v_pk_add_f32 v[192:193], v[192:193], v[200:201]
  v_pk_add_f32 v[194:195], v[194:195], v[202:203]
  v_pk_add_f32 v[196:197], v[196:197], v[204:205]
  v_pk_add_f32 v[198:199], v[198:199], v[206:207]
  v_pk_add_f32 v[160:161], v[160:161], v[176:177]
  v_pk_add_f32 v[162:163], v[162:163], v[178:179]
  v_pk_add_f32 v[164:165], v[164:165], v[180:181]
  v_pk_add_f32 v[166:167], v[166:167], v[182:183]
  v_cvt_pk_bf16_f32 v32, v192, v193
  v_cvt_pk_bf16_f32 v33, v194, v195
  v_cvt_pk_bf16_f32 v34, v196, v197
  v_cvt_pk_bf16_f32 v35, v198, v199
  v_cvt_pk_bf16_f32 v36, v160, v161
  v_cvt_pk_bf16_f32 v37, v162, v163
  v_cvt_pk_bf16_f32 v38, v164, v165
  v_cvt_pk_bf16_f32 v39, v166, v167
  buffer_store_dwordx4 v[32:35], v26, s[8:11], s26 offen sc1
  buffer_store_dwordx4 v[36:39], v26, s[8:11], s26 offen offset:1024 sc1
L_rd_ret:
  s_setpc_b64 s[92:93]
L_qproj:
  s_mov_b32 s75, 0
  s_bitcmp1_b32 s3, 2
  s_cbranch_scc1 L_load
  s_waitcnt lgkmcnt(0)
  s_barrier
  v_add_u32 v16, s4, v5
  v_xor_b32 v17, 32, v16
  ds_read_b64_tr_b16 v[72:73], v16 offset:0
  ds_read_b64_tr_b16 v[74:75], v16 offset:1024
  ds_read_b64_tr_b16 v[76:77], v17 offset:0
  ds_read_b64_tr_b16 v[78:79], v17 offset:1024
  ds_read_b128 v[80:83], v8 offset:0
  ds_read_b128 v[84:87], v8 offset:4096
  ds_read_b128 v[88:91], v8 offset:8192
  ds_read_b64_tr_b16 v[92:93], v16 offset:8192
  ds_read_b64_tr_b16 v[94:95], v16 offset:9216
  ds_read_b64_tr_b16 v[96:97], v17 offset:8192
  ds_read_b64_tr_b16 v[98:99], v17 offset:9216
  ds_read_b128 v[100:103], v9 offset:0
  ds_read_b128 v[104:107], v9 offset:4096
  ds_read_b128 v[108:111], v9 offset:8192
  s_waitcnt lgkmcnt(7)
  v_mfma_f32_16x16x32_bf16 v[24:27], v[72:75], v[80:83], 0
  s_add_u32 s4, s4, 32768
  v_mfma_f32_16x16x32_bf16 v[28:31], v[72:75], v[84:87], 0
  s_cmp_eq_u32 s4, 98304
  s_cselect_b32 s4, 0, s4
  v_mfma_f32_16x16x32_bf16 v[32:35], v[72:75], v[88:91], 0
  v_add_u32 v18, s4, v5
  v_mfma_f32_16x16x32_bf16 v[36:39], v[76:79], v[80:83], 0
  v_xor_b32 v19, 32, v18
  v_mfma_f32_16x16x32_bf16 v[40:43], v[76:79], v[84:87], 0
  v_mfma_f32_16x16x32_bf16 v[44:47], v[76:79], v[88:91], 0
  ds_read_b64_tr_b16 v[72:73], v16 offset:16384
  ds_read_b64_tr_b16 v[74:75], v16 offset:17408
  ds_read_b64_tr_b16 v[76:77], v17 offset:16384
  ds_read_b64_tr_b16 v[78:79], v17 offset:17408
  ds_read_b128 v[80:83], v10 offset:0
  ds_read_b128 v[84:87], v10 offset:4096
  ds_read_b128 v[88:91], v10 offset:8192
  s_waitcnt lgkmcnt(7)
  v_mfma_f32_16x16x32_bf16 v[24:27], v[92:95], v[100:103], v[24:27]
  v_mfma_f32_16x16x32_bf16 v[28:31], v[92:95], v[104:107], v[28:31]
  v_mfma_f32_16x16x32_bf16 v[32:35], v[92:95], v[108:111], v[32:35]
  v_mfma_f32_16x16x32_bf16 v[36:39], v[96:99], v[100:103], v[36:39]
  v_mfma_f32_16x16x32_bf16 v[40:43], v[96:99], v[104:107], v[40:43]
  v_mfma_f32_16x16x32_bf16 v[44:47], v[96:99], v[108:111], v[44:47]
  ds_read_b64_tr_b16 v[92:93], v16 offset:24576
  ds_read_b64_tr_b16 v[94:95], v16 offset:25600
  ds_read_b64_tr_b16 v[96:97], v17 offset:24576
  ds_read_b64_tr_b16 v[98:99], v17 offset:25600
  ds_read_b128 v[100:103], v11 offset:0
  ds_read_b128 v[104:107], v11 offset:4096
  ds_read_b128 v[108:111], v11 offset:8192
  s_waitcnt lgkmcnt(7)
  v_mfma_f32_16x16x32_bf16 v[24:27], v[72:75], v[80:83], v[24:27]
  v_mfma_f32_16x16x32_bf16 v[28:31], v[72:75], v[84:87], v[28:31]
  v_mfma_f32_16x16x32_bf16 v[32:35], v[72:75], v[88:91], v[32:35]
  v_mfma_f32_16x16x32_bf16 v[36:39], v[76:79], v[80:83], v[36:39]
  v_mfma_f32_16x16x32_bf16 v[40:43], v[76:79], v[84:87], v[40:43]
  v_mfma_f32_16x16x32_bf16 v[44:47], v[76:79], v[88:91], v[44:47]
  s_waitcnt lgkmcnt(0)
  s_barrier
  ds_read_b64_tr_b16 v[72:73], v18 offset:0
  ds_read_b64_tr_b16 v[74:75], v18 offset:1024
  ds_read_b64_tr_b16 v[76:77], v19 offset:0
  ds_read_b64_tr_b16 v[78:79], v19 offset:1024
  ds_read_b128 v[80:83], v8 offset:12288
  ds_read_b128 v[84:87], v8 offset:16384
  ds_read_b128 v[88:91], v8 offset:20480
  v_mfma_f32_16x16x32_bf16 v[24:27], v[92:95], v[100:103], v[24:27]
  s_add_u32 s4, s4, 32768
  v_mfma_f32_16x16x32_bf16 v[28:31], v[92:95], v[104:107], v[28:31]
  s_cmp_eq_u32 s4, 98304
  s_cselect_b32 s4, 0, s4
  v_mfma_f32_16x16x32_bf16 v[32:35], v[92:95], v[108:111], v[32:35]
  v_add_u32 v16, s4, v5
  v_mfma_f32_16x16x32_bf16 v[36:39], v[96:99], v[100:103], v[36:39]
  v_xor_b32 v17, 32, v16
  v_mfma_f32_16x16x32_bf16 v[40:43], v[96:99], v[104:107], v[40:43]
  v_mfma_f32_16x16x32_bf16 v[44:47], v[96:99], v[108:111], v[44:47]
  ds_read_b64_tr_b16 v[92:93], v18 offset:8192
  ds_read_b64_tr_b16 v[94:95], v18 offset:9216
  ds_read_b64_tr_b16 v[96:97], v19 offset:8192
  ds_read_b64_tr_b16 v[98:99], v19 offset:9216
  ds_read_b128 v[100:103], v9 offset:12288
  ds_read_b128 v[104:107], v9 offset:16384
  ds_read_b128 v[108:111], v9 offset:20480
  s_waitcnt lgkmcnt(7)
  v_mfma_f32_16x16x32_bf16 v[24:27], v[72:75], v[80:83], v[24:27]
  v_mfma_f32_16x16x32_bf16 v[28:31], v[72:75], v[84:87], v[28:31]
  v_mfma_f32_16x16x32_bf16 v[32:35], v[72:75], v[88:91], v[32:35]
  v_mfma_f32_16x16x32_bf16 v[36:39], v[76:79], v[80:83], v[36:39]
  v_mfma_f32_16x16x32_bf16 v[40:43], v[76:79], v[84:87], v[40:43]
  v_mfma_f32_16x16x32_bf16 v[44:47], v[76:79], v[88:91], v[44:47]
  ds_read_b64_tr_b16 v[72:73], v18 offset:16384
  ds_read_b64_tr_b16 v[74:75], v18 offset:17408
  ds_read_b64_tr_b16 v[76:77], v19 offset:16384
  ds_read_b64_tr_b16 v[78:79], v19 offset:17408
  ds_read_b128 v[80:83], v10 offset:12288
  ds_read_b128 v[84:87], v10 offset:16384
  ds_read_b128 v[88:91], v10 offset:20480
  s_waitcnt lgkmcnt(7)
  v_mfma_f32_16x16x32_bf16 v[24:27], v[92:95], v[100:103], v[24:27]
  v_mfma_f32_16x16x32_bf16 v[28:31], v[92:95], v[104:107], v[28:31]
  v_mfma_f32_16x16x32_bf16 v[32:35], v[92:95], v[108:111], v[32:35]
  v_mfma_f32_16x16x32_bf16 v[36:39], v[96:99], v[100:103], v[36:39]
  v_mfma_f32_16x16x32_bf16 v[40:43], v[96:99], v[104:107], v[40:43]
  v_mfma_f32_16x16x32_bf16 v[44:47], v[96:99], v[108:111], v[44:47]
  ds_read_b64_tr_b16 v[92:93], v18 offset:24576
  ds_read_b64_tr_b16 v[94:95], v18 offset:25600
  ds_read_b64_tr_b16 v[96:97], v19 offset:24576
  ds_read_b64_tr_b16 v[98:99], v19 offset:25600
  ds_read_b128 v[100:103], v11 offset:12288
  ds_read_b128 v[104:107], v11 offset:16384
  ds_read_b128 v[108:111], v11 offset:20480
  s_waitcnt lgkmcnt(7)
  v_mfma_f32_16x16x32_bf16 v[24:27], v[72:75], v[80:83], v[24:27]
  v_mfma_f32_16x16x32_bf16 v[28:31], v[72:75], v[84:87], v[28:31]
  v_mfma_f32_16x16x32_bf16 v[32:35], v[72:75], v[88:91], v[32:35]
  v_mfma_f32_16x16x32_bf16 v[36:39], v[76:79], v[80:83], v[36:39]
  v_mfma_f32_16x16x32_bf16 v[40:43], v[76:79], v[84:87], v[40:43]
  v_mfma_f32_16x16x32_bf16 v[44:47], v[76:79], v[88:91], v[44:47]
  s_waitcnt lgkmcnt(0)
  s_barrier
  ds_read_b64_tr_b16 v[72:73], v16 offset:0
  ds_read_b64_tr_b16 v[74:75], v16 offset:1024
  ds_read_b64_tr_b16 v[76:77], v17 offset:0
  ds_read_b64_tr_b16 v[78:79], v17 offset:1024
  ds_read_b128 v[80:83], v8 offset:24576
  ds_read_b128 v[84:87], v8 offset:28672
  ds_read_b128 v[88:91], v8 offset:32768
  v_mfma_f32_16x16x32_bf16 v[24:27], v[92:95], v[100:103], v[24:27]
  s_add_u32 s4, s4, 32768
  v_mfma_f32_16x16x32_bf16 v[28:31], v[92:95], v[104:107], v[28:31]
  s_cmp_eq_u32 s4, 98304
  s_cselect_b32 s4, 0, s4
  v_mfma_f32_16x16x32_bf16 v[32:35], v[92:95], v[108:111], v[32:35]
  v_add_u32 v18, s4, v5
  v_mfma_f32_16x16x32_bf16 v[36:39], v[96:99], v[100:103], v[36:39]
  v_xor_b32 v19, 32, v18
  v_mfma_f32_16x16x32_bf16 v[40:43], v[96:99], v[104:107], v[40:43]
  v_mfma_f32_16x16x32_bf16 v[44:47], v[96:99], v[108:111], v[44:47]
  ds_read_b64_tr_b16 v[92:93], v16 offset:8192
  ds_read_b64_tr_b16 v[94:95], v16 offset:9216
  ds_read_b64_tr_b16 v[96:97], v17 offset:8192
  ds_read_b64_tr_b16 v[98:99], v17 offset:9216
  ds_read_b128 v[100:103], v9 offset:24576
  ds_read_b128 v[104:107], v9 offset:28672
  ds_read_b128 v[108:111], v9 offset:32768
  s_waitcnt lgkmcnt(7)
  v_mfma_f32_16x16x32_bf16 v[24:27], v[72:75], v[80:83], v[24:27]
  v_mfma_f32_16x16x32_bf16 v[28:31], v[72:75], v[84:87], v[28:31]
  v_mfma_f32_16x16x32_bf16 v[32:35], v[72:75], v[88:91], v[32:35]
  v_mfma_f32_16x16x32_bf16 v[36:39], v[76:79], v[80:83], v[36:39]
  v_mfma_f32_16x16x32_bf16 v[40:43], v[76:79], v[84:87], v[40:43]
  v_mfma_f32_16x16x32_bf16 v[44:47], v[76:79], v[88:91], v[44:47]
  ds_read_b64_tr_b16 v[72:73], v16 offset:16384
  ds_read_b64_tr_b16 v[74:75], v16 offset:17408
  ds_read_b64_tr_b16 v[76:77], v17 offset:16384
  ds_read_b64_tr_b16 v[78:79], v17 offset:17408
  ds_read_b128 v[80:83], v10 offset:24576
  ds_read_b128 v[84:87], v10 offset:28672
  ds_read_b128 v[88:91], v10 offset:32768
  s_waitcnt lgkmcnt(7)
  v_mfma_f32_16x16x32_bf16 v[24:27], v[92:95], v[100:103], v[24:27]
  v_mfma_f32_16x16x32_bf16 v[28:31], v[92:95], v[104:107], v[28:31]
  v_mfma_f32_16x16x32_bf16 v[32:35], v[92:95], v[108:111], v[32:35]
  v_mfma_f32_16x16x32_bf16 v[36:39], v[96:99], v[100:103], v[36:39]
  v_mfma_f32_16x16x32_bf16 v[40:43], v[96:99], v[104:107], v[40:43]
  v_mfma_f32_16x16x32_bf16 v[44:47], v[96:99], v[108:111], v[44:47]
  ds_read_b64_tr_b16 v[92:93], v16 offset:24576
  ds_read_b64_tr_b16 v[94:95], v16 offset:25600
  ds_read_b64_tr_b16 v[96:97], v17 offset:24576
  ds_read_b64_tr_b16 v[98:99], v17 offset:25600
  ds_read_b128 v[100:103], v11 offset:24576
  ds_read_b128 v[104:107], v11 offset:28672
  ds_read_b128 v[108:111], v11 offset:32768
  s_waitcnt lgkmcnt(7)
  v_mfma_f32_16x16x32_bf16 v[24:27], v[72:75], v[80:83], v[24:27]
  v_mfma_f32_16x16x32_bf16 v[28:31], v[72:75], v[84:87], v[28:31]
  v_mfma_f32_16x16x32_bf16 v[32:35], v[72:75], v[88:91], v[32:35]
  v_mfma_f32_16x16x32_bf16 v[36:39], v[76:79], v[80:83], v[36:39]
  v_mfma_f32_16x16x32_bf16 v[40:43], v[76:79], v[84:87], v[40:43]
  v_mfma_f32_16x16x32_bf16 v[44:47], v[76:79], v[88:91], v[44:47]
  s_waitcnt lgkmcnt(0)
  s_barrier
  ds_read_b64_tr_b16 v[72:73], v18 offset:0
  ds_read_b64_tr_b16 v[74:75], v18 offset:1024
  ds_read_b64_tr_b16 v[76:77], v19 offset:0
  ds_read_b64_tr_b16 v[78:79], v19 offset:1024
  ds_read_b128 v[80:83], v8 offset:36864
  ds_read_b128 v[84:87], v8 offset:40960
  ds_read_b128 v[88:91], v8 offset:45056
  v_mfma_f32_16x16x32_bf16 v[24:27], v[92:95], v[100:103], v[24:27]
  s_add_u32 s4, s4, 32768
  v_mfma_f32_16x16x32_bf16 v[28:31], v[92:95], v[104:107], v[28:31]
  s_cmp_eq_u32 s4, 98304
  s_cselect_b32 s4, 0, s4
  v_mfma_f32_16x16x32_bf16 v[32:35], v[92:95], v[108:111], v[32:35]
  v_mfma_f32_16x16x32_bf16 v[36:39], v[96:99], v[100:103], v[36:39]
  v_mfma_f32_16x16x32_bf16 v[40:43], v[96:99], v[104:107], v[40:43]
  v_mfma_f32_16x16x32_bf16 v[44:47], v[96:99], v[108:111], v[44:47]
  ds_read_b64_tr_b16 v[92:93], v18 offset:8192
  ds_read_b64_tr_b16 v[94:95], v18 offset:9216
  ds_read_b64_tr_b16 v[96:97], v19 offset:8192
  ds_read_b64_tr_b16 v[98:99], v19 offset:9216
  ds_read_b128 v[100:103], v9 offset:36864
  ds_read_b128 v[104:107], v9 offset:40960
  ds_read_b128 v[108:111], v9 offset:45056
  s_waitcnt lgkmcnt(7)
  v_mfma_f32_16x16x32_bf16 v[24:27], v[72:75], v[80:83], v[24:27]
  v_mfma_f32_16x16x32_bf16 v[28:31], v[72:75], v[84:87], v[28:31]
  v_mfma_f32_16x16x32_bf16 v[32:35], v[72:75], v[88:91], v[32:35]
  v_mfma_f32_16x16x32_bf16 v[36:39], v[76:79], v[80:83], v[36:39]
  v_mfma_f32_16x16x32_bf16 v[40:43], v[76:79], v[84:87], v[40:43]
  v_mfma_f32_16x16x32_bf16 v[44:47], v[76:79], v[88:91], v[44:47]
  ds_read_b64_tr_b16 v[72:73], v18 offset:16384
  ds_read_b64_tr_b16 v[74:75], v18 offset:17408
  ds_read_b64_tr_b16 v[76:77], v19 offset:16384
  ds_read_b64_tr_b16 v[78:79], v19 offset:17408
  ds_read_b128 v[80:83], v10 offset:36864
  ds_read_b128 v[84:87], v10 offset:40960
  ds_read_b128 v[88:91], v10 offset:45056
  s_waitcnt lgkmcnt(7)
  v_mfma_f32_16x16x32_bf16 v[24:27], v[92:95], v[100:103], v[24:27]
  v_mfma_f32_16x16x32_bf16 v[28:31], v[92:95], v[104:107], v[28:31]
  v_mfma_f32_16x16x32_bf16 v[32:35], v[92:95], v[108:111], v[32:35]
  v_mfma_f32_16x16x32_bf16 v[36:39], v[96:99], v[100:103], v[36:39]
  v_mfma_f32_16x16x32_bf16 v[40:43], v[96:99], v[104:107], v[40:43]
  v_mfma_f32_16x16x32_bf16 v[44:47], v[96:99], v[108:111], v[44:47]
  ds_read_b64_tr_b16 v[92:93], v18 offset:24576
  ds_read_b64_tr_b16 v[94:95], v18 offset:25600
  ds_read_b64_tr_b16 v[96:97], v19 offset:24576
  ds_read_b64_tr_b16 v[98:99], v19 offset:25600
  ds_read_b128 v[100:103], v11 offset:36864
  ds_read_b128 v[104:107], v11 offset:40960
  ds_read_b128 v[108:111], v11 offset:45056
  s_waitcnt lgkmcnt(7)
  v_mfma_f32_16x16x32_bf16 v[24:27], v[72:75], v[80:83], v[24:27]
  v_mfma_f32_16x16x32_bf16 v[28:31], v[72:75], v[84:87], v[28:31]
  v_mfma_f32_16x16x32_bf16 v[32:35], v[72:75], v[88:91], v[32:35]
  v_mfma_f32_16x16x32_bf16 v[36:39], v[76:79], v[80:83], v[36:39]
  v_mfma_f32_16x16x32_bf16 v[40:43], v[76:79], v[84:87], v[40:43]
  v_mfma_f32_16x16x32_bf16 v[44:47], v[76:79], v[88:91], v[44:47]
  s_waitcnt lgkmcnt(0)
  s_cmp_eq_u32 s65, 0
  s_cbranch_scc0 L_e116
  s_barrier
L_e116:
  v_mfma_f32_16x16x32_bf16 v[24:27], v[92:95], v[100:103], v[24:27]
  v_mfma_f32_16x16x32_bf16 v[28:31], v[92:95], v[104:107], v[28:31]
  v_mfma_f32_16x16x32_bf16 v[32:35], v[92:95], v[108:111], v[32:35]
  v_mfma_f32_16x16x32_bf16 v[36:39], v[96:99], v[100:103], v[36:39]
  v_mfma_f32_16x16x32_bf16 v[40:43], v[96:99], v[104:107], v[40:43]
  v_mfma_f32_16x16x32_bf16 v[44:47], v[96:99], v[108:111], v[44:47]
  v_mov_b32 v16, s61
  s_nop 6
  v_pk_mul_f32 v[24:25], v[24:25], v[16:17] op_sel_hi:[1,0]
  v_pk_mul_f32 v[26:27], v[26:27], v[16:17] op_sel_hi:[1,0]
  v_cvt_pk_bf16_f32 v24, v24, v25
  v_cvt_pk_bf16_f32 v25, v26, v27
  v_pk_mul_f32 v[28:29], v[28:29], v[16:17] op_sel_hi:[1,0]
  v_pk_mul_f32 v[30:31], v[30:31], v[16:17] op_sel_hi:[1,0]
  v_cvt_pk_bf16_f32 v26, v28, v29
  v_cvt_pk_bf16_f32 v27, v30, v31
  v_pk_mul_f32 v[32:33], v[32:33], v[16:17] op_sel_hi:[1,0]
  v_pk_mul_f32 v[34:35], v[34:35], v[16:17] op_sel_hi:[1,0]
  v_cvt_pk_bf16_f32 v28, v32, v33
  v_cvt_pk_bf16_f32 v29, v34, v35
  v_pk_mul_f32 v[36:37], v[36:37], v[16:17] op_sel_hi:[1,0]
  v_pk_mul_f32 v[38:39], v[38:39], v[16:17] op_sel_hi:[1,0]
  v_cvt_pk_bf16_f32 v30, v36, v37
  v_cvt_pk_bf16_f32 v31, v38, v39
  v_pk_mul_f32 v[40:41], v[40:41], v[16:17] op_sel_hi:[1,0]
  v_pk_mul_f32 v[42:43], v[42:43], v[16:17] op_sel_hi:[1,0]
  v_cvt_pk_bf16_f32 v32, v40, v41
  v_cvt_pk_bf16_f32 v33, v42, v43
  v_pk_mul_f32 v[44:45], v[44:45], v[16:17] op_sel_hi:[1,0]
  v_pk_mul_f32 v[46:47], v[46:47], v[16:17] op_sel_hi:[1,0]
  v_cvt_pk_bf16_f32 v34, v44, v45
  v_cvt_pk_bf16_f32 v35, v46, v47
  s_setpc_b64 s[92:93]
L_wide:
  s_bitcmp1_b32 s3, 2
  s_cbranch_scc1 L_load
  s_lshl_b32 s67, s3, 13
  s_mov_b32 s70, 0
  s_cmp_eq_u32 s75, 0
  s_cselect_b32 s68, 31, 15
  s_add_u32 s66, s4, s67
  v_add_u32 v19, s66, v6
  s_and_b32 s69, s63, 3
  s_lshl_b32 s69, s69, 6
  s_lshr_b32 s71, s63, 2
  s_mul_i32 s71, s71, 12288
  v_xor_b32 v21, s69, v8
  v_add_u32 v21, s71, v21
  s_waitcnt lgkmcnt(0)
  s_barrier
  ds_read_b128 v[24:27], v21 offset:0
  ds_read_b128 v[28:31], v21 offset:4096
  ds_read_b128 v[32:35], v21 offset:8192
  v_xor_b32 v17, 0, v19
  ds_read_b64_tr_b16 v[72:73], v17 offset:0
  ds_read_b64_tr_b16 v[74:75], v17 offset:1024
  v_xor_b32 v17, 192, v19
  ds_read_b64_tr_b16 v[96:97], v17 offset:0
  ds_read_b64_tr_b16 v[98:99], v17 offset:1024
  v_xor_b32 v18, 32, v19
  ds_read_b64_tr_b16 v[76:77], v18 offset:0
  ds_read_b64_tr_b16 v[78:79], v18 offset:1024
  v_xor_b32 v18, 224, v19
  ds_read_b64_tr_b16 v[100:101], v18 offset:0
  ds_read_b64_tr_b16 v[102:103], v18 offset:1024
  v_xor_b32 v17, 64, v19
  ds_read_b64_tr_b16 v[80:81], v17 offset:0
  ds_read_b64_tr_b16 v[82:83], v17 offset:1024
  v_xor_b32 v18, 96, v19
  ds_read_b64_tr_b16 v[84:85], v18 offset:0
  ds_read_b64_tr_b16 v[86:87], v18 offset:1024
  v_xor_b32 v17, 128, v19
  ds_read_b64_tr_b16 v[88:89], v17 offset:0
  ds_read_b64_tr_b16 v[90:91], v17 offset:1024
  v_xor_b32 v18, 160, v19
  ds_read_b64_tr_b16 v[92:93], v18 offset:0
  ds_read_b64_tr_b16 v[94:95], v18 offset:1024
  s_add_u32 s4, s4, 32768
  s_cmp_eq_u32 s4, 98304
  s_cselect_b32 s4, 0, s4
  s_add_u32 s63, s63, 1
  s_and_b32 s63, s63, s68
  s_add_u32 s66, s4, s67
  v_add_u32 v22, s66, v6
  s_and_b32 s69, s63, 3
  s_lshl_b32 s69, s69, 6
  s_lshr_b32 s71, s63, 2
  s_mul_i32 s71, s71, 12288
  v_xor_b32 v21, s69, v8
  v_add_u32 v21, s71, v21
  s_cmp_eq_u32 s91, 0
  s_cbranch_scc1 L_wide_loop
  s_mov_b32 s91, 0
  s_waitcnt lgkmcnt(0)
  s_barrier
  v_mfma_f32_16x16x32_bf16 v[160:163], v[72:75], v[24:27], 0
  v_mfma_f32_16x16x32_bf16 v[164:167], v[72:75], v[28:31], 0
  v_mfma_f32_16x16x32_bf16 v[168:171], v[72:75], v[32:35], 0
  ds_read_b128 v[36:39], v21 offset:0
  ds_read_b128 v[40:43], v21 offset:4096
  ds_read_b128 v[44:47], v21 offset:8192
  v_xor_b32 v17, 0, v22
  ds_read_b64_tr_b16 v[72:73], v17 offset:0
  ds_read_b64_tr_b16 v[74:75], v17 offset:1024
  v_xor_b32 v17, 192, v22
  ds_read_b64_tr_b16 v[104:105], v17 offset:0
  ds_read_b64_tr_b16 v[106:107], v17 offset:1024
  v_mfma_f32_16x16x32_bf16 v[172:175], v[76:79], v[24:27], 0
  s_add_u32 s4, s4, 32768
  v_mfma_f32_16x16x32_bf16 v[176:179], v[76:79], v[28:31], 0
  s_cmp_eq_u32 s4, 98304
  s_cselect_b32 s4, 0, s4
  v_mfma_f32_16x16x32_bf16 v[180:183], v[76:79], v[32:35], 0
  s_add_u32 s63, s63, 1
  v_xor_b32 v18, 32, v22
  ds_read_b64_tr_b16 v[76:77], v18 offset:0
  ds_read_b64_tr_b16 v[78:79], v18 offset:1024
  v_xor_b32 v18, 224, v22
  ds_read_b64_tr_b16 v[108:109], v18 offset:0
  ds_read_b64_tr_b16 v[110:111], v18 offset:1024
  v_mfma_f32_16x16x32_bf16 v[184:187], v[80:83], v[24:27], 0
  s_and_b32 s63, s63, s68
  v_mfma_f32_16x16x32_bf16 v[188:191], v[80:83], v[28:31], 0
  s_add_u32 s66, s4, s67
  v_mfma_f32_16x16x32_bf16 v[192:195], v[80:83], v[32:35], 0
  v_add_u32 v19, s66, v6
  v_xor_b32 v17, 64, v22
  ds_read_b64_tr_b16 v[80:81], v17 offset:0
  ds_read_b64_tr_b16 v[82:83], v17 offset:1024
  v_mfma_f32_16x16x32_bf16 v[196:199], v[84:87], v[24:27], 0
  s_and_b32 s69, s63, 3
  v_mfma_f32_16x16x32_bf16 v[200:203], v[84:87], v[28:31], 0
  s_lshl_b32 s69, s69, 6
  v_mfma_f32_16x16x32_bf16 v[204:207], v[84:87], v[32:35], 0
  s_lshr_b32 s71, s63, 2
  v_xor_b32 v18, 96, v22
  ds_read_b64_tr_b16 v[84:85], v18 offset:0
  ds_read_b64_tr_b16 v[86:87], v18 offset:1024
  v_mfma_f32_16x16x32_bf16 v[208:211], v[88:91], v[24:27], 0
  s_mul_i32 s71, s71, 12288
  v_mfma_f32_16x16x32_bf16 v[212:215], v[88:91], v[28:31], 0
  v_xor_b32 v21, s69, v8
  v_mfma_f32_16x16x32_bf16 v[216:219], v[88:91], v[32:35], 0
  v_add_u32 v21, s71, v21
  v_xor_b32 v17, 128, v22
  ds_read_b64_tr_b16 v[88:89], v17 offset:0
  ds_read_b64_tr_b16 v[90:91], v17 offset:1024
  v_mfma_f32_16x16x32_bf16 v[220:223], v[92:95], v[24:27], 0
  v_mfma_f32_16x16x32_bf16 v[224:227], v[92:95], v[28:31], 0
  v_mfma_f32_16x16x32_bf16 v[228:231], v[92:95], v[32:35], 0
  v_xor_b32 v18, 160, v22
  ds_read_b64_tr_b16 v[92:93], v18 offset:0
  ds_read_b64_tr_b16 v[94:95], v18 offset:1024
  v_mfma_f32_16x16x32_bf16 v[232:235], v[96:99], v[24:27], 0
  v_mfma_f32_16x16x32_bf16 v[236:239], v[96:99], v[28:31], 0
  v_mfma_f32_16x16x32_bf16 v[240:243], v[96:99], v[32:35], 0
  v_mfma_f32_16x16x32_bf16 v[244:247], v[100:103], v[24:27], 0
  v_mfma_f32_16x16x32_bf16 v[248:251], v[100:103], v[28:31], 0
  v_mfma_f32_16x16x32_bf16 v[252:255], v[100:103], v[32:35], 0
  s_branch L_wide_s2
L_wide_loop:
  s_waitcnt lgkmcnt(0)
  s_barrier
  v_mfma_f32_16x16x32_bf16 v[160:163], v[72:75], v[24:27], v[160:163]
  v_mfma_f32_16x16x32_bf16 v[164:167], v[72:75], v[28:31], v[164:167]
  v_mfma_f32_16x16x32_bf16 v[168:171], v[72:75], v[32:35], v[168:171]
  ds_read_b128 v[36:39], v21 offset:0
  ds_read_b128 v[40:43], v21 offset:4096
  ds_read_b128 v[44:47], v21 offset:8192
  v_xor_b32 v17, 0, v22
  ds_read_b64_tr_b16 v[72:73], v17 offset:0
  ds_read_b64_tr_b16 v[74:75], v17 offset:1024
  v_xor_b32 v17, 192, v22
  ds_read_b64_tr_b16 v[104:105], v17 offset:0
  ds_read_b64_tr_b16 v[106:107], v17 offset:1024
  v_mfma_f32_16x16x32_bf16 v[172:175], v[76:79], v[24:27], v[172:175]
  s_add_u32 s4, s4, 32768
  v_mfma_f32_16x16x32_bf16 v[176:179], v[76:79], v[28:31], v[176:179]
  s_cmp_eq_u32 s4, 98304
  s_cselect_b32 s4, 0, s4
  v_mfma_f32_16x16x32_bf16 v[180:183], v[76:79], v[32:35], v[180:183]
  s_add_u32 s63, s63, 1
  v_xor_b32 v18, 32, v22
  ds_read_b64_tr_b16 v[76:77], v18 offset:0
  ds_read_b64_tr_b16 v[78:79], v18 offset:1024
  v_xor_b32 v18, 224, v22
  ds_read_b64_tr_b16 v[108:109], v18 offset:0
  ds_read_b64_tr_b16 v[110:111], v18 offset:1024
  v_mfma_f32_16x16x32_bf16 v[184:187], v[80:83], v[24:27], v[184:187]
  s_and_b32 s63, s63, s68
  v_mfma_f32_16x16x32_bf16 v[188:191], v[80:83], v[28:31], v[188:191]
  s_add_u32 s66, s4, s67
  v_mfma_f32_16x16x32_bf16 v[192:195], v[80:83], v[32:35], v[192:195]
  v_add_u32 v19, s66, v6
  v_xor_b32 v17, 64, v22
  ds_read_b64_tr_b16 v[80:81], v17 offset:0
  ds_read_b64_tr_b16 v[82:83], v17 offset:1024
  v_mfma_f32_16x16x32_bf16 v[196:199], v[84:87], v[24:27], v[196:199]
  s_and_b32 s69, s63, 3
  v_mfma_f32_16x16x32_bf16 v[200:203], v[84:87], v[28:31], v[200:203]
  s_lshl_b32 s69, s69, 6
  v_mfma_f32_16x16x32_bf16 v[204:207], v[84:87], v[32:35], v[204:207]
  s_lshr_b32 s71, s63, 2
  v_xor_b32 v18, 96, v22
  ds_read_b64_tr_b16 v[84:85], v18 offset:0
  ds_read_b64_tr_b16 v[86:87], v18 offset:1024
  v_mfma_f32_16x16x32_bf16 v[208:211], v[88:91], v[24:27], v[208:211]
  s_mul_i32 s71, s71, 12288
  v_mfma_f32_16x16x32_bf16 v[212:215], v[88:91], v[28:31], v[212:215]
  v_xor_b32 v21, s69, v8
  v_mfma_f32_16x16x32_bf16 v[216:219], v[88:91], v[32:35], v[216:219]
  v_add_u32 v21, s71, v21
  v_xor_b32 v17, 128, v22
  ds_read_b64_tr_b16 v[88:89], v17 offset:0
  ds_read_b64_tr_b16 v[90:91], v17 offset:1024
  v_mfma_f32_16x16x32_bf16 v[220:223], v[92:95], v[24:27], v[220:223]
  v_mfma_f32_16x16x32_bf16 v[224:227], v[92:95], v[28:31], v[224:227]
  v_mfma_f32_16x16x32_bf16 v[228:231], v[92:95], v[32:35], v[228:231]
  v_xor_b32 v18, 160, v22
  ds_read_b64_tr_b16 v[92:93], v18 offset:0
  ds_read_b64_tr_b16 v[94:95], v18 offset:1024
  v_mfma_f32_16x16x32_bf16 v[232:235], v[96:99], v[24:27], v[232:235]
  v_mfma_f32_16x16x32_bf16 v[236:239], v[96:99], v[28:31], v[236:239]
  v_mfma_f32_16x16x32_bf16 v[240:243], v[96:99], v[32:35], v[240:243]
  v_mfma_f32_16x16x32_bf16 v[244:247], v[100:103], v[24:27], v[244:247]
  v_mfma_f32_16x16x32_bf16 v[248:251], v[100:103], v[28:31], v[248:251]
  v_mfma_f32_16x16x32_bf16 v[252:255], v[100:103], v[32:35], v[252:255]
L_wide_s2:
  s_waitcnt lgkmcnt(0)
  s_barrier
  v_mfma_f32_16x16x32_bf16 v[160:163], v[72:75], v[36:39], v[160:163]
  v_mfma_f32_16x16x32_bf16 v[164:167], v[72:75], v[40:43], v[164:167]
  v_mfma_f32_16x16x32_bf16 v[168:171], v[72:75], v[44:47], v[168:171]
  ds_read_b128 v[24:27], v21 offset:0
  ds_read_b128 v[28:31], v21 offset:4096
  ds_read_b128 v[32:35], v21 offset:8192
  v_xor_b32 v17, 0, v19
  ds_read_b64_tr_b16 v[72:73], v17 offset:0
  ds_read_b64_tr_b16 v[74:75], v17 offset:1024
  v_xor_b32 v17, 192, v19
  ds_read_b64_tr_b16 v[96:97], v17 offset:0
  ds_read_b64_tr_b16 v[98:99], v17 offset:1024
  v_mfma_f32_16x16x32_bf16 v[172:175], v[76:79], v[36:39], v[172:175]
  s_add_u32 s4, s4, 32768
  v_mfma_f32_16x16x32_bf16 v[176:179], v[76:79], v[40:43], v[176:179]
  s_cmp_eq_u32 s4, 98304
  s_cselect_b32 s4, 0, s4
  v_mfma_f32_16x16x32_bf16 v[180:183], v[76:79], v[44:47], v[180:183]
  s_add_u32 s63, s63, 1
  v_xor_b32 v18, 32, v19
  ds_read_b64_tr_b16 v[76:77], v18 offset:0
  ds_read_b64_tr_b16 v[78:79], v18 offset:1024
  v_xor_b32 v18, 224, v19
  ds_read_b64_tr_b16 v[100:101], v18 offset:0
  ds_read_b64_tr_b16 v[102:103], v18 offset:1024
  v_mfma_f32_16x16x32_bf16 v[184:187], v[80:83], v[36:39], v[184:187]
  s_and_b32 s63, s63, s68
  v_mfma_f32_16x16x32_bf16 v[188:191], v[80:83], v[40:43], v[188:191]
  s_add_u32 s66, s4, s67
  v_mfma_f32_16x16x32_bf16 v[192:195], v[80:83], v[44:47], v[192:195]
  v_add_u32 v22, s66, v6
  v_xor_b32 v17, 64, v19
  ds_read_b64_tr_b16 v[80:81], v17 offset:0
  ds_read_b64_tr_b16 v[82:83], v17 offset:1024
  v_mfma_f32_16x16x32_bf16 v[196:199], v[84:87], v[36:39], v[196:199]
  s_and_b32 s69, s63, 3
  v_mfma_f32_16x16x32_bf16 v[200:203], v[84:87], v[40:43], v[200:203]
  s_lshl_b32 s69, s69, 6
  v_mfma_f32_16x16x32_bf16 v[204:207], v[84:87], v[44:47], v[204:207]
  s_lshr_b32 s71, s63, 2
  v_xor_b32 v18, 96, v19
  ds_read_b64_tr_b16 v[84:85], v18 offset:0
  ds_read_b64_tr_b16 v[86:87], v18 offset:1024
  v_mfma_f32_16x16x32_bf16 v[208:211], v[88:91], v[36:39], v[208:211]
  s_mul_i32 s71, s71, 12288
  v_mfma_f32_16x16x32_bf16 v[212:215], v[88:91], v[40:43], v[212:215]
  v_xor_b32 v21, s69, v8
  v_mfma_f32_16x16x32_bf16 v[216:219], v[88:91], v[44:47], v[216:219]
  v_add_u32 v21, s71, v21
  v_xor_b32 v17, 128, v19
  ds_read_b64_tr_b16 v[88:89], v17 offset:0
  ds_read_b64_tr_b16 v[90:91], v17 offset:1024
  v_mfma_f32_16x16x32_bf16 v[220:223], v[92:95], v[36:39], v[220:223]
  v_mfma_f32_16x16x32_bf16 v[224:227], v[92:95], v[40:43], v[224:227]
  v_mfma_f32_16x16x32_bf16 v[228:231], v[92:95], v[44:47], v[228:231]
  v_xor_b32 v18, 160, v19
  ds_read_b64_tr_b16 v[92:93], v18 offset:0
  ds_read_b64_tr_b16 v[94:95], v18 offset:1024
  v_mfma_f32_16x16x32_bf16 v[232:235], v[104:107], v[36:39], v[232:235]
  v_mfma_f32_16x16x32_bf16 v[236:239], v[104:107], v[40:43], v[236:239]
  v_mfma_f32_16x16x32_bf16 v[240:243], v[104:107], v[44:47], v[240:243]
  v_mfma_f32_16x16x32_bf16 v[244:247], v[108:111], v[36:39], v[244:247]
  v_mfma_f32_16x16x32_bf16 v[248:251], v[108:111], v[40:43], v[248:251]
  v_mfma_f32_16x16x32_bf16 v[252:255], v[108:111], v[44:47], v[252:255]
  s_waitcnt lgkmcnt(0)
  s_barrier
  v_mfma_f32_16x16x32_bf16 v[160:163], v[72:75], v[24:27], v[160:163]
  v_mfma_f32_16x16x32_bf16 v[164:167], v[72:75], v[28:31], v[164:167]
  v_mfma_f32_16x16x32_bf16 v[168:171], v[72:75], v[32:35], v[168:171]
  ds_read_b128 v[36:39], v21 offset:0
  ds_read_b128 v[40:43], v21 offset:4096
  ds_read_b128 v[44:47], v21 offset:8192
  v_xor_b32 v17, 0, v22
  ds_read_b64_tr_b16 v[72:73], v17 offset:0
  ds_read_b64_tr_b16 v[74:75], v17 offset:1024
  v_xor_b32 v17, 192, v22
  ds_read_b64_tr_b16 v[104:105], v17 offset:0
  ds_read_b64_tr_b16 v[106:107], v17 offset:1024
  v_mfma_f32_16x16x32_bf16 v[172:175], v[76:79], v[24:27], v[172:175]
  s_add_u32 s4, s4, 32768
  v_mfma_f32_16x16x32_bf16 v[176:179], v[76:79], v[28:31], v[176:179]
  s_cmp_eq_u32 s4, 98304
  s_cselect_b32 s4, 0, s4
  v_mfma_f32_16x16x32_bf16 v[180:183], v[76:79], v[32:35], v[180:183]
  s_add_u32 s70, s70, 12288
  v_xor_b32 v18, 32, v22
  ds_read_b64_tr_b16 v[76:77], v18 offset:0
  ds_read_b64_tr_b16 v[78:79], v18 offset:1024
  v_xor_b32 v18, 224, v22
  ds_read_b64_tr_b16 v[108:109], v18 offset:0
  ds_read_b64_tr_b16 v[110:111], v18 offset:1024
  v_mfma_f32_16x16x32_bf16 v[184:187], v[80:83], v[24:27], v[184:187]
  s_add_u32 s63, s63, 1
  v_mfma_f32_16x16x32_bf16 v[188:191], v[80:83], v[28:31], v[188:191]
  s_and_b32 s63, s63, s68
  v_mfma_f32_16x16x32_bf16 v[192:195], v[80:83], v[32:35], v[192:195]
  s_add_u32 s66, s4, s67
  v_xor_b32 v17, 64, v22
  ds_read_b64_tr_b16 v[80:81], v17 offset:0
  ds_read_b64_tr_b16 v[82:83], v17 offset:1024
  v_mfma_f32_16x16x32_bf16 v[196:199], v[84:87], v[24:27], v[196:199]
  v_add_u32 v19, s66, v6
  v_mfma_f32_16x16x32_bf16 v[200:203], v[84:87], v[28:31], v[200:203]
  s_and_b32 s69, s63, 3
  v_mfma_f32_16x16x32_bf16 v[204:207], v[84:87], v[32:35], v[204:207]
  s_lshl_b32 s69, s69, 6
  v_xor_b32 v18, 96, v22
  ds_read_b64_tr_b16 v[84:85], v18 offset:0
  ds_read_b64_tr_b16 v[86:87], v18 offset:1024
  v_mfma_f32_16x16x32_bf16 v[208:211], v[88:91], v[24:27], v[208:211]
  s_lshr_b32 s71, s63, 2
  v_mfma_f32_16x16x32_bf16 v[212:215], v[88:91], v[28:31], v[212:215]
  s_mul_i32 s71, s71, 12288
  v_mfma_f32_16x16x32_bf16 v[216:219], v[88:91], v[32:35], v[216:219]
  v_xor_b32 v21, s69, v8
  v_xor_b32 v17, 128, v22
  ds_read_b64_tr_b16 v[88:89], v17 offset:0
  ds_read_b64_tr_b16 v[90:91], v17 offset:1024
  v_mfma_f32_16x16x32_bf16 v[220:223], v[92:95], v[24:27], v[220:223]
  v_add_u32 v21, s71, v21
  v_mfma_f32_16x16x32_bf16 v[224:227], v[92:95], v[28:31], v[224:227]
  v_mfma_f32_16x16x32_bf16 v[228:231], v[92:95], v[32:35], v[228:231]
  v_xor_b32 v18, 160, v22
  ds_read_b64_tr_b16 v[92:93], v18 offset:0
  ds_read_b64_tr_b16 v[94:95], v18 offset:1024
  v_mfma_f32_16x16x32_bf16 v[232:235], v[96:99], v[24:27], v[232:235]
  v_mfma_f32_16x16x32_bf16 v[236:239], v[96:99], v[28:31], v[236:239]
  v_mfma_f32_16x16x32_bf16 v[240:243], v[96:99], v[32:35], v[240:243]
  v_mfma_f32_16x16x32_bf16 v[244:247], v[100:103], v[24:27], v[244:247]
  v_mfma_f32_16x16x32_bf16 v[248:251], v[100:103], v[28:31], v[248:251]
  v_mfma_f32_16x16x32_bf16 v[252:255], v[100:103], v[32:35], v[252:255]
  s_cmp_gt_u32 s70, s75
  s_cbranch_scc1 L_wide_drain
  s_waitcnt lgkmcnt(0)
  s_barrier
  v_mfma_f32_16x16x32_bf16 v[160:163], v[72:75], v[36:39], v[160:163]
  v_mfma_f32_16x16x32_bf16 v[164:167], v[72:75], v[40:43], v[164:167]
  v_mfma_f32_16x16x32_bf16 v[168:171], v[72:75], v[44:47], v[168:171]
  ds_read_b128 v[24:27], v21 offset:0
  ds_read_b128 v[28:31], v21 offset:4096
  ds_read_b128 v[32:35], v21 offset:8192
  v_xor_b32 v17, 0, v19
  ds_read_b64_tr_b16 v[72:73], v17 offset:0
  ds_read_b64_tr_b16 v[74:75], v17 offset:1024
  v_xor_b32 v17, 192, v19
  ds_read_b64_tr_b16 v[96:97], v17 offset:0
  ds_read_b64_tr_b16 v[98:99], v17 offset:1024
  v_mfma_f32_16x16x32_bf16 v[172:175], v[76:79], v[36:39], v[172:175]
  s_add_u32 s4, s4, 32768
  v_mfma_f32_16x16x32_bf16 v[176:179], v[76:79], v[40:43], v[176:179]
  s_cmp_eq_u32 s4, 98304
  s_cselect_b32 s4, 0, s4
  v_mfma_f32_16x16x32_bf16 v[180:183], v[76:79], v[44:47], v[180:183]
  s_add_u32 s63, s63, 1
  v_xor_b32 v18, 32, v19
  ds_read_b64_tr_b16 v[76:77], v18 offset:0
  ds_read_b64_tr_b16 v[78:79], v18 offset:1024
  v_xor_b32 v18, 224, v19
  ds_read_b64_tr_b16 v[100:101], v18 offset:0
  ds_read_b64_tr_b16 v[102:103], v18 offset:1024
  v_mfma_f32_16x16x32_bf16 v[184:187], v[80:83], v[36:39], v[184:187]
  s_and_b32 s63, s63, s68
  v_mfma_f32_16x16x32_bf16 v[188:191], v[80:83], v[40:43], v[188:191]
  s_add_u32 s66, s4, s67
  v_mfma_f32_16x16x32_bf16 v[192:195], v[80:83], v[44:47], v[192:195]
  v_add_u32 v22, s66, v6
  v_xor_b32 v17, 64, v19
  ds_read_b64_tr_b16 v[80:81], v17 offset:0
  ds_read_b64_tr_b16 v[82:83], v17 offset:1024
  v_mfma_f32_16x16x32_bf16 v[196:199], v[84:87], v[36:39], v[196:199]
  s_and_b32 s69, s63, 3
  v_mfma_f32_16x16x32_bf16 v[200:203], v[84:87], v[40:43], v[200:203]
  s_lshl_b32 s69, s69, 6
  v_mfma_f32_16x16x32_bf16 v[204:207], v[84:87], v[44:47], v[204:207]
  s_lshr_b32 s71, s63, 2
  v_xor_b32 v18, 96, v19
  ds_read_b64_tr_b16 v[84:85], v18 offset:0
  ds_read_b64_tr_b16 v[86:87], v18 offset:1024
  v_mfma_f32_16x16x32_bf16 v[208:211], v[88:91], v[36:39], v[208:211]
  s_mul_i32 s71, s71, 12288
  v_mfma_f32_16x16x32_bf16 v[212:215], v[88:91], v[40:43], v[212:215]
  v_xor_b32 v21, s69, v8
  v_mfma_f32_16x16x32_bf16 v[216:219], v[88:91], v[44:47], v[216:219]
  v_add_u32 v21, s71, v21
  v_xor_b32 v17, 128, v19
  ds_read_b64_tr_b16 v[88:89], v17 offset:0
  ds_read_b64_tr_b16 v[90:91], v17 offset:1024
  v_mfma_f32_16x16x32_bf16 v[220:223], v[92:95], v[36:39], v[220:223]
  v_mfma_f32_16x16x32_bf16 v[224:227], v[92:95], v[40:43], v[224:227]
  v_mfma_f32_16x16x32_bf16 v[228:231], v[92:95], v[44:47], v[228:231]
  v_xor_b32 v18, 160, v19
  ds_read_b64_tr_b16 v[92:93], v18 offset:0
  ds_read_b64_tr_b16 v[94:95], v18 offset:1024
  v_mfma_f32_16x16x32_bf16 v[232:235], v[104:107], v[36:39], v[232:235]
  v_mfma_f32_16x16x32_bf16 v[236:239], v[104:107], v[40:43], v[236:239]
  v_mfma_f32_16x16x32_bf16 v[240:243], v[104:107], v[44:47], v[240:243]
  v_mfma_f32_16x16x32_bf16 v[244:247], v[108:111], v[36:39], v[244:247]
  v_mfma_f32_16x16x32_bf16 v[248:251], v[108:111], v[40:43], v[248:251]
  v_mfma_f32_16x16x32_bf16 v[252:255], v[108:111], v[44:47], v[252:255]
  s_branch L_wide_loop
L_wide_drain:
  s_waitcnt lgkmcnt(0)
  s_setpc_b64 s[92:93]
L_load:
  s_mov_b32 s70, 0
  s_cmp_eq_u32 s6, 3
  s_cbranch_scc0 L_load1
  s_waitcnt vmcnt(3) lgkmcnt(0)
  s_barrier
  s_add_u32 s42, s56, 1
  s_and_b32 s42, s42, s5
  s_mul_i32 s42, s42, s96
  s_add_u32 s42, s42, s73
  s_add_u32 m0, s62, 32768
  s_nop 0
  buffer_load_dwordx4 v4, s[80:83], s42 offen lds
  s_add_u32 m0, s62, 36864
  s_add_u32 s43, s42, 131072
  buffer_load_dwordx4 v4, s[80:83], s43 offen lds
  s_add_u32 m0, s62, 40960
  s_add_u32 s42, s42, s74
  buffer_load_dwordx4 v4, s[80:83], s42 offen lds
  s_add_u32 m0, s62, 45056
  s_add_u32 s43, s42, 131072
  buffer_load_dwordx4 v4, s[80:83], s43 offen lds
  s_add_u32 m0, s62, 49152
  s_add_u32 s42, s42, s74
  buffer_load_dwordx4 v4, s[80:83], s42 offen lds
  s_add_u32 m0, s62, 53248
  s_add_u32 s43, s42, 131072
  buffer_load_dwordx4 v4, s[80:83], s43 offen lds
  s_add_u32 m0, s62, 57344
  s_add_u32 s42, s42, s74
  buffer_load_dwordx4 v4, s[80:83], s42 offen lds
  s_add_u32 m0, s62, 61440
  s_add_u32 s43, s42, 131072
  buffer_load_dwordx4 v4, s[80:83], s43 offen lds
  s_add_u32 s42, s90, 2
  s_and_b32 s42, s42, 3
  s_cmp_eq_u32 s60, 1
  s_cselect_b32 s43, s42, 2
  s_mul_i32 s43, s43, 12288
  s_add_u32 s43, s43, s89
  s_lshl_b32 s42, s42, 8
  s_add_u32 s42, s42, s88
  s_add_u32 m0, s43, 0
  s_nop 0
  buffer_load_dwordx4 v160, s[28:31], s42 offen lds
  s_add_u32 m0, s43, 1024
  s_add_u32 s42, s42, 4096
  buffer_load_dwordx4 v161, s[28:31], s42 offen lds
  s_add_u32 m0, s43, 2048
  s_add_u32 s42, s42, 4096
  buffer_load_dwordx4 v162, s[28:31], s42 offen lds
  s_add_u32 s42, s56, 2
  s_and_b32 s42, s42, s5
  s_mul_i32 s42, s42, s96
  s_add_u32 s42, s42, s73
  s_add_u32 m0, s62, 65536
  s_nop 0
  buffer_load_dwordx4 v4, s[80:83], s42 offen lds
  s_add_u32 m0, s62, 69632
  s_add_u32 s43, s42, 131072
  buffer_load_dwordx4 v4, s[80:83], s43 offen lds
  s_add_u32 m0, s62, 73728
  s_add_u32 s42, s42, s74
  buffer_load_dwordx4 v4, s[80:83], s42 offen lds
  s_add_u32 m0, s62, 77824
  s_add_u32 s43, s42, 131072
  buffer_load_dwordx4 v4, s[80:83], s43 offen lds
  s_add_u32 m0, s62, 81920
  s_add_u32 s42, s42, s74
  buffer_load_dwordx4 v4, s[80:83], s42 offen lds
  s_add_u32 m0, s62, 86016
  s_add_u32 s43, s42, 131072
  buffer_load_dwordx4 v4, s[80:83], s43 offen lds
  s_add_u32 m0, s62, 90112
  s_add_u32 s42, s42, s74
  buffer_load_dwordx4 v4, s[80:83], s42 offen lds
  s_add_u32 m0, s62, 94208
  s_add_u32 s43, s42, 131072
  buffer_load_dwordx4 v4, s[80:83], s43 offen lds
  s_add_u32 s42, s90, 3
  s_and_b32 s42, s42, 3
  s_cmp_eq_u32 s60, 1
  s_cselect_b32 s43, s42, 3
  s_mul_i32 s43, s43, 12288
  s_add_u32 s68, s43, s89
  s_lshl_b32 s42, s42, 8
  s_add_u32 s67, s42, s88
  s_branch L_load2
L_load1:
  s_waitcnt vmcnt(16) lgkmcnt(0)
  s_barrier
L_load2:
  s_setprio 2
  s_add_u32 s97, s4, s62
  s_add_u32 s4, s4, 32768
  s_cmp_eq_u32 s4, 98304
  s_cselect_b32 s4, 0, s4
  s_and_b32 s94, s7, 0xffffff00
  s_and_b32 s95, s7, 7
  s_add_u32 s6, s6, 1
  s_lshl_b32 m0, s95, 2
  s_mul_i32 s42, s95, 5
  s_movrels_b64 s[84:85], s[8:9]
  s_movrels_b32 s86, s10
  v_readlane_b32 s7, v1, s6
  s_lshr_b32 s43, 0xd5210d, s42
  s_lshr_b32 s42, 0x8435b2, s42
  v_lshl_add_u32 v0, v2, s43, v3
  s_lshl_b32 s96, 1, s42
  s_lshl_b32 s89, 16, s43
L_ldloop:
  s_waitcnt vmcnt(8) lgkmcnt(0)
  s_barrier
  s_bitcmp1_b32 6, s95
  s_cbranch_scc1 L_kv117
  s_add_u32 m0, s97, 0
  s_nop 0
  buffer_load_dwordx4 v0, s[84:87], s94 offen lds
  s_add_u32 s5, s4, s62
  s_add_u32 s4, s4, 32768
  s_add_u32 m0, s97, 4096
  s_add_u32 s90, s94, s89
  buffer_load_dwordx4 v0, s[84:87], s90 offen lds
  s_cmp_eq_u32 s4, 98304
  s_cselect_b32 s4, 0, s4
  s_and_b32 s72, s7, 0xffffff00
  s_add_u32 m0, s97, 8192
  s_add_u32 s94, s94, s96
  buffer_load_dwordx4 v0, s[84:87], s94 offen lds
  s_and_b32 s73, s7, 7
  s_add_u32 s6, s6, 1
  s_add_u32 m0, s97, 12288
  s_add_u32 s90, s94, s89
  buffer_load_dwordx4 v0, s[84:87], s90 offen lds
  s_lshl_b32 m0, s73, 2
  s_mul_i32 s42, s73, 5
  s_movrels_b64 s[80:81], s[8:9]
  s_movrels_b32 s82, s10
  v_readlane_b32 s7, v1, s6
  s_add_u32 m0, s97, 16384
  s_add_u32 s94, s94, s96
  buffer_load_dwordx4 v0, s[84:87], s94 offen lds
  s_lshr_b32 s43, 0xd5210d, s42
  s_lshr_b32 s42, 0x8435b2, s42
  s_add_u32 m0, s97, 20480
  s_add_u32 s90, s94, s89
  buffer_load_dwordx4 v0, s[84:87], s90 offen lds
  v_lshl_add_u32 v4, v2, s43, v3
  s_lshl_b32 s74, 1, s42
  s_add_u32 m0, s97, 24576
  s_add_u32 s94, s94, s96
  buffer_load_dwordx4 v0, s[84:87], s94 offen lds
  s_lshl_b32 s88, 16, s43
  s_add_u32 m0, s97, 28672
  s_add_u32 s90, s94, s89
  buffer_load_dwordx4 v0, s[84:87], s90 offen lds
  s_branch L_dd118
L_kv117:
  s_add_u32 m0, s97, 0
  s_nop 0
  buffer_load_dwordx4 v0, s[84:87], s94 offen nt lds
  s_add_u32 s5, s4, s62
  s_add_u32 s4, s4, 32768
  s_add_u32 m0, s97, 4096
  s_add_u32 s90, s94, s89
  buffer_load_dwordx4 v0, s[84:87], s90 offen nt lds
  s_cmp_eq_u32 s4, 98304
  s_cselect_b32 s4, 0, s4
  s_and_b32 s72, s7, 0xffffff00
  s_add_u32 m0, s97, 8192
  s_add_u32 s94, s94, s96
  buffer_load_dwordx4 v0, s[84:87], s94 offen nt lds
  s_and_b32 s73, s7, 7
  s_add_u32 s6, s6, 1
  s_add_u32 m0, s97, 12288
  s_add_u32 s90, s94, s89
  buffer_load_dwordx4 v0, s[84:87], s90 offen nt lds
  s_lshl_b32 m0, s73, 2
  s_mul_i32 s42, s73, 5
  s_movrels_b64 s[80:81], s[8:9]
  s_movrels_b32 s82, s10
  v_readlane_b32 s7, v1, s6
  s_add_u32 m0, s97, 16384
  s_add_u32 s94, s94, s96
  buffer_load_dwordx4 v0, s[84:87], s94 offen nt lds
  s_lshr_b32 s43, 0xd5210d, s42
  s_lshr_b32 s42, 0x8435b2, s42
  s_add_u32 m0, s97, 20480
  s_add_u32 s90, s94, s89
  buffer_load_dwordx4 v0, s[84:87], s90 offen nt lds
  v_lshl_add_u32 v4, v2, s43, v3
  s_lshl_b32 s74, 1, s42
  s_add_u32 m0, s97, 24576
  s_add_u32 s94, s94, s96
  buffer_load_dwordx4 v0, s[84:87], s94 offen nt lds
  s_lshl_b32 s88, 16, s43
  s_add_u32 m0, s97, 28672
  s_add_u32 s90, s94, s89
  buffer_load_dwordx4 v0, s[84:87], s90 offen nt lds
L_dd118:
  s_cmp_eq_u32 s6, 5
  s_cbranch_scc0 L_ldh1
  s_add_u32 m0, s68, 0
  s_add_u32 s69, s67, 0
  buffer_load_dwordx4 v160, s[28:31], s69 offen lds
  s_add_u32 m0, s68, 1024
  s_add_u32 s69, s67, 4096
  buffer_load_dwordx4 v161, s[28:31], s69 offen lds
  s_add_u32 m0, s68, 2048
  s_add_u32 s69, s67, 8192
  buffer_load_dwordx4 v162, s[28:31], s69 offen lds
L_ldh1:
  s_cmp_eq_u32 s101, 2
  s_cbranch_scc0 L_ldh2
  v_mbcnt_lo_u32_b32 v162, -1, 0
  v_mbcnt_hi_u32_b32 v162, -1, v162
  v_lshrrev_b32 v161, 4, v162
  v_and_b32 v162, 15, v162
  v_xor_b32 v162, v162, v161
  v_lshlrev_b32 v162, 4, v162
  v_lshl_or_b32 v162, v161, 10, v162
  s_mul_i32 s66, s62, 3
  s_add_u32 s68, s66, 98304
  s_mul_i32 s67, s56, 49152
  s_lshl_b32 s69, s66, 2
  s_add_u32 s67, s67, s69
  s_lshr_b32 s66, s66, 4
  s_add_u32 s69, s66, 0
  s_and_b32 s69, s69, 0xc0
  v_xor_b32 v160, s69, v162
  s_add_u32 s69, s66, 64
  s_and_b32 s69, s69, 0xc0
  v_xor_b32 v161, s69, v162
  s_add_u32 s69, s66, 128
  s_and_b32 s69, s69, 0xc0
  v_xor_b32 v162, s69, v162
  s_lshr_b32 s90, s56, 2
  s_add_u32 s42, s90, 0
  s_and_b32 s42, s42, 3
  s_mul_i32 s43, s42, 12288
  s_add_u32 s43, s43, s68
  s_lshl_b32 s42, s42, 8
  s_add_u32 s42, s42, s67
  s_add_u32 m0, s43, 0
  s_nop 0
  buffer_load_dwordx4 v160, s[28:31], s42 offen lds
  s_add_u32 m0, s43, 1024
  s_add_u32 s42, s42, 4096
  buffer_load_dwordx4 v161, s[28:31], s42 offen lds
  s_add_u32 m0, s43, 2048
  s_add_u32 s42, s42, 4096
  buffer_load_dwordx4 v162, s[28:31], s42 offen lds
  s_lshr_b32 s90, s56, 2
  s_add_u32 s42, s90, 1
  s_and_b32 s42, s42, 3
  s_mul_i32 s43, s42, 12288
  s_add_u32 s43, s43, s68
  s_lshl_b32 s42, s42, 8
  s_add_u32 s42, s42, s67
  s_add_u32 m0, s43, 0
  s_nop 0
  buffer_load_dwordx4 v160, s[28:31], s42 offen lds
  s_add_u32 m0, s43, 1024
  s_add_u32 s42, s42, 4096
  buffer_load_dwordx4 v161, s[28:31], s42 offen lds
  s_add_u32 m0, s43, 2048
  s_add_u32 s42, s42, 4096
  buffer_load_dwordx4 v162, s[28:31], s42 offen lds
L_ldh2:
  s_waitcnt vmcnt(8) lgkmcnt(0)
  s_barrier
  s_bitcmp1_b32 6, s73
  s_cbranch_scc1 L_kv119
  s_add_u32 m0, s5, 0
  s_nop 0
  buffer_load_dwordx4 v4, s[80:83], s72 offen lds
  s_add_u32 s97, s4, s62
  s_add_u32 s4, s4, 32768
  s_add_u32 m0, s5, 4096
  s_add_u32 s90, s72, s88
  buffer_load_dwordx4 v4, s[80:83], s90 offen lds
  s_cmp_eq_u32 s4, 98304
  s_cselect_b32 s4, 0, s4
  s_and_b32 s94, s7, 0xffffff00
  s_add_u32 m0, s5, 8192
  s_add_u32 s72, s72, s74
  buffer_load_dwordx4 v4, s[80:83], s72 offen lds
  s_and_b32 s95, s7, 7
  s_add_u32 s6, s6, 1
  s_add_u32 m0, s5, 12288
  s_add_u32 s90, s72, s88
  buffer_load_dwordx4 v4, s[80:83], s90 offen lds
  s_lshl_b32 m0, s95, 2
  s_mul_i32 s42, s95, 5
  s_movrels_b64 s[84:85], s[8:9]
  s_movrels_b32 s86, s10
  v_readlane_b32 s7, v1, s6
  s_add_u32 m0, s5, 16384
  s_add_u32 s72, s72, s74
  buffer_load_dwordx4 v4, s[80:83], s72 offen lds
  s_lshr_b32 s43, 0xd5210d, s42
  s_lshr_b32 s42, 0x8435b2, s42
  s_add_u32 m0, s5, 20480
  s_add_u32 s90, s72, s88
  buffer_load_dwordx4 v4, s[80:83], s90 offen lds
  v_lshl_add_u32 v0, v2, s43, v3
  s_lshl_b32 s96, 1, s42
  s_add_u32 m0, s5, 24576
  s_add_u32 s72, s72, s74
  buffer_load_dwordx4 v4, s[80:83], s72 offen lds
  s_lshl_b32 s89, 16, s43
  s_add_u32 m0, s5, 28672
  s_add_u32 s90, s72, s88
  buffer_load_dwordx4 v4, s[80:83], s90 offen lds
  s_branch L_dd120
L_kv119:
  s_add_u32 m0, s5, 0
  s_nop 0
  buffer_load_dwordx4 v4, s[80:83], s72 offen nt lds
  s_add_u32 s97, s4, s62
  s_add_u32 s4, s4, 32768
  s_add_u32 m0, s5, 4096
  s_add_u32 s90, s72, s88
  buffer_load_dwordx4 v4, s[80:83], s90 offen nt lds
  s_cmp_eq_u32 s4, 98304
  s_cselect_b32 s4, 0, s4
  s_and_b32 s94, s7, 0xffffff00
  s_add_u32 m0, s5, 8192
  s_add_u32 s72, s72, s74
  buffer_load_dwordx4 v4, s[80:83], s72 offen nt lds
  s_and_b32 s95, s7, 7
  s_add_u32 s6, s6, 1
  s_add_u32 m0, s5, 12288
  s_add_u32 s90, s72, s88
  buffer_load_dwordx4 v4, s[80:83], s90 offen nt lds
  s_lshl_b32 m0, s95, 2
  s_mul_i32 s42, s95, 5
  s_movrels_b64 s[84:85], s[8:9]
  s_movrels_b32 s86, s10
  v_readlane_b32 s7, v1, s6
  s_add_u32 m0, s5, 16384
  s_add_u32 s72, s72, s74
  buffer_load_dwordx4 v4, s[80:83], s72 offen nt lds
  s_lshr_b32 s43, 0xd5210d, s42
  s_lshr_b32 s42, 0x8435b2, s42
  s_add_u32 m0, s5, 20480
  s_add_u32 s90, s72, s88
  buffer_load_dwordx4 v4, s[80:83], s90 offen nt lds
  v_lshl_add_u32 v0, v2, s43, v3
  s_lshl_b32 s96, 1, s42
  s_add_u32 m0, s5, 24576
  s_add_u32 s72, s72, s74
  buffer_load_dwordx4 v4, s[80:83], s72 offen nt lds
  s_lshl_b32 s89, 16, s43
  s_add_u32 m0, s5, 28672
  s_add_u32 s90, s72, s88
  buffer_load_dwordx4 v4, s[80:83], s90 offen nt lds
L_dd120:
  s_cmp_eq_u32 s65, 3
  s_cbranch_scc0 L_ld3
  s_cmp_eq_u32 s70, s75
  s_cbranch_scc0 L_ld3
  s_waitcnt vmcnt(8) lgkmcnt(0)
  s_barrier
  s_add_u32 s5, s4, s62
  s_add_u32 s4, s4, 32768
  s_cmp_eq_u32 s4, 98304
  s_cselect_b32 s4, 0, s4
  s_and_b32 s72, s7, 0xffffff00
  s_and_b32 s73, s7, 7
  s_add_u32 s6, s6, 1
  s_lshl_b32 m0, s73, 2
  s_mul_i32 s42, s73, 5
  s_movrels_b64 s[80:81], s[8:9]
  s_movrels_b32 s82, s10
  v_readlane_b32 s7, v1, s6
  s_lshr_b32 s43, 0xd5210d, s42
  s_lshr_b32 s42, 0x8435b2, s42
  v_lshl_add_u32 v4, v2, s43, v3
  s_lshl_b32 s74, 1, s42
  s_lshl_b32 s88, 16, s43
  s_barrier
  s_add_u32 m0, s97, 0
  s_add_u32 s90, s94, s89
  buffer_load_dwordx4 v0, s[84:87], s94 offen nt lds
  s_add_u32 m0, m0, 4096
  s_nop 0
  buffer_load_dwordx4 v0, s[84:87], s90 offen nt lds
L_sk121:
  s_add_u32 s94, s94, s96
  s_add_u32 m0, s97, 8192
  s_add_u32 s90, s94, s89
  buffer_load_dwordx4 v0, s[84:87], s94 offen nt lds
  s_add_u32 m0, m0, 4096
  s_nop 0
  buffer_load_dwordx4 v0, s[84:87], s90 offen nt lds
L_sk122:
  s_add_u32 s94, s94, s96
  s_add_u32 m0, s97, 16384
  s_add_u32 s90, s94, s89
  buffer_load_dwordx4 v0, s[84:87], s94 offen nt lds
  s_add_u32 m0, m0, 4096
  s_nop 0
  buffer_load_dwordx4 v0, s[84:87], s90 offen nt lds
L_sk123:
  s_add_u32 s94, s94, s96
  s_add_u32 m0, s97, 24576
  s_add_u32 s90, s94, s89
  buffer_load_dwordx4 v0, s[84:87], s94 offen nt lds
  s_add_u32 m0, m0, 4096
  s_nop 0
  buffer_load_dwordx4 v0, s[84:87], s90 offen nt lds
L_sk124:
  s_setprio 0
  s_setpc_b64 s[92:93]
L_ld3:
  s_waitcnt vmcnt(8) lgkmcnt(0)
  s_barrier
  s_bitcmp1_b32 6, s95
  s_cbranch_scc1 L_kv125
  s_add_u32 m0, s97, 0
  s_nop 0
  buffer_load_dwordx4 v0, s[84:87], s94 offen lds
  s_add_u32 s5, s4, s62
  s_add_u32 s4, s4, 32768
  s_add_u32 m0, s97, 4096
  s_add_u32 s90, s94, s89
  buffer_load_dwordx4 v0, s[84:87], s90 offen lds
  s_cmp_eq_u32 s4, 98304
  s_cselect_b32 s4, 0, s4
  s_and_b32 s72, s7, 0xffffff00
  s_add_u32 m0, s97, 8192
  s_add_u32 s94, s94, s96
  buffer_load_dwordx4 v0, s[84:87], s94 offen lds
  s_and_b32 s73, s7, 7
  s_add_u32 s6, s6, 1
  s_add_u32 m0, s97, 12288
  s_add_u32 s90, s94, s89
  buffer_load_dwordx4 v0, s[84:87], s90 offen lds
  s_lshl_b32 m0, s73, 2
  s_mul_i32 s42, s73, 5
  s_movrels_b64 s[80:81], s[8:9]
  s_movrels_b32 s82, s10
  v_readlane_b32 s7, v1, s6
  s_add_u32 m0, s97, 16384
  s_add_u32 s94, s94, s96
  buffer_load_dwordx4 v0, s[84:87], s94 offen lds
  s_lshr_b32 s43, 0xd5210d, s42
  s_lshr_b32 s42, 0x8435b2, s42
  s_add_u32 m0, s97, 20480
  s_add_u32 s90, s94, s89
  buffer_load_dwordx4 v0, s[84:87], s90 offen lds
  v_lshl_add_u32 v4, v2, s43, v3
  s_lshl_b32 s74, 1, s42
  s_add_u32 m0, s97, 24576
  s_add_u32 s94, s94, s96
  buffer_load_dwordx4 v0, s[84:87], s94 offen lds
  s_lshl_b32 s88, 16, s43
  s_add_u32 m0, s97, 28672
  s_add_u32 s90, s94, s89
  buffer_load_dwordx4 v0, s[84:87], s90 offen lds
  s_branch L_dd126
L_kv125:
  s_add_u32 m0, s97, 0
  s_nop 0
  buffer_load_dwordx4 v0, s[84:87], s94 offen nt lds
  s_add_u32 s5, s4, s62
  s_add_u32 s4, s4, 32768
  s_add_u32 m0, s97, 4096
  s_add_u32 s90, s94, s89
  buffer_load_dwordx4 v0, s[84:87], s90 offen nt lds
  s_cmp_eq_u32 s4, 98304
  s_cselect_b32 s4, 0, s4
  s_and_b32 s72, s7, 0xffffff00
  s_add_u32 m0, s97, 8192
  s_add_u32 s94, s94, s96
  buffer_load_dwordx4 v0, s[84:87], s94 offen nt lds
  s_and_b32 s73, s7, 7
  s_add_u32 s6, s6, 1
  s_add_u32 m0, s97, 12288
  s_add_u32 s90, s94, s89
  buffer_load_dwordx4 v0, s[84:87], s90 offen nt lds
  s_lshl_b32 m0, s73, 2
  s_mul_i32 s42, s73, 5
  s_movrels_b64 s[80:81], s[8:9]
  s_movrels_b32 s82, s10
  v_readlane_b32 s7, v1, s6
  s_add_u32 m0, s97, 16384
  s_add_u32 s94, s94, s96
  buffer_load_dwordx4 v0, s[84:87], s94 offen nt lds
  s_lshr_b32 s43, 0xd5210d, s42
  s_lshr_b32 s42, 0x8435b2, s42
  s_add_u32 m0, s97, 20480
  s_add_u32 s90, s94, s89
  buffer_load_dwordx4 v0, s[84:87], s90 offen nt lds
  v_lshl_add_u32 v4, v2, s43, v3
  s_lshl_b32 s74, 1, s42
  s_add_u32 m0, s97, 24576
  s_add_u32 s94, s94, s96
  buffer_load_dwordx4 v0, s[84:87], s94 offen nt lds
  s_lshl_b32 s88, 16, s43
  s_add_u32 m0, s97, 28672
  s_add_u32 s90, s94, s89
  buffer_load_dwordx4 v0, s[84:87], s90 offen nt lds
L_dd126:
  s_add_u32 s70, s70, 12288
  s_cmp_gt_u32 s70, s75
  s_cbranch_scc1 L_lddrain
  s_waitcnt vmcnt(8) lgkmcnt(0)
  s_barrier
  s_bitcmp1_b32 6, s73
  s_cbranch_scc1 L_kv127
  s_add_u32 m0, s5, 0
  s_nop 0
  buffer_load_dwordx4 v4, s[80:83], s72 offen lds
  s_add_u32 s97, s4, s62
  s_add_u32 s4, s4, 32768
  s_add_u32 m0, s5, 4096
  s_add_u32 s90, s72, s88
  buffer_load_dwordx4 v4, s[80:83], s90 offen lds
  s_cmp_eq_u32 s4, 98304
  s_cselect_b32 s4, 0, s4
  s_and_b32 s94, s7, 0xffffff00
  s_add_u32 m0, s5, 8192
  s_add_u32 s72, s72, s74
  buffer_load_dwordx4 v4, s[80:83], s72 offen lds
  s_and_b32 s95, s7, 7
  s_add_u32 s6, s6, 1
  s_add_u32 m0, s5, 12288
  s_add_u32 s90, s72, s88
  buffer_load_dwordx4 v4, s[80:83], s90 offen lds
  s_lshl_b32 m0, s95, 2
  s_mul_i32 s42, s95, 5
  s_movrels_b64 s[84:85], s[8:9]
  s_movrels_b32 s86, s10
  v_readlane_b32 s7, v1, s6
  s_add_u32 m0, s5, 16384
  s_add_u32 s72, s72, s74
  buffer_load_dwordx4 v4, s[80:83], s72 offen lds
  s_lshr_b32 s43, 0xd5210d, s42
  s_lshr_b32 s42, 0x8435b2, s42
  s_add_u32 m0, s5, 20480
  s_add_u32 s90, s72, s88
  buffer_load_dwordx4 v4, s[80:83], s90 offen lds
  v_lshl_add_u32 v0, v2, s43, v3
  s_lshl_b32 s96, 1, s42
  s_add_u32 m0, s5, 24576
  s_add_u32 s72, s72, s74
  buffer_load_dwordx4 v4, s[80:83], s72 offen lds
  s_lshl_b32 s89, 16, s43
  s_add_u32 m0, s5, 28672
  s_add_u32 s90, s72, s88
  buffer_load_dwordx4 v4, s[80:83], s90 offen lds
  s_branch L_dd128
L_kv127:
  s_add_u32 m0, s5, 0
  s_nop 0
  buffer_load_dwordx4 v4, s[80:83], s72 offen nt lds
  s_add_u32 s97, s4, s62
  s_add_u32 s4, s4, 32768
  s_add_u32 m0, s5, 4096
  s_add_u32 s90, s72, s88
  buffer_load_dwordx4 v4, s[80:83], s90 offen nt lds
  s_cmp_eq_u32 s4, 98304
  s_cselect_b32 s4, 0, s4
  s_and_b32 s94, s7, 0xffffff00
  s_add_u32 m0, s5, 8192
  s_add_u32 s72, s72, s74
  buffer_load_dwordx4 v4, s[80:83], s72 offen nt lds
  s_and_b32 s95, s7, 7
  s_add_u32 s6, s6, 1
  s_add_u32 m0, s5, 12288
  s_add_u32 s90, s72, s88
  buffer_load_dwordx4 v4, s[80:83], s90 offen nt lds
  s_lshl_b32 m0, s95, 2
  s_mul_i32 s42, s95, 5
  s_movrels_b64 s[84:85], s[8:9]
  s_movrels_b32 s86, s10
  v_readlane_b32 s7, v1, s6
  s_add_u32 m0, s5, 16384
  s_add_u32 s72, s72, s74
  buffer_load_dwordx4 v4, s[80:83], s72 offen nt lds
  s_lshr_b32 s43, 0xd5210d, s42
  s_lshr_b32 s42, 0x8435b2, s42
  s_add_u32 m0, s5, 20480
  s_add_u32 s90, s72, s88
  buffer_load_dwordx4 v4, s[80:83], s90 offen nt lds
  v_lshl_add_u32 v0, v2, s43, v3
  s_lshl_b32 s96, 1, s42
  s_add_u32 m0, s5, 24576
  s_add_u32 s72, s72, s74
  buffer_load_dwordx4 v4, s[80:83], s72 offen nt lds
  s_lshl_b32 s89, 16, s43
  s_add_u32 m0, s5, 28672
  s_add_u32 s90, s72, s88
  buffer_load_dwordx4 v4, s[80:83], s90 offen nt lds
L_dd128:
  s_cmp_eq_u32 s101, 1
  s_cbranch_scc0 L_hk129
  s_add_u32 m0, s68, 0
  s_add_u32 s69, s67, 0
  buffer_load_dwordx4 v160, s[28:31], s69 offen lds
  s_add_u32 m0, s68, 1024
  s_add_u32 s69, s67, 4096
  buffer_load_dwordx4 v161, s[28:31], s69 offen lds
  s_add_u32 m0, s68, 2048
  s_add_u32 s69, s67, 8192
  buffer_load_dwordx4 v162, s[28:31], s69 offen lds
  s_add_u32 s67, s67, 256
  s_add_u32 s68, s68, 12288
L_hk129:
  s_branch L_ldloop
L_lddrain:
  s_cmp_eq_u32 s65, 2
  s_cbranch_scc1 L_ldret
  s_waitcnt lgkmcnt(0)
  s_barrier
  s_bitcmp1_b32 6, s73
  s_cbranch_scc1 L_kv130
  s_add_u32 m0, s5, 0
  s_nop 0
  buffer_load_dwordx4 v4, s[80:83], s72 offen lds
  s_add_u32 m0, s5, 4096
  s_add_u32 s90, s72, s88
  buffer_load_dwordx4 v4, s[80:83], s90 offen lds
  s_add_u32 m0, s5, 8192
  s_add_u32 s72, s72, s74
  buffer_load_dwordx4 v4, s[80:83], s72 offen lds
  s_add_u32 m0, s5, 12288
  s_add_u32 s90, s72, s88
  buffer_load_dwordx4 v4, s[80:83], s90 offen lds
  s_add_u32 m0, s5, 16384
  s_add_u32 s72, s72, s74
  buffer_load_dwordx4 v4, s[80:83], s72 offen lds
  s_add_u32 m0, s5, 20480
  s_add_u32 s90, s72, s88
  buffer_load_dwordx4 v4, s[80:83], s90 offen lds
  s_add_u32 m0, s5, 24576
  s_add_u32 s72, s72, s74
  buffer_load_dwordx4 v4, s[80:83], s72 offen lds
  s_add_u32 m0, s5, 28672
  s_add_u32 s90, s72, s88
  buffer_load_dwordx4 v4, s[80:83], s90 offen lds
  s_branch L_dd131
L_kv130:
  s_add_u32 m0, s5, 0
  s_nop 0
  buffer_load_dwordx4 v4, s[80:83], s72 offen nt lds
  s_add_u32 m0, s5, 4096
  s_add_u32 s90, s72, s88
  buffer_load_dwordx4 v4, s[80:83], s90 offen nt lds
  s_add_u32 m0, s5, 8192
  s_add_u32 s72, s72, s74
  buffer_load_dwordx4 v4, s[80:83], s72 offen nt lds
  s_add_u32 m0, s5, 12288
  s_add_u32 s90, s72, s88
  buffer_load_dwordx4 v4, s[80:83], s90 offen nt lds
  s_add_u32 m0, s5, 16384
  s_add_u32 s72, s72, s74
  buffer_load_dwordx4 v4, s[80:83], s72 offen nt lds
  s_add_u32 m0, s5, 20480
  s_add_u32 s90, s72, s88
  buffer_load_dwordx4 v4, s[80:83], s90 offen nt lds
  s_add_u32 m0, s5, 24576
  s_add_u32 s72, s72, s74
  buffer_load_dwordx4 v4, s[80:83], s72 offen nt lds
  s_add_u32 m0, s5, 28672
  s_add_u32 s90, s72, s88
  buffer_load_dwordx4 v4, s[80:83], s90 offen nt lds
L_dd131:
  s_cmp_eq_u32 s101, 1
  s_cbranch_scc0 L_hk132
  s_add_u32 m0, s68, 0
  s_add_u32 s69, s67, 0
  buffer_load_dwordx4 v160, s[28:31], s69 offen lds
  s_add_u32 m0, s68, 1024
  s_add_u32 s69, s67, 4096
  buffer_load_dwordx4 v161, s[28:31], s69 offen lds
  s_add_u32 m0, s68, 2048
  s_add_u32 s69, s67, 8192
  buffer_load_dwordx4 v162, s[28:31], s69 offen lds
  s_add_u32 s67, s67, 256
  s_add_u32 s68, s68, 12288
L_hk132:
  s_cmp_eq_u32 s101, 4
  s_cbranch_scc0 L_ldh3
  s_and_b32 s94, s7, 0xffffff00
  s_and_b32 s95, s7, 7
  s_add_u32 s6, s6, 1
  s_lshl_b32 m0, s95, 2
  s_mul_i32 s42, s95, 5
  s_movrels_b64 s[84:85], s[8:9]
  s_movrels_b32 s86, s10
  v_readlane_b32 s7, v1, s6
  s_lshr_b32 s43, 0xd5210d, s42
  s_lshr_b32 s42, 0x8435b2, s42
  v_lshl_add_u32 v0, v2, s43, v3
  s_lshl_b32 s96, 1, s42
  s_lshl_b32 s89, 16, s43
  s_add_u32 s97, s62, 110592
  s_add_u32 m0, s97, 0
  s_add_u32 s90, s94, s89
  buffer_load_dwordx4 v0, s[84:87], s94 offen nt lds
  s_add_u32 m0, m0, 4096
  s_nop 0
  buffer_load_dwordx4 v0, s[84:87], s90 offen nt lds
L_sk133:
  s_add_u32 s94, s94, s96
  s_add_u32 m0, s97, 8192
  s_add_u32 s90, s94, s89
  buffer_load_dwordx4 v0, s[84:87], s94 offen nt lds
  s_add_u32 m0, m0, 4096
  s_nop 0
  buffer_load_dwordx4 v0, s[84:87], s90 offen nt lds
L_sk134:
  s_add_u32 s94, s94, s96
  s_add_u32 m0, s97, 16384
  s_add_u32 s90, s94, s89
  buffer_load_dwordx4 v0, s[84:87], s94 offen nt lds
  s_add_u32 m0, m0, 4096
  s_nop 0
  buffer_load_dwordx4 v0, s[84:87], s90 offen nt lds
L_sk135:
  s_add_u32 s94, s94, s96
  s_add_u32 m0, s97, 24576
  s_add_u32 s90, s94, s89
  buffer_load_dwordx4 v0, s[84:87], s94 offen nt lds
  s_add_u32 m0, m0, 4096
  s_nop 0
  buffer_load_dwordx4 v0, s[84:87], s90 offen nt lds
L_sk136:
L_ldh3:
  s_cmp_eq_u32 s101, 2
  s_cbranch_scc0 L_ldret
  s_lshr_b32 s90, s56, 2
  s_add_u32 s42, s90, 2
  s_and_b32 s42, s42, 3
  s_mul_i32 s43, s42, 12288
  s_add_u32 s43, s43, s68
  s_lshl_b32 s42, s42, 8
  s_add_u32 s42, s42, s67
  s_add_u32 m0, s43, 0
  s_nop 0
  buffer_load_dwordx4 v160, s[28:31], s42 offen lds
  s_add_u32 m0, s43, 1024
  s_add_u32 s42, s42, 4096
  buffer_load_dwordx4 v161, s[28:31], s42 offen lds
  s_add_u32 m0, s43, 2048
  s_add_u32 s42, s42, 4096
  buffer_load_dwordx4 v162, s[28:31], s42 offen lds
  s_lshr_b32 s90, s56, 2
  s_add_u32 s42, s90, 3
  s_and_b32 s42, s42, 3
  s_mul_i32 s43, s42, 12288
  s_add_u32 s43, s43, s68
  s_lshl_b32 s42, s42, 8
  s_add_u32 s42, s42, s67
  s_add_u32 m0, s43, 0
  s_nop 0
  buffer_load_dwordx4 v160, s[28:31], s42 offen lds
  s_add_u32 m0, s43, 1024
  s_add_u32 s42, s42, 4096
  buffer_load_dwordx4 v161, s[28:31], s42 offen lds
  s_add_u32 m0, s43, 2048
  s_add_u32 s42, s42, 4096
  buffer_load_dwordx4 v162, s[28:31], s42 offen lds
L_ldret:
  s_setprio 0
  s_setpc_b64 s[92:93]
.p2align 2
.type L_table,@object
L_table:
  .long 0x0, 0x100000, 0x200000, 0x300000, 0x9, 0x8009, 0x10009, 0x18009
  .long 0x100, 0x100100, 0x200100, 0x300100, 0x200, 0x100200, 0x200200, 0x300200
  .long 0xa, 0x800a, 0x1000a, 0x1800a, 0x13, 0x8013, 0x10013, 0x20009
  .long 0x18013, 0x28009, 0x30009, 0x38009, 0x2000a, 0x2800a, 0x3000a, 0x3800a
  .long 0x20013, 0x28013, 0x30013, 0x40009, 0x38013, 0x48009, 0x50009, 0x58009
  .long 0x4000a, 0x4800a, 0x5000a, 0x5800a, 0x40013, 0x48013, 0x50013, 0x58013
  .long 0x40000000, 0x40000000, 0x40000000, 0x40000000, 0x40000000, 0x40000000, 0x40000000, 0x40000000
  .long 0x40000000, 0x40000000, 0x40000000, 0x40000000, 0x40000000, 0x40000000, 0x40000000, 0x40000000
  .long 0x4, 0x40004, 0x80004, 0xc0004, 0x100004, 0x140004, 0x180004, 0x1c0004
  .long 0x200004, 0x240004, 0x280004, 0x2c0004, 0x300004, 0x340004, 0x380004, 0x3c0004
  .long 0x19, 0x1a, 0x8019, 0x801a, 0x10019, 0x1001a, 0x18019, 0x1801a
  .long 0x13, 0x8013, 0x10013, 0x18013, 0x20013, 0x28013, 0x30013, 0x38013
  .long 0x40013, 0x48013, 0x50013, 0x58013, 0x60013, 0x68013, 0x70013, 0x78013
  .long 0x0, 0x100000, 0x200000, 0x300000, 0x9, 0x8009, 0x10009, 0x18009
  .long 0xa, 0x800a, 0x1000a, 0x1800a, 0x13, 0x8013, 0x10013, 0x18013
  .long 0x40000000, 0x40000000, 0x40000000, 0x40000000, 0x40000000, 0x40000000, 0x40000000, 0x40000000
  .long 0x0, 0x100000, 0x200000, 0x300000, 0x9, 0x8009, 0x10009, 0x18009
  .long 0xa, 0x800a, 0x1000a, 0x1800a, 0x13, 0x8013, 0x10013, 0x18013
  .long 0x4, 0x40004, 0x80004, 0xc0004, 0x100004, 0x140004, 0x180004, 0x1c0004
  .long 0x200004, 0x240004, 0x280004, 0x2c0004, 0x300004, 0x340004, 0x380004, 0x3c0004
  .long 0x19, 0x1a, 0x8019, 0x801a, 0x10019, 0x1001a, 0x18019, 0x1801a
  .long 0x13, 0x8013, 0x10013, 0x18013, 0x20013, 0x28013, 0x30013, 0x38013
  .long 0x40013, 0x48013, 0x50013, 0x58013, 0x60013, 0x68013, 0x70013, 0x78013
  .long 0x40000000, 0x40000000, 0x40000000, 0x40000000, 0x40000000, 0x40000000, 0x40000000, 0x40000000
.section .rodata,"a"
.p2align 6
.amdhsa_kernel concat_heads__gqa_block_cached__mha_block_cached__near_ridge_kernel
  .amdhsa_next_free_vgpr 256
  .amdhsa_next_free_sgpr 102
  .amdhsa_accum_offset 256
  .amdhsa_group_segment_fixed_size 0
  .amdhsa_kernarg_size 104
  .amdhsa_user_sgpr_count 2
  .amdhsa_user_sgpr_kernarg_segment_ptr 1
  .amdhsa_system_sgpr_workgroup_id_x 1
.end_amdhsa_kernel
```
